```python
import torch

def _softmax(x, axis=-1):
    return torch.softmax(x, dim=axis)
def _gelu(x):
    return torch.nn.functional.gelu(x, approximate="tanh")
def _silu(x):
    return torch.nn.functional.silu(x)
def _sigmoid(x):
    return torch.sigmoid(x)
def _layernorm(x, axis=-1, eps=1e-5):
    m = x.mean(dim=axis, keepdim=True)
    v = x.var(dim=axis, keepdim=True, unbiased=False)
    return (x - m) / torch.sqrt(v + eps)
def _scatter_add(tgt, idx, src, axis=0):
    return tgt.clone().index_add_(axis, idx, src)
def _segment_sum(src, seg, n):
    out = torch.zeros((n,) + src.shape[1:], dtype=src.dtype)
    return out.index_add_(0, seg, src)
def _pad(x, pw):
    flat = tuple(v for pair in reversed(pw) for v in pair)
    return torch.nn.functional.pad(x, flat)

kernel_name = 'parallel_sum__ssm_conv_h3__glu_gated_bilinear__prompt'

def setup_inputs():

    _w = (lambda a: (lambda t: t.to(torch.bfloat16) if t.is_floating_point() else t)(torch.as_tensor(a)))
    def _A_setup():
        B, S, D = 1, 2048, 448
        ks = 4
        return {
            "q": _w((lambda *s: torch.randn(*s, dtype=torch.bfloat16) * 0.05)(B, S, D)),
            "k": _w((lambda *s: torch.randn(*s, dtype=torch.bfloat16) * 0.2)(B, S, D)),
            "v": _w((lambda *s: torch.randn(*s, dtype=torch.bfloat16) * 0.2)(B, S, D)),
            "shift_k": _w((lambda *s: torch.randn(*s, dtype=torch.bfloat16) * 0.2)(D, ks) * 0.5),
            "ssm_k": _w((lambda *s: torch.randn(*s, dtype=torch.bfloat16) * 0.4)(D, S) * (1.0 / S ** 0.5)),
            "ssm_D": _w((lambda *s: torch.randn(*s, dtype=torch.bfloat16) * 0.2)(D)),
        }
    _A_in = _A_setup()

    def _B_setup():
        B, S, D, F = 1, 2048, 448, 1792
        return {
            "x": _w((lambda *s: torch.randn(*s, dtype=torch.bfloat16) * 0.05)(B, S, D)),
            "w_gate": _w((lambda *s: torch.randn(*s, dtype=torch.bfloat16) * 0.2)(D, F) * (D ** -0.5)),
            "w_up": _w((lambda *s: torch.randn(*s, dtype=torch.bfloat16) * 0.2)(D, F) * (D ** -0.5)),
            "w_down": _w((lambda *s: torch.randn(*s, dtype=torch.bfloat16) * 0.2)(F, D) * (F ** -0.5)),
        }
    _B_in = _B_setup()

    return {
        "A_q": _A_in["q"],
        "A_k": _A_in["k"],
        "A_v": _A_in["v"],
        "A_shift_k": _A_in["shift_k"],
        "A_ssm_k": _A_in["ssm_k"],
        "A_ssm_D": _A_in["ssm_D"],
        "B_x": _B_in["x"],
        "B_w_gate": _B_in["w_gate"],
        "B_w_up": _B_in["w_up"],
        "B_w_down": _B_in["w_down"],
    }

def reference(A_q, A_k, A_v, A_shift_k, A_ssm_k, A_ssm_D, B_x, B_w_gate, B_w_up, B_w_down):
    def _A_ref(q, k, v, shift_k, ssm_k, ssm_D):
        B, S, D = q.shape
        ks = shift_k.shape[-1]
        k_pad = _pad(k, ((0, 0), (ks - 1, 0), (0, 0)))
        k_shift = torch.zeros_like(k)
        for t in range(ks):
            k_shift = k_shift + k_pad[:, t:t + S, :] * shift_k[:, ks - 1 - t][None, None, :]
        kv = k_shift * v
        L = 2 * S
        kv_pad = _pad(kv, ((0, 0), (0, S), (0, 0)))
        kf_pad = _pad(ssm_k, ((0, 0), (0, S)))
        kv_f = (lambda x, axes=(-2,-1): torch.fft.rfft2(x.float(), dim=axes))(kv_pad[:, None, :, :], axes=(1, 2))
        kf_f = (lambda x, axes=(-2,-1): torch.fft.rfft2(x.float(), dim=axes))(kf_pad[:, None, :], axes=(1, 2))
        kf_f = (lambda x, *d: x.permute(*d))(kf_f, 1, 2, 0)
        y_f = kv_f * kf_f[None, :, :, :]
        y = (lambda x, s, axes=(-2,-1): torch.fft.irfft2(x, s=s, dim=axes).to(torch.bfloat16))(y_f, (1, L), axes=(1, 2))[:, 0, :S, :]
        y = y + kv * ssm_D[None, None, :]
        return q * y

    def _B_ref(x, w_gate, w_up, w_down):
        g = torch.einsum("bsd,df->bsf", x, w_gate)
        u = torch.einsum("bsd,df->bsf", x, w_up)
        h = g * u
        return torch.einsum("bsf,fd->bsd", h, w_down)

    x = A_q
    xn = _layernorm(x, axis=-1)
    return x + _A_ref(xn, A_k, A_v, A_shift_k, A_ssm_k, A_ssm_D) + _B_ref(xn, B_w_gate, B_w_up, B_w_down)
```

```asm
; @launch grid=(256,1,1) block=(256,1,1) lds=163840
.amdgcn_target "amdgcn-amd-amdhsa--gfx950"
.text
.globl parallel_sum__ssm_conv_h3__glu_gated_bilinear__prompt_kernel
.p2align 8
.type parallel_sum__ssm_conv_h3__glu_gated_bilinear__prompt_kernel,@function
parallel_sum__ssm_conv_h3__glu_gated_bilinear__prompt_kernel:
    s_cmp_ge_u32 s2, 256
    s_cbranch_scc1 L_end
    s_load_dwordx16 s[16:31], s[0:1], 0
    s_load_dwordx8 s[32:39], s[0:1], 64
    s_load_dwordx2 s[40:41], s[0:1], 96
    s_memrealtime s[92:93]
    s_getpc_b64 s[8:9]
L_pc:
    v_lshrrev_b32 v1, 6, v0
    v_and_b32 v2, 63, v0
    v_readfirstlane_b32 s3, v1
    v_lshlrev_b32 v3, 4, v2
    v_cmp_eq_u32 vcc, 0, v0
    v_bfrev_b32 v5, 1
    s_nop 0
    v_cndmask_b32 v4, v5, 0, vcc
    s_and_b32 s4, s2, 7
    s_lshr_b32 s5, s2, 3
    s_mov_b32 s100, 0
    s_lshl_b32 s6, s5, 2
    s_add_u32 s6, s6, s3
    s_lshl_b32 s6, s6, 9
    v_and_b32 v5, 3, v2
    v_lshlrev_b32 v5, 7, v5
    v_add_u32 v5, s6, v5
    v_min_u32 v5, L_end-L_pc, v5
    global_load_dword v16, v5, s[8:9]
    s_mov_b32 s15, 0xffff0000
    s_lshl_b32 s14, s3, 12
    s_lshr_b32 s10, s3, 1
    s_and_b32 s11, s3, 1
    s_cmp_ge_u32 s5, 30
    s_cbranch_scc1 L_srole
    s_cmp_ge_u32 s5, 16
    s_cbranch_scc1 L_crole
    s_lshr_b32 s6, s5, 2
    s_and_b32 s7, s5, 3
    s_lshr_b32 s64, s4, 1
    s_lshl_b32 s64, s64, 2
    s_add_u32 s64, s64, s6
    s_and_b32 s65, s4, 1
    s_lshl_b32 s65, s65, 2
    s_add_u32 s65, s65, s7
    s_and_b32 s67, s7, 1
    s_add_u32 s68, s6, s7
    s_and_b32 s68, s68, 3
    s_lshl_b32 s68, s68, 1
    v_lshrrev_b32 v15, 3, v2
    v_and_b32 v1, 7, v2
    v_lshrrev_b32 v5, 1, v15
    v_xor_b32 v5, v5, v1
    v_mul_u32_u24 v204, 896, v15
    v_lshl_add_u32 v204, v5, 4, v204
    v_xor_b32 v205, 64, v204
    v_add_u32 v205, 6144, v205
    v_add_u32 v206, 12288, v204
    v_add_u32 v207, 12288, v205
    s_lshl_b32 s5, s10, 3
    s_lshl_b32 s6, s10, 2
    v_and_b32 v5, 2, v15
    v_or_b32 v5, s6, v5
    v_xor_b32 v5, v5, v1
    v_add_u32 v208, s5, v15
    v_mul_u32_u24 v208, 3584, v208
    v_lshl_add_u32 v208, v5, 4, v208
    v_add_u32 v209, 56320, v208
    v_add_u32 v210, 112640, v208
    v_add_u32 v211, 168960, v208
    s_lshl_b32 s6, s64, 2
    s_add_u32 s6, s6, s3
    s_mul_i32 s6, s6, 28672
    s_lshr_b32 s7, s65, 1
    s_mul_i32 s7, s7, 896
    s_mul_i32 s5, s67, 384
    s_add_u32 s7, s7, s5
    s_lshl_b32 s70, s68, 7
    s_add_u32 s70, s70, s6
    s_mul_i32 s77, s68, 229376
    s_add_u32 s77, s77, s7
    s_add_u32 s5, s68, 1
    s_cmp_ge_u32 s5, 7
    s_cselect_b32 s4, 7, 0
    s_sub_u32 s5, s5, s4
    s_lshl_b32 s71, s5, 7
    s_add_u32 s71, s71, s6
    s_mul_i32 s78, s5, 229376
    s_add_u32 s78, s78, s7
    s_mov_b32 s46, 1835008
    s_mov_b32 s47, 0x00020000
    s_mov_b32 s50, 1605632
    s_mov_b32 s51, 0x00020000
    s_cmp_eq_u32 s11, 0
    s_waitcnt lgkmcnt(0)
    s_mov_b32 s44, s16
    s_mov_b32 s45, s17
    s_cselect_b32 s48, s30, s32
    s_cselect_b32 s49, s31, s33
    s_add_u32 m0, s14, 0
    s_nop 0
    buffer_load_dwordx4 v204, s[44:47], s70 offen offset:0 lds
    buffer_load_dwordx4 v205, s[44:47], s70 offen offset:1024 lds
    buffer_load_dwordx4 v206, s[44:47], s70 offen offset:2048 lds
    buffer_load_dwordx4 v207, s[44:47], s70 offen offset:3072 lds
    s_add_u32 m0, s14, 49152
    s_nop 0
    buffer_load_dwordx4 v208, s[48:51], s77 offen offset:0 lds
    buffer_load_dwordx4 v209, s[48:51], s77 offen offset:1024 lds
    buffer_load_dwordx4 v210, s[48:51], s77 offen offset:2048 lds
    buffer_load_dwordx4 v211, s[48:51], s77 offen offset:3072 lds
    s_mov_b32 s60, s38
    s_mov_b32 s61, s39
    s_mov_b32 s62, 256
    s_mov_b32 s63, 0x00020000
    s_add_u32 s5, s68, 2
    s_cmp_ge_u32 s5, 7
    s_cselect_b32 s4, 7, 0
    s_sub_u32 s5, s5, s4
    s_lshl_b32 s72, s5, 7
    s_add_u32 s72, s72, s6
    s_mul_i32 s79, s5, 229376
    s_add_u32 s79, s79, s7
    s_add_u32 s5, s68, 3
    s_cmp_ge_u32 s5, 7
    s_cselect_b32 s4, 7, 0
    s_sub_u32 s5, s5, s4
    s_lshl_b32 s73, s5, 7
    s_add_u32 s73, s73, s6
    s_mul_i32 s80, s5, 229376
    s_add_u32 s80, s80, s7
    s_add_u32 s5, s68, 4
    s_cmp_ge_u32 s5, 7
    s_cselect_b32 s4, 7, 0
    s_sub_u32 s5, s5, s4
    s_lshl_b32 s74, s5, 7
    s_add_u32 s74, s74, s6
    s_mul_i32 s81, s5, 229376
    s_add_u32 s81, s81, s7
    s_add_u32 s5, s68, 5
    s_cmp_ge_u32 s5, 7
    s_cselect_b32 s4, 7, 0
    s_sub_u32 s5, s5, s4
    s_lshl_b32 s75, s5, 7
    s_add_u32 s75, s75, s6
    s_mul_i32 s82, s5, 229376
    s_add_u32 s82, s82, s7
    s_add_u32 s5, s68, 6
    s_cmp_ge_u32 s5, 7
    s_cselect_b32 s4, 7, 0
    s_sub_u32 s5, s5, s4
    s_lshl_b32 s76, s5, 7
    s_add_u32 s76, s76, s6
    s_mul_i32 s83, s5, 229376
    s_add_u32 s83, s83, s7
    s_lshl_b32 s5, s64, 1
    s_add_u32 s5, s5, s10
    s_mul_i32 s5, s5, 56
    s_lshr_b32 s6, s7, 6
    s_add_u32 s6, s6, s5
    s_add_u32 s6, s6, s11
    s_lshl_b32 s6, s6, 12
    s_lshl_b32 s4, s11, 11
    s_add_u32 s13, s6, s4
    s_lshr_b32 s6, s65, 1
    s_mul_i32 s6, s6, 14
    s_add_u32 s6, s6, s67
    s_add_u32 s6, s6, 12
    s_add_u32 s6, s6, s5
    s_lshl_b32 s6, s6, 12
    s_add_u32 s66, s6, s4
    s_lshl_b32 s5, s64, 5
    s_add_u32 s5, s5, s65
    s_lshl_b32 s5, s5, 7
    s_add_u32 s12, s5, 11057152
    s_mul_i32 s9, s67, 384
    s_sub_u32 s9, 512, s9
    v_and_b32 v8, 15, v2
    v_lshrrev_b32 v9, 4, v2
    v_bfe_u32 v10, v2, 2, 2
    v_and_b32 v11, 3, v2
    v_lshrrev_b32 v12, 3, v8
    v_lshlrev_b32 v12, 10, v12
    v_and_b32 v13, 7, v8
    v_lshl_add_u32 v12, v13, 7, v12
    v_lshrrev_b32 v13, 1, v8
    v_xor_b32 v13, v13, v9
    v_lshl_add_u32 v12, v13, 4, v12
    v_add_u32 v200, s14, v12
    v_xor_b32 v201, 64, v200
    v_xor_b32 v202, 0x1000, v200
    v_xor_b32 v203, 0x1000, v201
    s_lshl_b32 s5, s67, 13
    s_lshl_b32 s6, s3, 11
    s_add_u32 s5, s5, s6
    v_add_u32 v228, s5, v12
    v_xor_b32 v229, 64, v228
    v_and_b32 v12, 1, v9
    v_lshlrev_b32 v13, 13, v12
    v_lshrrev_b32 v14, 1, v9
    v_lshl_add_u32 v13, v14, 10, v13
    v_lshl_add_u32 v13, v10, 7, v13
    v_lshl_add_u32 v13, v11, 3, v13
    v_lshrrev_b32 v14, 1, v10
    v_lshl_add_u32 v14, v12, 1, v14
    s_lshl_b32 s5, s11, 1
    v_xor_b32 v14, s5, v14
    v_lshl_add_u32 v13, v14, 5, v13
    s_lshl_b32 s5, s10, 12
    s_add_u32 s5, s5, 49152
    v_add_u32 v192, s5, v13
    v_xor_b32 v193, 32, v192
    v_xor_b32 v194, 0x1000, v192
    v_xor_b32 v195, 0x1000, v193
    v_add_u32 v196, 65536, v192
    v_add_u32 v197, 65536, v193
    v_add_u32 v198, 65536, v194
    v_add_u32 v199, 65536, v195
    s_xor_b32 s5, s11, s67
    s_lshl_b32 s5, s5, 6
    v_xor_b32 v232, s5, v192
    v_xor_b32 v233, s5, v193
    v_xor_b32 v234, s5, v194
    v_xor_b32 v235, s5, v195
    v_xor_b32 v236, s5, v196
    v_xor_b32 v237, s5, v197
    v_xor_b32 v238, s5, v198
    v_xor_b32 v239, s5, v199
    v_mov_b32 v212, 0x3f803f80
    v_mov_b32 v213, 0x3f803f80
    v_mov_b32 v214, 0x3f803f80
    v_mov_b32 v215, 0x3f803f80
    s_add_u32 m0, s14, 65536
    s_nop 0
    buffer_load_dwordx4 v208, s[48:51], s78 offen offset:0 lds
    buffer_load_dwordx4 v209, s[48:51], s78 offen offset:1024 lds
    buffer_load_dwordx4 v210, s[48:51], s78 offen offset:2048 lds
    buffer_load_dwordx4 v211, s[48:51], s78 offen offset:3072 lds
    s_mov_b32 s52, s40
    s_mov_b32 s53, s41
    s_mov_b32 s54, 11141120
    s_mov_b32 s55, 0x00020000
    s_lshl_b32 s5, s3, 7
    s_add_u32 s6, s5, 36864
    v_lshl_add_u32 v164, v9, 4, s6
    s_add_u32 s6, s5, 40960
    v_lshl_add_u32 v165, v8, 2, s6
    s_lshl_b32 s6, s64, 9
    s_add_u32 s16, s6, s5
    s_add_u32 s16, s16, 11010048
    s_cmp_eq_u32 s65, 0
    s_cselect_b32 s5, 0, 0x40000000
    s_add_u32 s16, s16, s5
    s_lshl_b32 s5, s67, 8
    s_add_u32 s6, s6, s5
    s_lshl_b32 s5, s3, 6
    s_add_u32 s6, s6, s5
    s_add_u32 s17, s6, 11018240
    s_cmp_lt_u32 s65, 2
    s_cselect_b32 s5, 0, 0x40000000
    s_add_u32 s17, s17, s5
    v_cmp_eq_u32 vcc, v10, v9
    v_lshlrev_b32 v12, 2, v8
    v_bfrev_b32 v13, 1
    v_cndmask_b32 v166, v13, v12, vcc
    v_cmp_gt_u32 vcc, 16, v2
    v_cmp_eq_u32 s[18:19], 1, v11
    v_cmp_eq_u32 s[20:21], 2, v11
    v_cndmask_b32 v167, v13, v12, vcc
    v_cmp_eq_u32 s[22:23], 3, v11
    s_lshl_b32 s5, s11, 7
    v_lshl_add_u32 v230, v9, 4, s5
    s_lshl_b32 s5, s67, 7
    v_lshl_add_u32 v231, v9, 4, s5
    s_lshl_b32 s5, s65, 1
    s_lshl_b32 s24, s5, 7
    s_add_u32 s24, s24, 11137024
    s_add_u32 s5, s5, s10
    s_lshl_b32 s5, s5, 10
    s_add_u32 s25, s5, 11026432
    s_xor_b32 s5, s5, 1024
    s_add_u32 s26, s5, 11026432
    v_and_b32 v1, 1, v2
    v_lshlrev_b32 v1, 7, v1
    v_mov_b32 v5, 0
    s_add_u32 m0, s14, 16384
    s_nop 0
    buffer_load_dwordx4 v204, s[44:47], s71 offen offset:0 lds
    buffer_load_dwordx4 v205, s[44:47], s71 offen offset:1024 lds
    buffer_load_dwordx4 v206, s[44:47], s71 offen offset:2048 lds
    buffer_load_dwordx4 v207, s[44:47], s71 offen offset:3072 lds
    s_waitcnt vmcnt(8)
    s_barrier
    ds_read_b128 a[0:3], v200 offset:0
    ds_read_b128 a[4:7], v200 offset:2048
    ds_read_b128 a[8:11], v202 offset:0
    ds_read_b128 a[12:15], v202 offset:2048
    ds_read_b64_tr_b16 a[224:225], v192 offset:0
    ds_read_b64_tr_b16 a[226:227], v192 offset:512
    ds_read_b64_tr_b16 a[228:229], v193 offset:0
    ds_read_b64_tr_b16 a[230:231], v193 offset:512
    ds_read_b64_tr_b16 a[232:233], v194 offset:0
    ds_read_b64_tr_b16 a[234:235], v194 offset:512
    ds_read_b64_tr_b16 a[236:237], v195 offset:0
    ds_read_b64_tr_b16 a[238:239], v195 offset:512
    s_waitcnt lgkmcnt(4)
    v_mfma_f32_16x16x32_bf16 v[16:19], a[224:227], a[0:3], 0
    ds_read_b64_tr_b16 a[240:241], v192 offset:2048
    v_mfma_f32_16x16x32_bf16 v[20:23], a[224:227], a[4:7], 0
    ds_read_b64_tr_b16 a[242:243], v192 offset:2560
    v_mfma_f32_16x16x32_bf16 v[24:27], a[224:227], a[8:11], 0
    ds_read_b128 a[16:19], v201 offset:0
    s_add_u32 m0, s14, 32768
    s_nop 0
    buffer_load_dwordx4 v204, s[44:47], s72 offen offset:0 lds
    v_mfma_f32_16x16x32_bf16 v[28:31], a[224:227], a[12:15], 0
    ds_read_b128 a[20:23], v201 offset:2048
    v_mfma_f32_16x16x32_bf16 v[168:171], a[224:227], v[212:215], 0
    v_mfma_f32_16x16x32_bf16 v[44:47], a[228:231], a[12:15], 0
    ds_read_b128 a[24:27], v203 offset:0
    v_mfma_f32_16x16x32_bf16 v[40:43], a[228:231], a[8:11], 0
    ds_read_b128 a[28:31], v203 offset:2048
    v_mfma_f32_16x16x32_bf16 v[216:219], v[212:215], a[0:3], 0
    buffer_load_dwordx4 v205, s[44:47], s72 offen offset:1024 lds
    v_mfma_f32_16x16x32_bf16 v[36:39], a[228:231], a[4:7], 0
    ds_read_b128 v[144:147], v228 offset:0
    v_mfma_f32_16x16x32_bf16 v[32:35], a[228:231], a[0:3], 0
    ds_read_b128 v[148:151], v229 offset:0
    v_mfma_f32_16x16x32_bf16 v[172:175], a[228:231], v[212:215], 0
    s_waitcnt lgkmcnt(8)
    v_mfma_f32_16x16x32_bf16 v[48:51], a[232:235], a[0:3], 0
    ds_read_b64_tr_b16 a[244:245], v193 offset:2048
    buffer_load_dwordx4 v206, s[44:47], s72 offen offset:2048 lds
    v_mfma_f32_16x16x32_bf16 v[52:55], a[232:235], a[4:7], 0
    ds_read_b64_tr_b16 a[246:247], v193 offset:2560
    v_mfma_f32_16x16x32_bf16 v[56:59], a[232:235], a[8:11], 0
    ds_read_b64_tr_b16 a[248:249], v194 offset:2048
    v_mfma_f32_16x16x32_bf16 v[60:63], a[232:235], a[12:15], 0
    ds_read_b64_tr_b16 a[250:251], v194 offset:2560
    v_mfma_f32_16x16x32_bf16 v[220:223], v[212:215], a[4:7], 0
    buffer_load_dwordx4 v207, s[44:47], s72 offen offset:3072 lds
    v_mfma_f32_16x16x32_bf16 v[76:79], a[236:239], a[12:15], 0
    ds_read_b64_tr_b16 a[252:253], v195 offset:2048
    v_mfma_f32_16x16x32_bf16 v[72:75], a[236:239], a[8:11], 0
    ds_read_b64_tr_b16 a[254:255], v195 offset:2560
    v_mfma_f32_16x16x32_bf16 v[68:71], a[236:239], a[4:7], 0
    s_add_u32 m0, s14, 81920
    s_nop 0
    buffer_load_dwordx4 v208, s[48:51], s79 offen offset:0 lds
    v_mfma_f32_16x16x32_bf16 v[64:67], a[236:239], a[0:3], 0
    s_waitcnt vmcnt(5) lgkmcnt(6)
    s_barrier
    s_waitcnt lgkmcnt(4)
    v_mfma_f32_16x16x32_bf16 v[16:19], a[240:243], a[16:19], v[16:19]
    ds_read_b64_tr_b16 a[224:225], v192 offset:16384
    v_mfma_f32_16x16x32_bf16 v[20:23], a[240:243], a[20:23], v[20:23]
    ds_read_b64_tr_b16 a[226:227], v192 offset:16896
    v_mfma_f32_16x16x32_bf16 v[224:227], v[144:147], v[144:147], 0
    v_mfma_f32_16x16x32_bf16 v[24:27], a[240:243], a[24:27], v[24:27]
    ds_read_b128 a[32:35], v200 offset:16384
    buffer_load_dwordx4 v209, s[48:51], s79 offen offset:1024 lds
    v_mfma_f32_16x16x32_bf16 v[28:31], a[240:243], a[28:31], v[28:31]
    ds_read_b128 a[36:39], v200 offset:18432
    v_mfma_f32_16x16x32_bf16 v[168:171], a[240:243], v[212:215], v[168:171]
    v_mfma_f32_16x16x32_bf16 v[44:47], a[244:247], a[28:31], v[44:47]
    ds_read_b128 a[40:43], v202 offset:16384
    v_mfma_f32_16x16x32_bf16 v[40:43], a[244:247], a[24:27], v[40:43]
    ds_read_b128 a[44:47], v202 offset:18432
    v_mfma_f32_16x16x32_bf16 v[216:219], v[212:215], a[16:19], v[216:219]
    buffer_load_dwordx4 v210, s[48:51], s79 offen offset:2048 lds
    v_mfma_f32_16x16x32_bf16 v[36:39], a[244:247], a[20:23], v[36:39]
    ds_read_b64_tr_b16 a[228:229], v193 offset:16384
    v_mfma_f32_16x16x32_bf16 v[32:35], a[244:247], a[16:19], v[32:35]
    ds_read_b64_tr_b16 a[230:231], v193 offset:16896
    v_mfma_f32_16x16x32_bf16 v[172:175], a[244:247], v[212:215], v[172:175]
    s_waitcnt lgkmcnt(8)
    v_mfma_f32_16x16x32_bf16 v[48:51], a[248:251], a[16:19], v[48:51]
    ds_read_b64_tr_b16 a[232:233], v194 offset:16384
    buffer_load_dwordx4 v211, s[48:51], s79 offen offset:3072 lds
    v_mfma_f32_16x16x32_bf16 v[52:55], a[248:251], a[20:23], v[52:55]
    ds_read_b64_tr_b16 a[234:235], v194 offset:16896
    v_mfma_f32_16x16x32_bf16 v[224:227], v[148:151], v[148:151], v[224:227]
    v_mfma_f32_16x16x32_bf16 v[56:59], a[248:251], a[24:27], v[56:59]
    ds_read_b64_tr_b16 a[236:237], v195 offset:16384
    v_mfma_f32_16x16x32_bf16 v[60:63], a[248:251], a[28:31], v[60:63]
    ds_read_b64_tr_b16 a[238:239], v195 offset:16896
    v_mfma_f32_16x16x32_bf16 v[220:223], v[212:215], a[20:23], v[220:223]
    s_add_u32 m0, s14, 98304
    s_nop 0
    buffer_load_dwordx4 v208, s[48:51], s80 offen offset:0 lds
    v_mfma_f32_16x16x32_bf16 v[76:79], a[252:255], a[28:31], v[76:79]
    v_mfma_f32_16x16x32_bf16 v[72:75], a[252:255], a[24:27], v[72:75]
    v_mfma_f32_16x16x32_bf16 v[68:71], a[252:255], a[20:23], v[68:71]
    buffer_load_dwordx4 v209, s[48:51], s80 offen offset:1024 lds
    v_mfma_f32_16x16x32_bf16 v[64:67], a[252:255], a[16:19], v[64:67]
    s_waitcnt lgkmcnt(4)
    v_mfma_f32_16x16x32_bf16 v[16:19], a[224:227], a[32:35], v[16:19]
    ds_read_b64_tr_b16 a[240:241], v192 offset:18432
    v_mfma_f32_16x16x32_bf16 v[20:23], a[224:227], a[36:39], v[20:23]
    ds_read_b64_tr_b16 a[242:243], v192 offset:18944
    v_mfma_f32_16x16x32_bf16 v[24:27], a[224:227], a[40:43], v[24:27]
    ds_read_b128 a[48:51], v201 offset:16384
    buffer_load_dwordx4 v210, s[48:51], s80 offen offset:2048 lds
    v_mfma_f32_16x16x32_bf16 v[28:31], a[224:227], a[44:47], v[28:31]
    ds_read_b128 a[52:55], v201 offset:18432
    v_mfma_f32_16x16x32_bf16 v[168:171], a[224:227], v[212:215], v[168:171]
    v_mfma_f32_16x16x32_bf16 v[44:47], a[228:231], a[44:47], v[44:47]
    ds_read_b128 a[56:59], v203 offset:16384
    v_mfma_f32_16x16x32_bf16 v[40:43], a[228:231], a[40:43], v[40:43]
    ds_read_b128 a[60:63], v203 offset:18432
    v_mfma_f32_16x16x32_bf16 v[216:219], v[212:215], a[32:35], v[216:219]
    buffer_load_dwordx4 v211, s[48:51], s80 offen offset:3072 lds
    v_mfma_f32_16x16x32_bf16 v[36:39], a[228:231], a[36:39], v[36:39]
    ds_read_b128 v[144:147], v228 offset:16384
    v_mfma_f32_16x16x32_bf16 v[32:35], a[228:231], a[32:35], v[32:35]
    ds_read_b128 v[148:151], v229 offset:16384
    v_mfma_f32_16x16x32_bf16 v[172:175], a[228:231], v[212:215], v[172:175]
    s_waitcnt lgkmcnt(8)
    v_mfma_f32_16x16x32_bf16 v[48:51], a[232:235], a[32:35], v[48:51]
    ds_read_b64_tr_b16 a[244:245], v193 offset:18432
    s_add_u32 m0, s14, 0
    s_nop 0
    buffer_load_dwordx4 v204, s[44:47], s73 offen offset:0 lds
    v_mfma_f32_16x16x32_bf16 v[52:55], a[232:235], a[36:39], v[52:55]
    ds_read_b64_tr_b16 a[246:247], v193 offset:18944
    v_mfma_f32_16x16x32_bf16 v[56:59], a[232:235], a[40:43], v[56:59]
    ds_read_b64_tr_b16 a[248:249], v194 offset:18432
    v_mfma_f32_16x16x32_bf16 v[60:63], a[232:235], a[44:47], v[60:63]
    ds_read_b64_tr_b16 a[250:251], v194 offset:18944
    v_mfma_f32_16x16x32_bf16 v[220:223], v[212:215], a[36:39], v[220:223]
    buffer_load_dwordx4 v205, s[44:47], s73 offen offset:1024 lds
    v_mfma_f32_16x16x32_bf16 v[76:79], a[236:239], a[44:47], v[76:79]
    ds_read_b64_tr_b16 a[252:253], v195 offset:18432
    v_mfma_f32_16x16x32_bf16 v[72:75], a[236:239], a[40:43], v[72:75]
    ds_read_b64_tr_b16 a[254:255], v195 offset:18944
    v_mfma_f32_16x16x32_bf16 v[68:71], a[236:239], a[36:39], v[68:71]
    buffer_load_dwordx4 v206, s[44:47], s73 offen offset:2048 lds
    v_mfma_f32_16x16x32_bf16 v[64:67], a[236:239], a[32:35], v[64:67]
    s_waitcnt vmcnt(7) lgkmcnt(6)
    s_barrier
    s_waitcnt lgkmcnt(4)
    v_mfma_f32_16x16x32_bf16 v[16:19], a[240:243], a[48:51], v[16:19]
    ds_read_b64_tr_b16 a[224:225], v192 offset:32768
    v_mfma_f32_16x16x32_bf16 v[20:23], a[240:243], a[52:55], v[20:23]
    ds_read_b64_tr_b16 a[226:227], v192 offset:33280
    v_mfma_f32_16x16x32_bf16 v[224:227], v[144:147], v[144:147], v[224:227]
    v_mfma_f32_16x16x32_bf16 v[24:27], a[240:243], a[56:59], v[24:27]
    ds_read_b128 a[64:67], v200 offset:32768
    buffer_load_dwordx4 v207, s[44:47], s73 offen offset:3072 lds
    v_mfma_f32_16x16x32_bf16 v[28:31], a[240:243], a[60:63], v[28:31]
    ds_read_b128 a[68:71], v200 offset:34816
    v_mfma_f32_16x16x32_bf16 v[168:171], a[240:243], v[212:215], v[168:171]
    v_mfma_f32_16x16x32_bf16 v[44:47], a[244:247], a[60:63], v[44:47]
    ds_read_b128 a[72:75], v202 offset:32768
    v_mfma_f32_16x16x32_bf16 v[40:43], a[244:247], a[56:59], v[40:43]
    ds_read_b128 a[76:79], v202 offset:34816
    v_mfma_f32_16x16x32_bf16 v[216:219], v[212:215], a[48:51], v[216:219]
    s_add_u32 m0, s14, 114688
    s_nop 0
    buffer_load_dwordx4 v208, s[48:51], s81 offen offset:0 lds
    v_mfma_f32_16x16x32_bf16 v[36:39], a[244:247], a[52:55], v[36:39]
    ds_read_b64_tr_b16 a[228:229], v193 offset:32768
    v_mfma_f32_16x16x32_bf16 v[32:35], a[244:247], a[48:51], v[32:35]
    ds_read_b64_tr_b16 a[230:231], v193 offset:33280
    v_mfma_f32_16x16x32_bf16 v[172:175], a[244:247], v[212:215], v[172:175]
    s_waitcnt lgkmcnt(8)
    v_mfma_f32_16x16x32_bf16 v[48:51], a[248:251], a[48:51], v[48:51]
    ds_read_b64_tr_b16 a[232:233], v194 offset:32768
    buffer_load_dwordx4 v209, s[48:51], s81 offen offset:1024 lds
    v_mfma_f32_16x16x32_bf16 v[52:55], a[248:251], a[52:55], v[52:55]
    ds_read_b64_tr_b16 a[234:235], v194 offset:33280
    v_mfma_f32_16x16x32_bf16 v[224:227], v[148:151], v[148:151], v[224:227]
    v_mfma_f32_16x16x32_bf16 v[56:59], a[248:251], a[56:59], v[56:59]
    ds_read_b64_tr_b16 a[236:237], v195 offset:32768
    v_mfma_f32_16x16x32_bf16 v[60:63], a[248:251], a[60:63], v[60:63]
    ds_read_b64_tr_b16 a[238:239], v195 offset:33280
    v_mfma_f32_16x16x32_bf16 v[220:223], v[212:215], a[52:55], v[220:223]
    buffer_load_dwordx4 v210, s[48:51], s81 offen offset:2048 lds
    v_mfma_f32_16x16x32_bf16 v[76:79], a[252:255], a[60:63], v[76:79]
    v_mfma_f32_16x16x32_bf16 v[72:75], a[252:255], a[56:59], v[72:75]
    v_mfma_f32_16x16x32_bf16 v[68:71], a[252:255], a[52:55], v[68:71]
    buffer_load_dwordx4 v211, s[48:51], s81 offen offset:3072 lds
    v_mfma_f32_16x16x32_bf16 v[64:67], a[252:255], a[48:51], v[64:67]
    s_waitcnt lgkmcnt(4)
    v_mfma_f32_16x16x32_bf16 v[16:19], a[224:227], a[64:67], v[16:19]
    ds_read_b64_tr_b16 a[240:241], v192 offset:34816
    v_mfma_f32_16x16x32_bf16 v[20:23], a[224:227], a[68:71], v[20:23]
    ds_read_b64_tr_b16 a[242:243], v192 offset:35328
    v_mfma_f32_16x16x32_bf16 v[24:27], a[224:227], a[72:75], v[24:27]
    ds_read_b128 a[80:83], v201 offset:32768
    s_add_u32 m0, s14, 16384
    s_nop 0
    buffer_load_dwordx4 v204, s[44:47], s74 offen offset:0 lds
    v_mfma_f32_16x16x32_bf16 v[28:31], a[224:227], a[76:79], v[28:31]
    ds_read_b128 a[84:87], v201 offset:34816
    v_mfma_f32_16x16x32_bf16 v[168:171], a[224:227], v[212:215], v[168:171]
    v_mfma_f32_16x16x32_bf16 v[44:47], a[228:231], a[76:79], v[44:47]
    ds_read_b128 a[88:91], v203 offset:32768
    v_mfma_f32_16x16x32_bf16 v[40:43], a[228:231], a[72:75], v[40:43]
    ds_read_b128 a[92:95], v203 offset:34816
    v_mfma_f32_16x16x32_bf16 v[216:219], v[212:215], a[64:67], v[216:219]
    buffer_load_dwordx4 v205, s[44:47], s74 offen offset:1024 lds
    v_mfma_f32_16x16x32_bf16 v[36:39], a[228:231], a[68:71], v[36:39]
    ds_read_b128 v[144:147], v228 offset:32768
    v_mfma_f32_16x16x32_bf16 v[32:35], a[228:231], a[64:67], v[32:35]
    ds_read_b128 v[148:151], v229 offset:32768
    v_mfma_f32_16x16x32_bf16 v[172:175], a[228:231], v[212:215], v[172:175]
    s_waitcnt lgkmcnt(8)
    v_mfma_f32_16x16x32_bf16 v[48:51], a[232:235], a[64:67], v[48:51]
    ds_read_b64_tr_b16 a[244:245], v193 offset:34816
    buffer_load_dwordx4 v206, s[44:47], s74 offen offset:2048 lds
    v_mfma_f32_16x16x32_bf16 v[52:55], a[232:235], a[68:71], v[52:55]
    ds_read_b64_tr_b16 a[246:247], v193 offset:35328
    v_mfma_f32_16x16x32_bf16 v[56:59], a[232:235], a[72:75], v[56:59]
    ds_read_b64_tr_b16 a[248:249], v194 offset:34816
    v_mfma_f32_16x16x32_bf16 v[60:63], a[232:235], a[76:79], v[60:63]
    ds_read_b64_tr_b16 a[250:251], v194 offset:35328
    v_mfma_f32_16x16x32_bf16 v[220:223], v[212:215], a[68:71], v[220:223]
    buffer_load_dwordx4 v207, s[44:47], s74 offen offset:3072 lds
    v_mfma_f32_16x16x32_bf16 v[76:79], a[236:239], a[76:79], v[76:79]
    ds_read_b64_tr_b16 a[252:253], v195 offset:34816
    v_mfma_f32_16x16x32_bf16 v[72:75], a[236:239], a[72:75], v[72:75]
    ds_read_b64_tr_b16 a[254:255], v195 offset:35328
    v_mfma_f32_16x16x32_bf16 v[68:71], a[236:239], a[68:71], v[68:71]
    s_add_u32 m0, s14, 131072
    s_nop 0
    buffer_load_dwordx4 v208, s[48:51], s82 offen offset:0 lds
    v_mfma_f32_16x16x32_bf16 v[64:67], a[236:239], a[64:67], v[64:67]
    s_waitcnt vmcnt(9) lgkmcnt(6)
    s_barrier
    s_waitcnt lgkmcnt(4)
    v_mfma_f32_16x16x32_bf16 v[16:19], a[240:243], a[80:83], v[16:19]
    ds_read_b64_tr_b16 a[224:225], v192 offset:49152
    v_mfma_f32_16x16x32_bf16 v[20:23], a[240:243], a[84:87], v[20:23]
    ds_read_b64_tr_b16 a[226:227], v192 offset:49664
    v_mfma_f32_16x16x32_bf16 v[224:227], v[144:147], v[144:147], v[224:227]
    v_mfma_f32_16x16x32_bf16 v[24:27], a[240:243], a[88:91], v[24:27]
    ds_read_b128 a[96:99], v200 offset:0
    buffer_load_dwordx4 v209, s[48:51], s82 offen offset:1024 lds
    v_mfma_f32_16x16x32_bf16 v[28:31], a[240:243], a[92:95], v[28:31]
    ds_read_b128 a[100:103], v200 offset:2048
    v_mfma_f32_16x16x32_bf16 v[168:171], a[240:243], v[212:215], v[168:171]
    v_mfma_f32_16x16x32_bf16 v[44:47], a[244:247], a[92:95], v[44:47]
    ds_read_b128 a[104:107], v202 offset:0
    v_mfma_f32_16x16x32_bf16 v[40:43], a[244:247], a[88:91], v[40:43]
    ds_read_b128 a[108:111], v202 offset:2048
    v_mfma_f32_16x16x32_bf16 v[216:219], v[212:215], a[80:83], v[216:219]
    buffer_load_dwordx4 v210, s[48:51], s82 offen offset:2048 lds
    v_mfma_f32_16x16x32_bf16 v[36:39], a[244:247], a[84:87], v[36:39]
    ds_read_b64_tr_b16 a[228:229], v193 offset:49152
    v_mfma_f32_16x16x32_bf16 v[32:35], a[244:247], a[80:83], v[32:35]
    ds_read_b64_tr_b16 a[230:231], v193 offset:49664
    v_mfma_f32_16x16x32_bf16 v[172:175], a[244:247], v[212:215], v[172:175]
    s_waitcnt lgkmcnt(8)
    v_mfma_f32_16x16x32_bf16 v[48:51], a[248:251], a[80:83], v[48:51]
    ds_read_b64_tr_b16 a[232:233], v194 offset:49152
    buffer_load_dwordx4 v211, s[48:51], s82 offen offset:3072 lds
    v_mfma_f32_16x16x32_bf16 v[52:55], a[248:251], a[84:87], v[52:55]
    ds_read_b64_tr_b16 a[234:235], v194 offset:49664
    v_mfma_f32_16x16x32_bf16 v[224:227], v[148:151], v[148:151], v[224:227]
    v_mfma_f32_16x16x32_bf16 v[56:59], a[248:251], a[88:91], v[56:59]
    ds_read_b64_tr_b16 a[236:237], v195 offset:49152
    v_mfma_f32_16x16x32_bf16 v[60:63], a[248:251], a[92:95], v[60:63]
    ds_read_b64_tr_b16 a[238:239], v195 offset:49664
    v_mfma_f32_16x16x32_bf16 v[220:223], v[212:215], a[84:87], v[220:223]
    s_add_u32 m0, s14, 32768
    s_nop 0
    buffer_load_dwordx4 v204, s[44:47], s75 offen offset:0 lds
    v_mfma_f32_16x16x32_bf16 v[76:79], a[252:255], a[92:95], v[76:79]
    v_mfma_f32_16x16x32_bf16 v[72:75], a[252:255], a[88:91], v[72:75]
    v_mfma_f32_16x16x32_bf16 v[68:71], a[252:255], a[84:87], v[68:71]
    buffer_load_dwordx4 v205, s[44:47], s75 offen offset:1024 lds
    v_mfma_f32_16x16x32_bf16 v[64:67], a[252:255], a[80:83], v[64:67]
    s_waitcnt lgkmcnt(4)
    v_mfma_f32_16x16x32_bf16 v[16:19], a[224:227], a[96:99], v[16:19]
    ds_read_b64_tr_b16 a[240:241], v192 offset:51200
    v_mfma_f32_16x16x32_bf16 v[20:23], a[224:227], a[100:103], v[20:23]
    ds_read_b64_tr_b16 a[242:243], v192 offset:51712
    v_mfma_f32_16x16x32_bf16 v[24:27], a[224:227], a[104:107], v[24:27]
    ds_read_b128 a[112:115], v201 offset:0
    buffer_load_dwordx4 v206, s[44:47], s75 offen offset:2048 lds
    v_mfma_f32_16x16x32_bf16 v[28:31], a[224:227], a[108:111], v[28:31]
    ds_read_b128 a[116:119], v201 offset:2048
    v_mfma_f32_16x16x32_bf16 v[168:171], a[224:227], v[212:215], v[168:171]
    v_mfma_f32_16x16x32_bf16 v[44:47], a[228:231], a[108:111], v[44:47]
    ds_read_b128 a[120:123], v203 offset:0
    v_mfma_f32_16x16x32_bf16 v[40:43], a[228:231], a[104:107], v[40:43]
    ds_read_b128 a[124:127], v203 offset:2048
    v_mfma_f32_16x16x32_bf16 v[216:219], v[212:215], a[96:99], v[216:219]
    buffer_load_dwordx4 v207, s[44:47], s75 offen offset:3072 lds
    v_mfma_f32_16x16x32_bf16 v[36:39], a[228:231], a[100:103], v[36:39]
    ds_read_b128 v[144:147], v228 offset:0
    v_mfma_f32_16x16x32_bf16 v[32:35], a[228:231], a[96:99], v[32:35]
    ds_read_b128 v[148:151], v229 offset:0
    v_mfma_f32_16x16x32_bf16 v[172:175], a[228:231], v[212:215], v[172:175]
    s_waitcnt lgkmcnt(8)
    v_mfma_f32_16x16x32_bf16 v[48:51], a[232:235], a[96:99], v[48:51]
    ds_read_b64_tr_b16 a[244:245], v193 offset:51200
    s_add_u32 m0, s14, 147456
    s_nop 0
    buffer_load_dwordx4 v208, s[48:51], s83 offen offset:0 lds
    v_mfma_f32_16x16x32_bf16 v[52:55], a[232:235], a[100:103], v[52:55]
    ds_read_b64_tr_b16 a[246:247], v193 offset:51712
    v_mfma_f32_16x16x32_bf16 v[56:59], a[232:235], a[104:107], v[56:59]
    ds_read_b64_tr_b16 a[248:249], v194 offset:51200
    v_mfma_f32_16x16x32_bf16 v[60:63], a[232:235], a[108:111], v[60:63]
    ds_read_b64_tr_b16 a[250:251], v194 offset:51712
    v_mfma_f32_16x16x32_bf16 v[220:223], v[212:215], a[100:103], v[220:223]
    buffer_load_dwordx4 v209, s[48:51], s83 offen offset:1024 lds
    v_mfma_f32_16x16x32_bf16 v[76:79], a[236:239], a[108:111], v[76:79]
    ds_read_b64_tr_b16 a[252:253], v195 offset:51200
    v_mfma_f32_16x16x32_bf16 v[72:75], a[236:239], a[104:107], v[72:75]
    ds_read_b64_tr_b16 a[254:255], v195 offset:51712
    v_mfma_f32_16x16x32_bf16 v[68:71], a[236:239], a[100:103], v[68:71]
    buffer_load_dwordx4 v210, s[48:51], s83 offen offset:2048 lds
    v_mfma_f32_16x16x32_bf16 v[64:67], a[236:239], a[96:99], v[64:67]
    s_waitcnt vmcnt(11) lgkmcnt(6)
    s_barrier
    s_waitcnt lgkmcnt(4)
    v_mfma_f32_16x16x32_bf16 v[16:19], a[240:243], a[112:115], v[16:19]
    ds_read_b64_tr_b16 a[224:225], v196 offset:0
    v_mfma_f32_16x16x32_bf16 v[20:23], a[240:243], a[116:119], v[20:23]
    ds_read_b64_tr_b16 a[226:227], v196 offset:512
    v_mfma_f32_16x16x32_bf16 v[224:227], v[144:147], v[144:147], v[224:227]
    v_mfma_f32_16x16x32_bf16 v[24:27], a[240:243], a[120:123], v[24:27]
    ds_read_b128 a[128:131], v200 offset:16384
    buffer_load_dwordx4 v211, s[48:51], s83 offen offset:3072 lds
    v_mfma_f32_16x16x32_bf16 v[28:31], a[240:243], a[124:127], v[28:31]
    ds_read_b128 a[132:135], v200 offset:18432
    v_mfma_f32_16x16x32_bf16 v[168:171], a[240:243], v[212:215], v[168:171]
    v_mfma_f32_16x16x32_bf16 v[44:47], a[244:247], a[124:127], v[44:47]
    ds_read_b128 a[136:139], v202 offset:16384
    v_mfma_f32_16x16x32_bf16 v[40:43], a[244:247], a[120:123], v[40:43]
    ds_read_b128 a[140:143], v202 offset:18432
    v_mfma_f32_16x16x32_bf16 v[216:219], v[212:215], a[112:115], v[216:219]
    s_add_u32 m0, s14, 0
    s_nop 0
    buffer_load_dwordx4 v204, s[44:47], s76 offen offset:0 lds
    v_mfma_f32_16x16x32_bf16 v[36:39], a[244:247], a[116:119], v[36:39]
    ds_read_b64_tr_b16 a[228:229], v197 offset:0
    v_mfma_f32_16x16x32_bf16 v[32:35], a[244:247], a[112:115], v[32:35]
    ds_read_b64_tr_b16 a[230:231], v197 offset:512
    v_mfma_f32_16x16x32_bf16 v[172:175], a[244:247], v[212:215], v[172:175]
    s_waitcnt lgkmcnt(8)
    v_mfma_f32_16x16x32_bf16 v[48:51], a[248:251], a[112:115], v[48:51]
    ds_read_b64_tr_b16 a[232:233], v198 offset:0
    buffer_load_dwordx4 v205, s[44:47], s76 offen offset:1024 lds
    v_mfma_f32_16x16x32_bf16 v[52:55], a[248:251], a[116:119], v[52:55]
    ds_read_b64_tr_b16 a[234:235], v198 offset:512
    v_mfma_f32_16x16x32_bf16 v[224:227], v[148:151], v[148:151], v[224:227]
    v_mfma_f32_16x16x32_bf16 v[56:59], a[248:251], a[120:123], v[56:59]
    ds_read_b64_tr_b16 a[236:237], v199 offset:0
    v_mfma_f32_16x16x32_bf16 v[60:63], a[248:251], a[124:127], v[60:63]
    ds_read_b64_tr_b16 a[238:239], v199 offset:512
    v_mfma_f32_16x16x32_bf16 v[220:223], v[212:215], a[116:119], v[220:223]
    buffer_load_dwordx4 v206, s[44:47], s76 offen offset:2048 lds
    v_mfma_f32_16x16x32_bf16 v[76:79], a[252:255], a[124:127], v[76:79]
    v_mfma_f32_16x16x32_bf16 v[72:75], a[252:255], a[120:123], v[72:75]
    v_mfma_f32_16x16x32_bf16 v[68:71], a[252:255], a[116:119], v[68:71]
    buffer_load_dwordx4 v207, s[44:47], s76 offen offset:3072 lds
    v_mfma_f32_16x16x32_bf16 v[64:67], a[252:255], a[112:115], v[64:67]
    s_waitcnt lgkmcnt(4)
    v_mfma_f32_16x16x32_bf16 v[16:19], a[224:227], a[128:131], v[16:19]
    ds_read_b64_tr_b16 a[240:241], v196 offset:2048
    v_mfma_f32_16x16x32_bf16 v[20:23], a[224:227], a[132:135], v[20:23]
    ds_read_b64_tr_b16 a[242:243], v196 offset:2560
    v_mfma_f32_16x16x32_bf16 v[24:27], a[224:227], a[136:139], v[24:27]
    ds_read_b128 a[144:147], v201 offset:16384
    buffer_load_dwordx2 v[6:7], v5, s[60:63], 0 offen sc1
    v_mfma_f32_16x16x32_bf16 v[28:31], a[224:227], a[140:143], v[28:31]
    ds_read_b128 a[148:151], v201 offset:18432
    v_mfma_f32_16x16x32_bf16 v[168:171], a[224:227], v[212:215], v[168:171]
    v_mfma_f32_16x16x32_bf16 v[44:47], a[228:231], a[140:143], v[44:47]
    ds_read_b128 a[152:155], v203 offset:16384
    v_mfma_f32_16x16x32_bf16 v[40:43], a[228:231], a[136:139], v[40:43]
    ds_read_b128 a[156:159], v203 offset:18432
    v_mfma_f32_16x16x32_bf16 v[216:219], v[212:215], a[128:131], v[216:219]
    v_mfma_f32_16x16x32_bf16 v[36:39], a[228:231], a[132:135], v[36:39]
    ds_read_b128 v[144:147], v228 offset:16384
    v_mfma_f32_16x16x32_bf16 v[32:35], a[228:231], a[128:131], v[32:35]
    ds_read_b128 v[148:151], v229 offset:16384
    v_mfma_f32_16x16x32_bf16 v[172:175], a[228:231], v[212:215], v[172:175]
    s_add_u32 m0, s14, 49152
    s_add_u32 s77, s77, 128
    buffer_load_dwordx4 v208, s[48:51], s77 offen offset:0 lds
    s_waitcnt lgkmcnt(8)
    v_mfma_f32_16x16x32_bf16 v[48:51], a[232:235], a[128:131], v[48:51]
    ds_read_b64_tr_b16 a[244:245], v197 offset:2048
    v_mfma_f32_16x16x32_bf16 v[52:55], a[232:235], a[132:135], v[52:55]
    ds_read_b64_tr_b16 a[246:247], v197 offset:2560
    v_mfma_f32_16x16x32_bf16 v[56:59], a[232:235], a[136:139], v[56:59]
    ds_read_b64_tr_b16 a[248:249], v198 offset:2048
    v_mfma_f32_16x16x32_bf16 v[60:63], a[232:235], a[140:143], v[60:63]
    ds_read_b64_tr_b16 a[250:251], v198 offset:2560
    v_mfma_f32_16x16x32_bf16 v[220:223], v[212:215], a[132:135], v[220:223]
    v_mfma_f32_16x16x32_bf16 v[76:79], a[236:239], a[140:143], v[76:79]
    ds_read_b64_tr_b16 a[252:253], v199 offset:2048
    buffer_load_dwordx4 v209, s[48:51], s77 offen offset:1024 lds
    v_mfma_f32_16x16x32_bf16 v[72:75], a[236:239], a[136:139], v[72:75]
    ds_read_b64_tr_b16 a[254:255], v199 offset:2560
    v_mfma_f32_16x16x32_bf16 v[68:71], a[236:239], a[132:135], v[68:71]
    v_mfma_f32_16x16x32_bf16 v[64:67], a[236:239], a[128:131], v[64:67]
    s_waitcnt vmcnt(11) lgkmcnt(6)
    s_barrier
    s_waitcnt lgkmcnt(4)
    v_mfma_f32_16x16x32_bf16 v[16:19], a[240:243], a[144:147], v[16:19]
    ds_read_b64_tr_b16 a[224:225], v196 offset:16384
    v_mfma_f32_16x16x32_bf16 v[20:23], a[240:243], a[148:151], v[20:23]
    ds_read_b64_tr_b16 a[226:227], v196 offset:16896
    v_mfma_f32_16x16x32_bf16 v[224:227], v[144:147], v[144:147], v[224:227]
    v_mfma_f32_16x16x32_bf16 v[24:27], a[240:243], a[152:155], v[24:27]
    ds_read_b128 a[160:163], v200 offset:32768
    buffer_load_dwordx4 v210, s[48:51], s77 offen offset:2048 lds
    v_mfma_f32_16x16x32_bf16 v[28:31], a[240:243], a[156:159], v[28:31]
    ds_read_b128 a[164:167], v200 offset:34816
    v_mfma_f32_16x16x32_bf16 v[168:171], a[240:243], v[212:215], v[168:171]
    v_mfma_f32_16x16x32_bf16 v[44:47], a[244:247], a[156:159], v[44:47]
    ds_read_b128 a[168:171], v202 offset:32768
    v_mfma_f32_16x16x32_bf16 v[40:43], a[244:247], a[152:155], v[40:43]
    ds_read_b128 a[172:175], v202 offset:34816
    v_mfma_f32_16x16x32_bf16 v[216:219], v[212:215], a[144:147], v[216:219]
    v_mfma_f32_16x16x32_bf16 v[36:39], a[244:247], a[148:151], v[36:39]
    ds_read_b64_tr_b16 a[228:229], v197 offset:16384
    v_mfma_f32_16x16x32_bf16 v[32:35], a[244:247], a[144:147], v[32:35]
    ds_read_b64_tr_b16 a[230:231], v197 offset:16896
    v_mfma_f32_16x16x32_bf16 v[172:175], a[244:247], v[212:215], v[172:175]
    buffer_load_dwordx4 v211, s[48:51], s77 offen offset:3072 lds
    s_waitcnt lgkmcnt(8)
    v_mfma_f32_16x16x32_bf16 v[48:51], a[248:251], a[144:147], v[48:51]
    ds_read_b64_tr_b16 a[232:233], v198 offset:16384
    v_mfma_f32_16x16x32_bf16 v[52:55], a[248:251], a[148:151], v[52:55]
    ds_read_b64_tr_b16 a[234:235], v198 offset:16896
    v_mfma_f32_16x16x32_bf16 v[224:227], v[148:151], v[148:151], v[224:227]
    v_mfma_f32_16x16x32_bf16 v[56:59], a[248:251], a[152:155], v[56:59]
    ds_read_b64_tr_b16 a[236:237], v199 offset:16384
    v_mfma_f32_16x16x32_bf16 v[60:63], a[248:251], a[156:159], v[60:63]
    ds_read_b64_tr_b16 a[238:239], v199 offset:16896
    v_mfma_f32_16x16x32_bf16 v[220:223], v[212:215], a[148:151], v[220:223]
    v_mfma_f32_16x16x32_bf16 v[76:79], a[252:255], a[156:159], v[76:79]
    s_add_u32 m0, s14, 65536
    s_add_u32 s78, s78, 128
    buffer_load_dwordx4 v208, s[48:51], s78 offen offset:0 lds
    v_mfma_f32_16x16x32_bf16 v[72:75], a[252:255], a[152:155], v[72:75]
    v_mfma_f32_16x16x32_bf16 v[68:71], a[252:255], a[148:151], v[68:71]
    v_mfma_f32_16x16x32_bf16 v[64:67], a[252:255], a[144:147], v[64:67]
    s_waitcnt lgkmcnt(4)
    v_mfma_f32_16x16x32_bf16 v[16:19], a[224:227], a[160:163], v[16:19]
    ds_read_b64_tr_b16 a[240:241], v196 offset:18432
    v_mfma_f32_16x16x32_bf16 v[20:23], a[224:227], a[164:167], v[20:23]
    ds_read_b64_tr_b16 a[242:243], v196 offset:18944
    v_mfma_f32_16x16x32_bf16 v[24:27], a[224:227], a[168:171], v[24:27]
    ds_read_b128 a[176:179], v201 offset:32768
    buffer_load_dwordx4 v209, s[48:51], s78 offen offset:1024 lds
    v_mfma_f32_16x16x32_bf16 v[28:31], a[224:227], a[172:175], v[28:31]
    ds_read_b128 a[180:183], v201 offset:34816
    v_mfma_f32_16x16x32_bf16 v[168:171], a[224:227], v[212:215], v[168:171]
    v_mfma_f32_16x16x32_bf16 v[44:47], a[228:231], a[172:175], v[44:47]
    ds_read_b128 a[184:187], v203 offset:32768
    v_mfma_f32_16x16x32_bf16 v[40:43], a[228:231], a[168:171], v[40:43]
    ds_read_b128 a[188:191], v203 offset:34816
    v_mfma_f32_16x16x32_bf16 v[216:219], v[212:215], a[160:163], v[216:219]
    v_mfma_f32_16x16x32_bf16 v[36:39], a[228:231], a[164:167], v[36:39]
    ds_read_b128 v[144:147], v228 offset:32768
    v_mfma_f32_16x16x32_bf16 v[32:35], a[228:231], a[160:163], v[32:35]
    ds_read_b128 v[148:151], v229 offset:32768
    v_mfma_f32_16x16x32_bf16 v[172:175], a[228:231], v[212:215], v[172:175]
    buffer_load_dwordx4 v210, s[48:51], s78 offen offset:2048 lds
    s_waitcnt lgkmcnt(8)
    v_mfma_f32_16x16x32_bf16 v[48:51], a[232:235], a[160:163], v[48:51]
    ds_read_b64_tr_b16 a[244:245], v197 offset:18432
    v_mfma_f32_16x16x32_bf16 v[52:55], a[232:235], a[164:167], v[52:55]
    ds_read_b64_tr_b16 a[246:247], v197 offset:18944
    v_mfma_f32_16x16x32_bf16 v[56:59], a[232:235], a[168:171], v[56:59]
    ds_read_b64_tr_b16 a[248:249], v198 offset:18432
    v_mfma_f32_16x16x32_bf16 v[60:63], a[232:235], a[172:175], v[60:63]
    ds_read_b64_tr_b16 a[250:251], v198 offset:18944
    v_mfma_f32_16x16x32_bf16 v[220:223], v[212:215], a[164:167], v[220:223]
    v_mfma_f32_16x16x32_bf16 v[76:79], a[236:239], a[172:175], v[76:79]
    ds_read_b64_tr_b16 a[252:253], v199 offset:18432
    buffer_load_dwordx4 v211, s[48:51], s78 offen offset:3072 lds
    v_mfma_f32_16x16x32_bf16 v[72:75], a[236:239], a[168:171], v[72:75]
    ds_read_b64_tr_b16 a[254:255], v199 offset:18944
    v_mfma_f32_16x16x32_bf16 v[68:71], a[236:239], a[164:167], v[68:71]
    v_mfma_f32_16x16x32_bf16 v[64:67], a[236:239], a[160:163], v[64:67]
    s_waitcnt vmcnt(9) lgkmcnt(6)
    s_barrier
    s_waitcnt lgkmcnt(4)
    v_mfma_f32_16x16x32_bf16 v[16:19], a[240:243], a[176:179], v[16:19]
    ds_read_b64_tr_b16 a[224:225], v196 offset:32768
    v_mfma_f32_16x16x32_bf16 v[20:23], a[240:243], a[180:183], v[20:23]
    ds_read_b64_tr_b16 a[226:227], v196 offset:33280
    v_mfma_f32_16x16x32_bf16 v[224:227], v[144:147], v[144:147], v[224:227]
    v_mfma_f32_16x16x32_bf16 v[24:27], a[240:243], a[184:187], v[24:27]
    ds_read_b128 a[192:195], v200 offset:0
    s_add_u32 m0, s14, 81920
    s_add_u32 s79, s79, 128
    buffer_load_dwordx4 v208, s[48:51], s79 offen offset:0 lds
    v_mfma_f32_16x16x32_bf16 v[28:31], a[240:243], a[188:191], v[28:31]
    ds_read_b128 a[196:199], v200 offset:2048
    v_mfma_f32_16x16x32_bf16 v[168:171], a[240:243], v[212:215], v[168:171]
    v_mfma_f32_16x16x32_bf16 v[44:47], a[244:247], a[188:191], v[44:47]
    ds_read_b128 a[200:203], v202 offset:0
    v_mfma_f32_16x16x32_bf16 v[40:43], a[244:247], a[184:187], v[40:43]
    ds_read_b128 a[204:207], v202 offset:2048
    v_mfma_f32_16x16x32_bf16 v[216:219], v[212:215], a[176:179], v[216:219]
    v_mfma_f32_16x16x32_bf16 v[36:39], a[244:247], a[180:183], v[36:39]
    ds_read_b64_tr_b16 a[228:229], v197 offset:32768
    v_mfma_f32_16x16x32_bf16 v[32:35], a[244:247], a[176:179], v[32:35]
    ds_read_b64_tr_b16 a[230:231], v197 offset:33280
    v_mfma_f32_16x16x32_bf16 v[172:175], a[244:247], v[212:215], v[172:175]
    buffer_load_dwordx4 v209, s[48:51], s79 offen offset:1024 lds
    s_waitcnt lgkmcnt(8)
    v_mfma_f32_16x16x32_bf16 v[48:51], a[248:251], a[176:179], v[48:51]
    ds_read_b64_tr_b16 a[232:233], v198 offset:32768
    v_mfma_f32_16x16x32_bf16 v[52:55], a[248:251], a[180:183], v[52:55]
    ds_read_b64_tr_b16 a[234:235], v198 offset:33280
    v_mfma_f32_16x16x32_bf16 v[224:227], v[148:151], v[148:151], v[224:227]
    v_mfma_f32_16x16x32_bf16 v[56:59], a[248:251], a[184:187], v[56:59]
    ds_read_b64_tr_b16 a[236:237], v199 offset:32768
    v_mfma_f32_16x16x32_bf16 v[60:63], a[248:251], a[188:191], v[60:63]
    ds_read_b64_tr_b16 a[238:239], v199 offset:33280
    v_mfma_f32_16x16x32_bf16 v[220:223], v[212:215], a[180:183], v[220:223]
    v_mfma_f32_16x16x32_bf16 v[76:79], a[252:255], a[188:191], v[76:79]
    buffer_load_dwordx4 v210, s[48:51], s79 offen offset:2048 lds
    v_mfma_f32_16x16x32_bf16 v[72:75], a[252:255], a[184:187], v[72:75]
    v_mfma_f32_16x16x32_bf16 v[68:71], a[252:255], a[180:183], v[68:71]
    v_mfma_f32_16x16x32_bf16 v[64:67], a[252:255], a[176:179], v[64:67]
    s_waitcnt lgkmcnt(4)
    v_mfma_f32_16x16x32_bf16 v[16:19], a[224:227], a[192:195], v[16:19]
    ds_read_b64_tr_b16 a[240:241], v196 offset:34816
    v_mfma_f32_16x16x32_bf16 v[20:23], a[224:227], a[196:199], v[20:23]
    ds_read_b64_tr_b16 a[242:243], v196 offset:35328
    v_mfma_f32_16x16x32_bf16 v[24:27], a[224:227], a[200:203], v[24:27]
    ds_read_b128 a[208:211], v201 offset:0
    buffer_load_dwordx4 v211, s[48:51], s79 offen offset:3072 lds
    v_mfma_f32_16x16x32_bf16 v[28:31], a[224:227], a[204:207], v[28:31]
    ds_read_b128 a[212:215], v201 offset:2048
    v_mfma_f32_16x16x32_bf16 v[168:171], a[224:227], v[212:215], v[168:171]
    v_mfma_f32_16x16x32_bf16 v[44:47], a[228:231], a[204:207], v[44:47]
    ds_read_b128 a[216:219], v203 offset:0
    v_mfma_f32_16x16x32_bf16 v[40:43], a[228:231], a[200:203], v[40:43]
    ds_read_b128 a[220:223], v203 offset:2048
    v_mfma_f32_16x16x32_bf16 v[216:219], v[212:215], a[192:195], v[216:219]
    v_mfma_f32_16x16x32_bf16 v[36:39], a[228:231], a[196:199], v[36:39]
    ds_read_b128 v[144:147], v228 offset:0
    v_mfma_f32_16x16x32_bf16 v[32:35], a[228:231], a[192:195], v[32:35]
    ds_read_b128 v[148:151], v229 offset:0
    v_mfma_f32_16x16x32_bf16 v[172:175], a[228:231], v[212:215], v[172:175]
    s_add_u32 m0, s14, 98304
    s_add_u32 s80, s80, 128
    buffer_load_dwordx4 v208, s[48:51], s80 offen offset:0 lds
    s_waitcnt lgkmcnt(8)
    v_mfma_f32_16x16x32_bf16 v[48:51], a[232:235], a[192:195], v[48:51]
    ds_read_b64_tr_b16 a[244:245], v197 offset:34816
    v_mfma_f32_16x16x32_bf16 v[52:55], a[232:235], a[196:199], v[52:55]
    ds_read_b64_tr_b16 a[246:247], v197 offset:35328
    v_mfma_f32_16x16x32_bf16 v[56:59], a[232:235], a[200:203], v[56:59]
    ds_read_b64_tr_b16 a[248:249], v198 offset:34816
    v_mfma_f32_16x16x32_bf16 v[60:63], a[232:235], a[204:207], v[60:63]
    ds_read_b64_tr_b16 a[250:251], v198 offset:35328
    v_mfma_f32_16x16x32_bf16 v[220:223], v[212:215], a[196:199], v[220:223]
    v_mfma_f32_16x16x32_bf16 v[76:79], a[236:239], a[204:207], v[76:79]
    ds_read_b64_tr_b16 a[252:253], v199 offset:34816
    buffer_load_dwordx4 v209, s[48:51], s80 offen offset:1024 lds
    v_mfma_f32_16x16x32_bf16 v[72:75], a[236:239], a[200:203], v[72:75]
    ds_read_b64_tr_b16 a[254:255], v199 offset:35328
    v_mfma_f32_16x16x32_bf16 v[68:71], a[236:239], a[196:199], v[68:71]
    v_mfma_f32_16x16x32_bf16 v[64:67], a[236:239], a[192:195], v[64:67]
    s_waitcnt vmcnt(10) lgkmcnt(6)
    s_barrier
    s_waitcnt lgkmcnt(4)
    v_mfma_f32_16x16x32_bf16 v[16:19], a[240:243], a[208:211], v[16:19]
    ds_read_b64_tr_b16 a[224:225], v192 offset:0
    v_readfirstlane_b32 s43, v7
    v_readfirstlane_b32 s42, v6
    s_cmp_lg_u32 s43, 0
    s_cbranch_scc1 L_ptag_ok
L_ptag_retry:
    s_add_u32 s100, s100, 1
    s_cmp_gt_u32 s100, 200000
    s_cbranch_scc1 L_ptag_ok
    s_sleep 8
    buffer_load_dwordx2 v[6:7], v5, s[60:63], 0 offen sc1
    s_waitcnt vmcnt(0)
    v_readfirstlane_b32 s43, v7
    v_readfirstlane_b32 s42, v6
    s_cmp_lg_u32 s43, 0
    s_cbranch_scc0 L_ptag_retry
L_ptag_ok:
    v_mfma_f32_16x16x32_bf16 v[20:23], a[240:243], a[212:215], v[20:23]
    ds_read_b64_tr_b16 a[226:227], v192 offset:512
    v_mfma_f32_16x16x32_bf16 v[224:227], v[144:147], v[144:147], v[224:227]
    v_mfma_f32_16x16x32_bf16 v[24:27], a[240:243], a[216:219], v[24:27]
    ds_read_b64_tr_b16 a[228:229], v193 offset:0
    buffer_load_dwordx4 v210, s[48:51], s80 offen offset:2048 lds
    v_mfma_f32_16x16x32_bf16 v[28:31], a[240:243], a[220:223], v[28:31]
    ds_read_b64_tr_b16 a[230:231], v193 offset:512
    v_mfma_f32_16x16x32_bf16 v[168:171], a[240:243], v[212:215], v[168:171]
    v_mfma_f32_16x16x32_bf16 v[44:47], a[244:247], a[220:223], v[44:47]
    ds_read_b64_tr_b16 a[232:233], v194 offset:0
    v_mfma_f32_16x16x32_bf16 v[40:43], a[244:247], a[216:219], v[40:43]
    ds_read_b64_tr_b16 a[234:235], v194 offset:512
    v_mfma_f32_16x16x32_bf16 v[216:219], v[212:215], a[208:211], v[216:219]
    v_mfma_f32_16x16x32_bf16 v[36:39], a[244:247], a[212:215], v[36:39]
    ds_read_b64_tr_b16 a[236:237], v195 offset:0
    v_mfma_f32_16x16x32_bf16 v[32:35], a[244:247], a[208:211], v[32:35]
    ds_read_b64_tr_b16 a[238:239], v195 offset:512
    v_mfma_f32_16x16x32_bf16 v[172:175], a[244:247], v[212:215], v[172:175]
    buffer_load_dwordx4 v211, s[48:51], s80 offen offset:3072 lds
    s_waitcnt lgkmcnt(8)
    v_mfma_f32_16x16x32_bf16 v[48:51], a[248:251], a[208:211], v[48:51]
    v_mfma_f32_16x16x32_bf16 v[52:55], a[248:251], a[212:215], v[52:55]
    v_mfma_f32_16x16x32_bf16 v[224:227], v[148:151], v[148:151], v[224:227]
    v_mfma_f32_16x16x32_bf16 v[56:59], a[248:251], a[216:219], v[56:59]
    v_mfma_f32_16x16x32_bf16 v[60:63], a[248:251], a[220:223], v[60:63]
    v_mfma_f32_16x16x32_bf16 v[220:223], v[212:215], a[212:215], v[220:223]
    v_mfma_f32_16x16x32_bf16 v[76:79], a[252:255], a[220:223], v[76:79]
    s_add_u32 m0, s14, 114688
    s_add_u32 s81, s81, 128
    buffer_load_dwordx4 v208, s[48:51], s81 offen offset:0 lds
    v_mfma_f32_16x16x32_bf16 v[72:75], a[252:255], a[216:219], v[72:75]
    v_mfma_f32_16x16x32_bf16 v[68:71], a[252:255], a[212:215], v[68:71]
    v_mfma_f32_16x16x32_bf16 v[64:67], a[252:255], a[208:211], v[64:67]
    s_waitcnt lgkmcnt(4)
    v_mfma_f32_16x16x32_bf16 v[80:83], a[224:227], a[0:3], 0
    ds_read_b64_tr_b16 a[240:241], v192 offset:2048
    v_mfma_f32_16x16x32_bf16 v[84:87], a[224:227], a[4:7], 0
    ds_read_b64_tr_b16 a[242:243], v192 offset:2560
    v_mfma_f32_16x16x32_bf16 v[88:91], a[224:227], a[8:11], 0
    ds_read_b64_tr_b16 a[244:245], v193 offset:2048
    buffer_load_dwordx4 v209, s[48:51], s81 offen offset:1024 lds
    v_mul_f32 v160, 0x3b124925, v216
    v_mul_f32 v161, 0x3b124925, v220
    v_mfma_f32_16x16x32_bf16 v[92:95], a[224:227], a[12:15], 0
    ds_read_b64_tr_b16 a[246:247], v193 offset:2560
    s_mov_b64 exec, 0xffff
    ds_write_b32 v165, v160 offset:0
    ds_write_b32 v165, v161 offset:64
    s_mov_b64 exec, -1
    v_mfma_f32_16x16x32_bf16 v[108:111], a[228:231], a[12:15], 0
    ds_read_b64_tr_b16 a[248:249], v194 offset:2048
    s_mov_b32 exec_lo, 0x00010001
    s_mov_b32 exec_hi, 0x00010001
    ds_write_b128 v164, v[168:171] offset:0
    ds_write_b128 v164, v[172:175] offset:64
    s_mov_b64 exec, -1
    v_mfma_f32_16x16x32_bf16 v[104:107], a[228:231], a[8:11], 0
    ds_read_b64_tr_b16 a[250:251], v194 offset:2560
    v_mfma_f32_16x16x32_bf16 v[100:103], a[228:231], a[4:7], 0
    ds_read_b64_tr_b16 a[252:253], v195 offset:2048
    v_mfma_f32_16x16x32_bf16 v[96:99], a[228:231], a[0:3], 0
    ds_read_b64_tr_b16 a[254:255], v195 offset:2560
    v_cndmask_b32 v224, v224, v225, s[18:19]
    s_waitcnt lgkmcnt(12)
    v_mfma_f32_16x16x32_bf16 v[112:115], a[232:235], a[0:3], 0
    v_cndmask_b32 v224, v224, v226, s[20:21]
    v_cndmask_b32 v224, v224, v227, s[22:23]
    v_mfma_f32_16x16x32_bf16 v[116:119], a[232:235], a[4:7], 0
    buffer_store_dword v160, v167, s[52:55], s16 offen offset:0 sc1
    buffer_store_dword v161, v167, s[52:55], s16 offen offset:64 sc1
    buffer_store_dword v224, v166, s[52:55], s17 offen sc1
    v_mfma_f32_16x16x32_bf16 v[120:123], a[232:235], a[8:11], 0
    buffer_load_dwordx4 v210, s[48:51], s81 offen offset:2048 lds
    v_mfma_f32_16x16x32_bf16 v[124:127], a[232:235], a[12:15], 0
    v_mfma_f32_16x16x32_bf16 v[140:143], a[236:239], a[12:15], 0
    v_mfma_f32_16x16x32_bf16 v[136:139], a[236:239], a[8:11], 0
    v_mfma_f32_16x16x32_bf16 v[132:135], a[236:239], a[4:7], 0
    v_mfma_f32_16x16x32_bf16 v[128:131], a[236:239], a[0:3], 0
    s_waitcnt vmcnt(14) lgkmcnt(3)
    s_barrier
    v_mfma_f32_16x16x32_bf16 v[80:83], a[240:243], a[16:19], v[80:83]
    ds_read_b64_tr_b16 a[224:225], v192 offset:16384
    v_xor_b32 v8, 128, v165
    ds_read_b32 v162, v8 offset:0
    v_mfma_f32_16x16x32_bf16 v[84:87], a[240:243], a[20:23], v[84:87]
    ds_read_b64_tr_b16 a[226:227], v192 offset:16896
    ds_read_b32 v163, v8 offset:64
    v_xor_b32 v9, 256, v164
    v_mfma_f32_16x16x32_bf16 v[88:91], a[240:243], a[24:27], v[88:91]
    ds_read_b64_tr_b16 a[228:229], v193 offset:16384
    buffer_load_dwordx4 v211, s[48:51], s81 offen offset:3072 lds
    ds_read_b128 v[152:155], v9 offset:0
    ds_read_b128 v[156:159], v9 offset:64
    v_mfma_f32_16x16x32_bf16 v[92:95], a[240:243], a[28:31], v[92:95]
    ds_read_b64_tr_b16 a[230:231], v193 offset:16896
    v_cvt_pk_bf16_f32 v160, v160, v160
    v_lshlrev_b32 v160, 16, v160
    v_mfma_f32_16x16x32_bf16 v[108:111], a[244:247], a[28:31], v[108:111]
    ds_read_b64_tr_b16 a[232:233], v194 offset:16384
    v_cvt_pk_bf16_f32 v161, v161, v161
    v_lshlrev_b32 v161, 16, v161
    v_mfma_f32_16x16x32_bf16 v[104:107], a[244:247], a[24:27], v[104:107]
    ds_read_b64_tr_b16 a[234:235], v194 offset:16896
    s_waitcnt lgkmcnt(6)
    v_cvt_pk_bf16_f32 v162, v162, v162
    v_mfma_f32_16x16x32_bf16 v[100:103], a[244:247], a[20:23], v[100:103]
    ds_read_b64_tr_b16 a[236:237], v195 offset:16384
    v_lshlrev_b32 v162, 16, v162
    v_cvt_pk_bf16_f32 v163, v163, v163
    v_mfma_f32_16x16x32_bf16 v[96:99], a[244:247], a[16:19], v[96:99]
    ds_read_b64_tr_b16 a[238:239], v195 offset:16896
    v_lshlrev_b32 v163, 16, v163
    v_fma_f32 v16, -v160, v168, v16
    v_mfma_f32_16x16x32_bf16 v[112:115], a[248:251], a[16:19], v[112:115]
    v_fma_f32 v17, -v160, v169, v17
    v_fma_f32 v18, -v160, v170, v18
    v_mfma_f32_16x16x32_bf16 v[116:119], a[248:251], a[20:23], v[116:119]
    v_fma_f32 v19, -v160, v171, v19
    v_fma_f32 v32, -v160, v172, v32
    v_mfma_f32_16x16x32_bf16 v[120:123], a[248:251], a[24:27], v[120:123]
    s_add_u32 m0, s14, 131072
    s_add_u32 s82, s82, 128
    buffer_load_dwordx4 v208, s[48:51], s82 offen offset:0 lds
    v_fma_f32 v33, -v160, v173, v33
    v_fma_f32 v34, -v160, v174, v34
    v_mfma_f32_16x16x32_bf16 v[124:127], a[248:251], a[28:31], v[124:127]
    v_fma_f32 v35, -v160, v175, v35
    s_waitcnt lgkmcnt(5)
    v_mfma_f32_16x16x32_bf16 v[140:143], a[252:255], a[28:31], v[140:143]
    v_fma_f32 v48, -v160, v152, v48
    v_fma_f32 v49, -v160, v153, v49
    v_mfma_f32_16x16x32_bf16 v[136:139], a[252:255], a[24:27], v[136:139]
    v_fma_f32 v50, -v160, v154, v50
    v_fma_f32 v51, -v160, v155, v51
    v_mfma_f32_16x16x32_bf16 v[132:135], a[252:255], a[20:23], v[132:135]
    v_fma_f32 v64, -v160, v156, v64
    v_fma_f32 v65, -v160, v157, v65
    v_mfma_f32_16x16x32_bf16 v[128:131], a[252:255], a[16:19], v[128:131]
    v_fma_f32 v66, -v160, v158, v66
    v_fma_f32 v67, -v160, v159, v67
    s_waitcnt lgkmcnt(4)
    v_mfma_f32_16x16x32_bf16 v[80:83], a[224:227], a[32:35], v[80:83]
    ds_read_b64_tr_b16 a[240:241], v192 offset:18432
    v_mul_f32 v16, v16, v48
    v_mul_f32 v17, v17, v49
    v_mfma_f32_16x16x32_bf16 v[84:87], a[224:227], a[36:39], v[84:87]
    ds_read_b64_tr_b16 a[242:243], v192 offset:18944
    v_mul_f32 v18, v18, v50
    v_mul_f32 v19, v19, v51
    v_mfma_f32_16x16x32_bf16 v[88:91], a[224:227], a[40:43], v[88:91]
    ds_read_b64_tr_b16 a[244:245], v193 offset:18432
    buffer_load_dwordx4 v209, s[48:51], s82 offen offset:1024 lds
    v_mul_f32 v32, v32, v64
    v_mul_f32 v33, v33, v65
    v_mfma_f32_16x16x32_bf16 v[92:95], a[224:227], a[44:47], v[92:95]
    ds_read_b64_tr_b16 a[246:247], v193 offset:18944
    v_mul_f32 v34, v34, v66
    v_mul_f32 v35, v35, v67
    v_mfma_f32_16x16x32_bf16 v[108:111], a[228:231], a[44:47], v[108:111]
    ds_read_b64_tr_b16 a[248:249], v194 offset:18432
    v_cvt_pk_bf16_f32 v48, v16, v17
    v_cvt_pk_bf16_f32 v49, v18, v19
    v_mfma_f32_16x16x32_bf16 v[104:107], a[228:231], a[40:43], v[104:107]
    ds_read_b64_tr_b16 a[250:251], v194 offset:18944
    v_cvt_pk_bf16_f32 v50, v32, v33
    v_cvt_pk_bf16_f32 v51, v34, v35
    v_mfma_f32_16x16x32_bf16 v[100:103], a[228:231], a[36:39], v[100:103]
    ds_read_b64_tr_b16 a[252:253], v195 offset:18432
    s_xor_b32 s101, s13, 0
    s_add_u32 s101, s101, 0
    buffer_store_dwordx4 v[48:51], v3, s[52:55], s101 offen offset:0 sc1
    v_mfma_f32_16x16x32_bf16 v[96:99], a[228:231], a[32:35], v[96:99]
    ds_read_b64_tr_b16 a[254:255], v195 offset:18944
    v_fma_f32 v20, -v161, v168, v20
    v_fma_f32 v21, -v161, v169, v21
    s_waitcnt lgkmcnt(8)
    v_mfma_f32_16x16x32_bf16 v[112:115], a[232:235], a[32:35], v[112:115]
    v_fma_f32 v22, -v161, v170, v22
    v_fma_f32 v23, -v161, v171, v23
    v_mfma_f32_16x16x32_bf16 v[116:119], a[232:235], a[36:39], v[116:119]
    v_fma_f32 v36, -v161, v172, v36
    v_fma_f32 v37, -v161, v173, v37
    v_mfma_f32_16x16x32_bf16 v[120:123], a[232:235], a[40:43], v[120:123]
    buffer_load_dwordx4 v210, s[48:51], s82 offen offset:2048 lds
    v_fma_f32 v38, -v161, v174, v38
    v_fma_f32 v39, -v161, v175, v39
    v_mfma_f32_16x16x32_bf16 v[124:127], a[232:235], a[44:47], v[124:127]
    v_fma_f32 v52, -v161, v152, v52
    v_fma_f32 v53, -v161, v153, v53
    v_mfma_f32_16x16x32_bf16 v[140:143], a[236:239], a[44:47], v[140:143]
    v_fma_f32 v54, -v161, v154, v54
    v_fma_f32 v55, -v161, v155, v55
    v_mfma_f32_16x16x32_bf16 v[136:139], a[236:239], a[40:43], v[136:139]
    v_fma_f32 v68, -v161, v156, v68
    v_fma_f32 v69, -v161, v157, v69
    v_mfma_f32_16x16x32_bf16 v[132:135], a[236:239], a[36:39], v[132:135]
    v_fma_f32 v70, -v161, v158, v70
    v_fma_f32 v71, -v161, v159, v71
    v_mfma_f32_16x16x32_bf16 v[128:131], a[236:239], a[32:35], v[128:131]
    v_mul_f32 v20, v20, v52
    v_mul_f32 v21, v21, v53
    s_waitcnt vmcnt(15)
    s_barrier
    s_waitcnt lgkmcnt(4)
    v_mfma_f32_16x16x32_bf16 v[80:83], a[240:243], a[48:51], v[80:83]
    ds_read_b64_tr_b16 a[224:225], v192 offset:32768
    v_mul_f32 v22, v22, v54
    v_mul_f32 v23, v23, v55
    v_mfma_f32_16x16x32_bf16 v[84:87], a[240:243], a[52:55], v[84:87]
    ds_read_b64_tr_b16 a[226:227], v192 offset:33280
    v_mul_f32 v36, v36, v68
    v_mul_f32 v37, v37, v69
    v_mfma_f32_16x16x32_bf16 v[88:91], a[240:243], a[56:59], v[88:91]
    ds_read_b64_tr_b16 a[228:229], v193 offset:32768
    buffer_load_dwordx4 v211, s[48:51], s82 offen offset:3072 lds
    v_mul_f32 v38, v38, v70
    v_mul_f32 v39, v39, v71
    v_mfma_f32_16x16x32_bf16 v[92:95], a[240:243], a[60:63], v[92:95]
    ds_read_b64_tr_b16 a[230:231], v193 offset:33280
    v_cvt_pk_bf16_f32 v52, v20, v21
    v_cvt_pk_bf16_f32 v53, v22, v23
    v_mfma_f32_16x16x32_bf16 v[108:111], a[244:247], a[60:63], v[108:111]
    ds_read_b64_tr_b16 a[232:233], v194 offset:32768
    v_cvt_pk_bf16_f32 v54, v36, v37
    v_cvt_pk_bf16_f32 v55, v38, v39
    v_mfma_f32_16x16x32_bf16 v[104:107], a[244:247], a[56:59], v[104:107]
    ds_read_b64_tr_b16 a[234:235], v194 offset:33280
    s_xor_b32 s101, s13, 0
    s_add_u32 s101, s101, 0
    buffer_store_dwordx4 v[52:55], v3, s[52:55], s101 offen offset:1024 sc1
    v_mfma_f32_16x16x32_bf16 v[100:103], a[244:247], a[52:55], v[100:103]
    ds_read_b64_tr_b16 a[236:237], v195 offset:32768
    v_fma_f32 v24, -v162, v168, v24
    v_fma_f32 v25, -v162, v169, v25
    v_mfma_f32_16x16x32_bf16 v[96:99], a[244:247], a[48:51], v[96:99]
    ds_read_b64_tr_b16 a[238:239], v195 offset:33280
    v_fma_f32 v26, -v162, v170, v26
    v_fma_f32 v27, -v162, v171, v27
    s_waitcnt lgkmcnt(8)
    v_mfma_f32_16x16x32_bf16 v[112:115], a[248:251], a[48:51], v[112:115]
    v_fma_f32 v40, -v162, v172, v40
    v_fma_f32 v41, -v162, v173, v41
    v_mfma_f32_16x16x32_bf16 v[116:119], a[248:251], a[52:55], v[116:119]
    v_fma_f32 v42, -v162, v174, v42
    v_fma_f32 v43, -v162, v175, v43
    v_mfma_f32_16x16x32_bf16 v[120:123], a[248:251], a[56:59], v[120:123]
    s_add_u32 m0, s14, 147456
    s_add_u32 s83, s83, 128
    buffer_load_dwordx4 v208, s[48:51], s83 offen offset:0 lds
    v_fma_f32 v56, -v162, v152, v56
    v_fma_f32 v57, -v162, v153, v57
    v_mfma_f32_16x16x32_bf16 v[124:127], a[248:251], a[60:63], v[124:127]
    v_fma_f32 v58, -v162, v154, v58
    v_fma_f32 v59, -v162, v155, v59
    v_mfma_f32_16x16x32_bf16 v[140:143], a[252:255], a[60:63], v[140:143]
    v_fma_f32 v72, -v162, v156, v72
    v_fma_f32 v73, -v162, v157, v73
    v_mfma_f32_16x16x32_bf16 v[136:139], a[252:255], a[56:59], v[136:139]
    v_fma_f32 v74, -v162, v158, v74
    v_fma_f32 v75, -v162, v159, v75
    v_mfma_f32_16x16x32_bf16 v[132:135], a[252:255], a[52:55], v[132:135]
    v_mul_f32 v24, v24, v56
    v_mul_f32 v25, v25, v57
    v_mfma_f32_16x16x32_bf16 v[128:131], a[252:255], a[48:51], v[128:131]
    v_mul_f32 v26, v26, v58
    v_mul_f32 v27, v27, v59
    s_waitcnt lgkmcnt(4)
    v_mfma_f32_16x16x32_bf16 v[80:83], a[224:227], a[64:67], v[80:83]
    ds_read_b64_tr_b16 a[240:241], v192 offset:34816
    v_mul_f32 v40, v40, v72
    v_mul_f32 v41, v41, v73
    v_mfma_f32_16x16x32_bf16 v[84:87], a[224:227], a[68:71], v[84:87]
    ds_read_b64_tr_b16 a[242:243], v192 offset:35328
    v_mul_f32 v42, v42, v74
    v_mul_f32 v43, v43, v75
    v_mfma_f32_16x16x32_bf16 v[88:91], a[224:227], a[72:75], v[88:91]
    ds_read_b64_tr_b16 a[244:245], v193 offset:34816
    buffer_load_dwordx4 v209, s[48:51], s83 offen offset:1024 lds
    v_cvt_pk_bf16_f32 v56, v24, v25
    v_cvt_pk_bf16_f32 v57, v26, v27
    v_mfma_f32_16x16x32_bf16 v[92:95], a[224:227], a[76:79], v[92:95]
    ds_read_b64_tr_b16 a[246:247], v193 offset:35328
    v_cvt_pk_bf16_f32 v58, v40, v41
    v_cvt_pk_bf16_f32 v59, v42, v43
    v_mfma_f32_16x16x32_bf16 v[108:111], a[228:231], a[76:79], v[108:111]
    ds_read_b64_tr_b16 a[248:249], v194 offset:34816
    s_xor_b32 s101, s13, 2048
    s_add_u32 s101, s101, 0
    buffer_store_dwordx4 v[56:59], v3, s[52:55], s101 offen offset:0 sc1
    v_mfma_f32_16x16x32_bf16 v[104:107], a[228:231], a[72:75], v[104:107]
    ds_read_b64_tr_b16 a[250:251], v194 offset:35328
    v_fma_f32 v28, -v163, v168, v28
    v_fma_f32 v29, -v163, v169, v29
    v_mfma_f32_16x16x32_bf16 v[100:103], a[228:231], a[68:71], v[100:103]
    ds_read_b64_tr_b16 a[252:253], v195 offset:34816
    v_fma_f32 v30, -v163, v170, v30
    v_fma_f32 v31, -v163, v171, v31
    v_mfma_f32_16x16x32_bf16 v[96:99], a[228:231], a[64:67], v[96:99]
    ds_read_b64_tr_b16 a[254:255], v195 offset:35328
    v_fma_f32 v44, -v163, v172, v44
    v_fma_f32 v45, -v163, v173, v45
    s_waitcnt lgkmcnt(8)
    v_mfma_f32_16x16x32_bf16 v[112:115], a[232:235], a[64:67], v[112:115]
    v_fma_f32 v46, -v163, v174, v46
    v_fma_f32 v47, -v163, v175, v47
    v_mfma_f32_16x16x32_bf16 v[116:119], a[232:235], a[68:71], v[116:119]
    v_fma_f32 v60, -v163, v152, v60
    v_fma_f32 v61, -v163, v153, v61
    v_mfma_f32_16x16x32_bf16 v[120:123], a[232:235], a[72:75], v[120:123]
    buffer_load_dwordx4 v210, s[48:51], s83 offen offset:2048 lds
    v_fma_f32 v62, -v163, v154, v62
    v_fma_f32 v63, -v163, v155, v63
    v_mfma_f32_16x16x32_bf16 v[124:127], a[232:235], a[76:79], v[124:127]
    v_fma_f32 v76, -v163, v156, v76
    v_fma_f32 v77, -v163, v157, v77
    v_mfma_f32_16x16x32_bf16 v[140:143], a[236:239], a[76:79], v[140:143]
    v_fma_f32 v78, -v163, v158, v78
    v_fma_f32 v79, -v163, v159, v79
    v_mfma_f32_16x16x32_bf16 v[136:139], a[236:239], a[72:75], v[136:139]
    v_mul_f32 v28, v28, v60
    v_mul_f32 v29, v29, v61
    v_mfma_f32_16x16x32_bf16 v[132:135], a[236:239], a[68:71], v[132:135]
    v_mul_f32 v30, v30, v62
    v_mul_f32 v31, v31, v63
    v_mfma_f32_16x16x32_bf16 v[128:131], a[236:239], a[64:67], v[128:131]
    v_mul_f32 v44, v44, v76
    v_mul_f32 v45, v45, v77
    s_waitcnt vmcnt(17)
    s_barrier
    s_waitcnt lgkmcnt(4)
    v_mfma_f32_16x16x32_bf16 v[80:83], a[240:243], a[80:83], v[80:83]
    ds_read_b64_tr_b16 a[224:225], v192 offset:49152
    buffer_load_dwordx2 v[14:15], v1, s[52:55], s24 offen sc1
    v_mul_f32 v46, v46, v78
    v_mul_f32 v47, v47, v79
    v_mfma_f32_16x16x32_bf16 v[84:87], a[240:243], a[84:87], v[84:87]
    ds_read_b64_tr_b16 a[226:227], v192 offset:49664
    v_cvt_pk_bf16_f32 v60, v28, v29
    v_cvt_pk_bf16_f32 v61, v30, v31
    v_mfma_f32_16x16x32_bf16 v[88:91], a[240:243], a[88:91], v[88:91]
    ds_read_b64_tr_b16 a[228:229], v193 offset:49152
    buffer_load_dwordx4 v211, s[48:51], s83 offen offset:3072 lds
    v_cvt_pk_bf16_f32 v62, v44, v45
    v_cvt_pk_bf16_f32 v63, v46, v47
    v_mfma_f32_16x16x32_bf16 v[92:95], a[240:243], a[92:95], v[92:95]
    ds_read_b64_tr_b16 a[230:231], v193 offset:49664
    s_xor_b32 s101, s13, 2048
    s_add_u32 s101, s101, 0
    buffer_store_dwordx4 v[60:63], v3, s[52:55], s101 offen offset:1024 sc1
    v_mfma_f32_16x16x32_bf16 v[108:111], a[244:247], a[92:95], v[108:111]
    ds_read_b64_tr_b16 a[232:233], v194 offset:49152
    v_mfma_f32_16x16x32_bf16 v[104:107], a[244:247], a[88:91], v[104:107]
    ds_read_b64_tr_b16 a[234:235], v194 offset:49664
    v_mfma_f32_16x16x32_bf16 v[100:103], a[244:247], a[84:87], v[100:103]
    ds_read_b64_tr_b16 a[236:237], v195 offset:49152
    v_mfma_f32_16x16x32_bf16 v[96:99], a[244:247], a[80:83], v[96:99]
    ds_read_b64_tr_b16 a[238:239], v195 offset:49664
    s_waitcnt lgkmcnt(8)
    v_mfma_f32_16x16x32_bf16 v[112:115], a[248:251], a[80:83], v[112:115]
    v_mfma_f32_16x16x32_bf16 v[116:119], a[248:251], a[84:87], v[116:119]
    v_mfma_f32_16x16x32_bf16 v[120:123], a[248:251], a[88:91], v[120:123]
    s_add_u32 m0, s14, 49152
    s_add_u32 s77, s77, 128
    buffer_load_dwordx4 v208, s[48:51], s77 offen offset:0 lds
    v_mfma_f32_16x16x32_bf16 v[124:127], a[248:251], a[92:95], v[124:127]
    v_mfma_f32_16x16x32_bf16 v[140:143], a[252:255], a[92:95], v[140:143]
    v_mfma_f32_16x16x32_bf16 v[136:139], a[252:255], a[88:91], v[136:139]
    v_mfma_f32_16x16x32_bf16 v[132:135], a[252:255], a[84:87], v[132:135]
    v_mfma_f32_16x16x32_bf16 v[128:131], a[252:255], a[80:83], v[128:131]
    s_waitcnt lgkmcnt(4)
    v_mfma_f32_16x16x32_bf16 v[80:83], a[224:227], a[96:99], v[80:83]
    ds_read_b64_tr_b16 a[240:241], v192 offset:51200
    v_mfma_f32_16x16x32_bf16 v[84:87], a[224:227], a[100:103], v[84:87]
    ds_read_b64_tr_b16 a[242:243], v192 offset:51712
    v_mfma_f32_16x16x32_bf16 v[88:91], a[224:227], a[104:107], v[88:91]
    ds_read_b64_tr_b16 a[244:245], v193 offset:51200
    buffer_load_dwordx4 v209, s[48:51], s77 offen offset:1024 lds
    v_mfma_f32_16x16x32_bf16 v[92:95], a[224:227], a[108:111], v[92:95]
    ds_read_b64_tr_b16 a[246:247], v193 offset:51712
    v_mfma_f32_16x16x32_bf16 v[108:111], a[228:231], a[108:111], v[108:111]
    ds_read_b64_tr_b16 a[248:249], v194 offset:51200
    v_mfma_f32_16x16x32_bf16 v[104:107], a[228:231], a[104:107], v[104:107]
    ds_read_b64_tr_b16 a[250:251], v194 offset:51712
    v_mfma_f32_16x16x32_bf16 v[100:103], a[228:231], a[100:103], v[100:103]
    ds_read_b64_tr_b16 a[252:253], v195 offset:51200
    v_mfma_f32_16x16x32_bf16 v[96:99], a[228:231], a[96:99], v[96:99]
    ds_read_b64_tr_b16 a[254:255], v195 offset:51712
    s_waitcnt lgkmcnt(8)
    v_mfma_f32_16x16x32_bf16 v[112:115], a[232:235], a[96:99], v[112:115]
    v_mfma_f32_16x16x32_bf16 v[116:119], a[232:235], a[100:103], v[116:119]
    v_mfma_f32_16x16x32_bf16 v[120:123], a[232:235], a[104:107], v[120:123]
    buffer_load_dwordx4 v210, s[48:51], s77 offen offset:2048 lds
    v_mfma_f32_16x16x32_bf16 v[124:127], a[232:235], a[108:111], v[124:127]
    v_mfma_f32_16x16x32_bf16 v[140:143], a[236:239], a[108:111], v[140:143]
    v_mfma_f32_16x16x32_bf16 v[136:139], a[236:239], a[104:107], v[136:139]
    v_mfma_f32_16x16x32_bf16 v[132:135], a[236:239], a[100:103], v[132:135]
    v_mfma_f32_16x16x32_bf16 v[128:131], a[236:239], a[96:99], v[128:131]
    s_waitcnt vmcnt(16)
    s_barrier
    s_waitcnt lgkmcnt(4)
    v_mfma_f32_16x16x32_bf16 v[80:83], a[240:243], a[112:115], v[80:83]
    ds_read_b64_tr_b16 a[224:225], v196 offset:0
    v_mfma_f32_16x16x32_bf16 v[84:87], a[240:243], a[116:119], v[84:87]
    ds_read_b64_tr_b16 a[226:227], v196 offset:512
    v_mfma_f32_16x16x32_bf16 v[88:91], a[240:243], a[120:123], v[88:91]
    ds_read_b64_tr_b16 a[228:229], v197 offset:0
    buffer_load_dwordx4 v211, s[48:51], s77 offen offset:3072 lds
    v_mfma_f32_16x16x32_bf16 v[92:95], a[240:243], a[124:127], v[92:95]
    ds_read_b64_tr_b16 a[230:231], v197 offset:512
    v_mfma_f32_16x16x32_bf16 v[108:111], a[244:247], a[124:127], v[108:111]
    ds_read_b64_tr_b16 a[232:233], v198 offset:0
    v_mfma_f32_16x16x32_bf16 v[104:107], a[244:247], a[120:123], v[104:107]
    ds_read_b64_tr_b16 a[234:235], v198 offset:512
    v_mfma_f32_16x16x32_bf16 v[100:103], a[244:247], a[116:119], v[100:103]
    ds_read_b64_tr_b16 a[236:237], v199 offset:0
    v_mfma_f32_16x16x32_bf16 v[96:99], a[244:247], a[112:115], v[96:99]
    ds_read_b64_tr_b16 a[238:239], v199 offset:512
    s_waitcnt lgkmcnt(8)
    v_mfma_f32_16x16x32_bf16 v[112:115], a[248:251], a[112:115], v[112:115]
    v_mfma_f32_16x16x32_bf16 v[116:119], a[248:251], a[116:119], v[116:119]
    v_mfma_f32_16x16x32_bf16 v[120:123], a[248:251], a[120:123], v[120:123]
    s_add_u32 m0, s14, 65536
    s_add_u32 s78, s78, 128
    buffer_load_dwordx4 v208, s[48:51], s78 offen offset:0 lds
    v_mfma_f32_16x16x32_bf16 v[124:127], a[248:251], a[124:127], v[124:127]
    v_mfma_f32_16x16x32_bf16 v[140:143], a[252:255], a[124:127], v[140:143]
    v_mfma_f32_16x16x32_bf16 v[136:139], a[252:255], a[120:123], v[136:139]
    v_mfma_f32_16x16x32_bf16 v[132:135], a[252:255], a[116:119], v[132:135]
    v_mfma_f32_16x16x32_bf16 v[128:131], a[252:255], a[112:115], v[128:131]
    s_waitcnt vmcnt(5)
    s_barrier
    buffer_store_dwordx2 v[6:7], v4, s[52:55], s12 offen offset:0 sc1
    s_add_u32 s12, s12, 1024
    s_waitcnt lgkmcnt(4)
    v_mfma_f32_16x16x32_bf16 v[80:83], a[224:227], a[128:131], v[80:83]
    ds_read_b64_tr_b16 a[240:241], v196 offset:2048
    v_mfma_f32_16x16x32_bf16 v[84:87], a[224:227], a[132:135], v[84:87]
    ds_read_b64_tr_b16 a[242:243], v196 offset:2560
    v_mfma_f32_16x16x32_bf16 v[88:91], a[224:227], a[136:139], v[88:91]
    ds_read_b64_tr_b16 a[244:245], v197 offset:2048
    buffer_load_dwordx4 v209, s[48:51], s78 offen offset:1024 lds
    v_mfma_f32_16x16x32_bf16 v[92:95], a[224:227], a[140:143], v[92:95]
    ds_read_b64_tr_b16 a[246:247], v197 offset:2560
    v_mfma_f32_16x16x32_bf16 v[108:111], a[228:231], a[140:143], v[108:111]
    ds_read_b64_tr_b16 a[248:249], v198 offset:2048
    v_mfma_f32_16x16x32_bf16 v[104:107], a[228:231], a[136:139], v[104:107]
    ds_read_b64_tr_b16 a[250:251], v198 offset:2560
    v_mfma_f32_16x16x32_bf16 v[100:103], a[228:231], a[132:135], v[100:103]
    ds_read_b64_tr_b16 a[252:253], v199 offset:2048
    v_mfma_f32_16x16x32_bf16 v[96:99], a[228:231], a[128:131], v[96:99]
    ds_read_b64_tr_b16 a[254:255], v199 offset:2560
    s_waitcnt lgkmcnt(8)
    v_mfma_f32_16x16x32_bf16 v[112:115], a[232:235], a[128:131], v[112:115]
    v_mfma_f32_16x16x32_bf16 v[116:119], a[232:235], a[132:135], v[116:119]
    v_mfma_f32_16x16x32_bf16 v[120:123], a[232:235], a[136:139], v[120:123]
    buffer_load_dwordx4 v210, s[48:51], s78 offen offset:2048 lds
    v_mfma_f32_16x16x32_bf16 v[124:127], a[232:235], a[140:143], v[124:127]
    v_mfma_f32_16x16x32_bf16 v[140:143], a[236:239], a[140:143], v[140:143]
    v_mfma_f32_16x16x32_bf16 v[136:139], a[236:239], a[136:139], v[136:139]
    v_mfma_f32_16x16x32_bf16 v[132:135], a[236:239], a[132:135], v[132:135]
    v_mfma_f32_16x16x32_bf16 v[128:131], a[236:239], a[128:131], v[128:131]
    s_barrier
    s_waitcnt lgkmcnt(4)
    v_mfma_f32_16x16x32_bf16 v[80:83], a[240:243], a[144:147], v[80:83]
    ds_read_b64_tr_b16 a[224:225], v196 offset:16384
    v_cmp_ne_u64 vcc, s[42:43], v[14:15]
    s_nop 0
    s_cmp_eq_u64 vcc, 0
    s_cbranch_scc1 L_p5_ok
L_p5_retry:
    s_add_u32 s100, s100, 1
    s_cmp_gt_u32 s100, 200000
    s_cbranch_scc1 L_p5_ok
    s_sleep 2
    buffer_load_dwordx2 v[14:15], v1, s[52:55], s24 offen sc1
    s_waitcnt vmcnt(0)
    v_cmp_ne_u64 vcc, s[42:43], v[14:15]
    s_nop 0
    s_cmp_eq_u64 vcc, 0
    s_cbranch_scc0 L_p5_retry
L_p5_ok:
    v_mfma_f32_16x16x32_bf16 v[84:87], a[240:243], a[148:151], v[84:87]
    ds_read_b64_tr_b16 a[226:227], v196 offset:16896
    buffer_load_dwordx4 v[168:171], v230, s[52:55], s25 offen offset:0 sc1
    v_mfma_f32_16x16x32_bf16 v[88:91], a[240:243], a[152:155], v[88:91]
    ds_read_b64_tr_b16 a[228:229], v197 offset:16384
    buffer_load_dwordx4 v211, s[48:51], s78 offen offset:3072 lds
    v_mfma_f32_16x16x32_bf16 v[92:95], a[240:243], a[156:159], v[92:95]
    ds_read_b64_tr_b16 a[230:231], v197 offset:16896
    v_mfma_f32_16x16x32_bf16 v[108:111], a[244:247], a[156:159], v[108:111]
    ds_read_b64_tr_b16 a[232:233], v198 offset:16384
    v_mfma_f32_16x16x32_bf16 v[104:107], a[244:247], a[152:155], v[104:107]
    ds_read_b64_tr_b16 a[234:235], v198 offset:16896
    v_mfma_f32_16x16x32_bf16 v[100:103], a[244:247], a[148:151], v[100:103]
    ds_read_b64_tr_b16 a[236:237], v199 offset:16384
    v_mfma_f32_16x16x32_bf16 v[96:99], a[244:247], a[144:147], v[96:99]
    ds_read_b64_tr_b16 a[238:239], v199 offset:16896
    buffer_load_dwordx4 v[172:175], v230, s[52:55], s25 offen offset:64 sc1
    s_waitcnt lgkmcnt(8)
    v_mfma_f32_16x16x32_bf16 v[112:115], a[248:251], a[144:147], v[112:115]
    v_mfma_f32_16x16x32_bf16 v[116:119], a[248:251], a[148:151], v[116:119]
    v_mfma_f32_16x16x32_bf16 v[120:123], a[248:251], a[152:155], v[120:123]
    s_add_u32 m0, s14, 81920
    s_add_u32 s79, s79, 128
    buffer_load_dwordx4 v208, s[48:51], s79 offen offset:0 lds
    v_mfma_f32_16x16x32_bf16 v[124:127], a[248:251], a[156:159], v[124:127]
    v_mfma_f32_16x16x32_bf16 v[140:143], a[252:255], a[156:159], v[140:143]
    v_mfma_f32_16x16x32_bf16 v[136:139], a[252:255], a[152:155], v[136:139]
    buffer_load_dwordx4 v[152:155], v230, s[52:55], s26 offen offset:0 sc1
    v_mfma_f32_16x16x32_bf16 v[132:135], a[252:255], a[148:151], v[132:135]
    v_mfma_f32_16x16x32_bf16 v[128:131], a[252:255], a[144:147], v[128:131]
    s_waitcnt lgkmcnt(4)
    v_mfma_f32_16x16x32_bf16 v[80:83], a[224:227], a[160:163], v[80:83]
    ds_read_b64_tr_b16 a[240:241], v196 offset:18432
    v_mfma_f32_16x16x32_bf16 v[84:87], a[224:227], a[164:167], v[84:87]
    ds_read_b64_tr_b16 a[242:243], v196 offset:18944
    v_mfma_f32_16x16x32_bf16 v[88:91], a[224:227], a[168:171], v[88:91]
    ds_read_b64_tr_b16 a[244:245], v197 offset:18432
    buffer_load_dwordx4 v209, s[48:51], s79 offen offset:1024 lds
    v_mfma_f32_16x16x32_bf16 v[92:95], a[224:227], a[172:175], v[92:95]
    ds_read_b64_tr_b16 a[246:247], v197 offset:18944
    buffer_load_dwordx4 v[156:159], v230, s[52:55], s26 offen offset:64 sc1
    v_mfma_f32_16x16x32_bf16 v[108:111], a[228:231], a[172:175], v[108:111]
    ds_read_b64_tr_b16 a[248:249], v198 offset:18432
    v_mfma_f32_16x16x32_bf16 v[104:107], a[228:231], a[168:171], v[104:107]
    ds_read_b64_tr_b16 a[250:251], v198 offset:18944
    v_mfma_f32_16x16x32_bf16 v[100:103], a[228:231], a[164:167], v[100:103]
    ds_read_b64_tr_b16 a[252:253], v199 offset:18432
    v_mfma_f32_16x16x32_bf16 v[96:99], a[228:231], a[160:163], v[96:99]
    ds_read_b64_tr_b16 a[254:255], v199 offset:18944
    s_waitcnt lgkmcnt(8)
    v_mfma_f32_16x16x32_bf16 v[112:115], a[232:235], a[160:163], v[112:115]
    v_mfma_f32_16x16x32_bf16 v[116:119], a[232:235], a[164:167], v[116:119]
    v_mfma_f32_16x16x32_bf16 v[120:123], a[232:235], a[168:171], v[120:123]
    buffer_load_dwordx4 v210, s[48:51], s79 offen offset:2048 lds
    v_mfma_f32_16x16x32_bf16 v[124:127], a[232:235], a[172:175], v[124:127]
    v_mfma_f32_16x16x32_bf16 v[140:143], a[236:239], a[172:175], v[140:143]
    v_mfma_f32_16x16x32_bf16 v[136:139], a[236:239], a[168:171], v[136:139]
    v_mfma_f32_16x16x32_bf16 v[132:135], a[236:239], a[164:167], v[132:135]
    v_mfma_f32_16x16x32_bf16 v[128:131], a[236:239], a[160:163], v[128:131]
    s_barrier
    s_waitcnt lgkmcnt(4)
    v_mfma_f32_16x16x32_bf16 v[80:83], a[240:243], a[176:179], v[80:83]
    ds_read_b64_tr_b16 a[224:225], v196 offset:32768
    v_mfma_f32_16x16x32_bf16 v[84:87], a[240:243], a[180:183], v[84:87]
    ds_read_b64_tr_b16 a[226:227], v196 offset:33280
    v_mfma_f32_16x16x32_bf16 v[88:91], a[240:243], a[184:187], v[88:91]
    ds_read_b64_tr_b16 a[228:229], v197 offset:32768
    buffer_load_dwordx4 v211, s[48:51], s79 offen offset:3072 lds
    v_mfma_f32_16x16x32_bf16 v[92:95], a[240:243], a[188:191], v[92:95]
    ds_read_b64_tr_b16 a[230:231], v197 offset:33280
    v_mfma_f32_16x16x32_bf16 v[108:111], a[244:247], a[188:191], v[108:111]
    ds_read_b64_tr_b16 a[232:233], v198 offset:32768
    v_mfma_f32_16x16x32_bf16 v[104:107], a[244:247], a[184:187], v[104:107]
    ds_read_b64_tr_b16 a[234:235], v198 offset:33280
    v_mfma_f32_16x16x32_bf16 v[100:103], a[244:247], a[180:183], v[100:103]
    ds_read_b64_tr_b16 a[236:237], v199 offset:32768
    v_mfma_f32_16x16x32_bf16 v[96:99], a[244:247], a[176:179], v[96:99]
    ds_read_b64_tr_b16 a[238:239], v199 offset:33280
    s_waitcnt lgkmcnt(8)
    v_mfma_f32_16x16x32_bf16 v[112:115], a[248:251], a[176:179], v[112:115]
    v_mfma_f32_16x16x32_bf16 v[116:119], a[248:251], a[180:183], v[116:119]
    v_mfma_f32_16x16x32_bf16 v[120:123], a[248:251], a[184:187], v[120:123]
    s_add_u32 m0, s14, 98304
    s_add_u32 s80, s80, 128
    buffer_load_dwordx4 v208, s[48:51], s80 offen offset:0 lds
    v_mfma_f32_16x16x32_bf16 v[124:127], a[248:251], a[188:191], v[124:127]
    v_mfma_f32_16x16x32_bf16 v[140:143], a[252:255], a[188:191], v[140:143]
    v_mfma_f32_16x16x32_bf16 v[136:139], a[252:255], a[184:187], v[136:139]
    v_mfma_f32_16x16x32_bf16 v[132:135], a[252:255], a[180:183], v[132:135]
    v_mfma_f32_16x16x32_bf16 v[128:131], a[252:255], a[176:179], v[128:131]
    s_waitcnt lgkmcnt(4)
    v_mfma_f32_16x16x32_bf16 v[80:83], a[224:227], a[192:195], v[80:83]
    ds_read_b64_tr_b16 a[240:241], v196 offset:34816
    v_mfma_f32_16x16x32_bf16 v[84:87], a[224:227], a[196:199], v[84:87]
    ds_read_b64_tr_b16 a[242:243], v196 offset:35328
    v_mfma_f32_16x16x32_bf16 v[88:91], a[224:227], a[200:203], v[88:91]
    ds_read_b64_tr_b16 a[244:245], v197 offset:34816
    buffer_load_dwordx4 v209, s[48:51], s80 offen offset:1024 lds
    v_mfma_f32_16x16x32_bf16 v[92:95], a[224:227], a[204:207], v[92:95]
    ds_read_b64_tr_b16 a[246:247], v197 offset:35328
    v_mfma_f32_16x16x32_bf16 v[108:111], a[228:231], a[204:207], v[108:111]
    ds_read_b64_tr_b16 a[248:249], v198 offset:34816
    v_mfma_f32_16x16x32_bf16 v[104:107], a[228:231], a[200:203], v[104:107]
    ds_read_b64_tr_b16 a[250:251], v198 offset:35328
    v_mfma_f32_16x16x32_bf16 v[100:103], a[228:231], a[196:199], v[100:103]
    ds_read_b64_tr_b16 a[252:253], v199 offset:34816
    v_mfma_f32_16x16x32_bf16 v[96:99], a[228:231], a[192:195], v[96:99]
    ds_read_b64_tr_b16 a[254:255], v199 offset:35328
    s_waitcnt lgkmcnt(8)
    v_mfma_f32_16x16x32_bf16 v[112:115], a[232:235], a[192:195], v[112:115]
    v_mfma_f32_16x16x32_bf16 v[116:119], a[232:235], a[196:199], v[116:119]
    v_mfma_f32_16x16x32_bf16 v[120:123], a[232:235], a[200:203], v[120:123]
    buffer_load_dwordx4 v210, s[48:51], s80 offen offset:2048 lds
    v_mfma_f32_16x16x32_bf16 v[124:127], a[232:235], a[204:207], v[124:127]
    v_mfma_f32_16x16x32_bf16 v[140:143], a[236:239], a[204:207], v[140:143]
    v_mfma_f32_16x16x32_bf16 v[136:139], a[236:239], a[200:203], v[136:139]
    v_mfma_f32_16x16x32_bf16 v[132:135], a[236:239], a[196:199], v[132:135]
    v_mfma_f32_16x16x32_bf16 v[128:131], a[236:239], a[192:195], v[128:131]
    s_waitcnt vmcnt(16)
    s_barrier
    s_waitcnt lgkmcnt(4)
    v_mfma_f32_16x16x32_bf16 v[80:83], a[240:243], a[208:211], v[80:83]
    ds_read_b64_tr_b16 a[224:225], v192 offset:0
    v_mfma_f32_16x16x32_bf16 v[84:87], a[240:243], a[212:215], v[84:87]
    ds_read_b64_tr_b16 a[226:227], v192 offset:512
    v_mfma_f32_16x16x32_bf16 v[88:91], a[240:243], a[216:219], v[88:91]
    ds_read_b64_tr_b16 a[228:229], v193 offset:0
    buffer_load_dwordx4 v211, s[48:51], s80 offen offset:3072 lds
    v_mfma_f32_16x16x32_bf16 v[92:95], a[240:243], a[220:223], v[92:95]
    ds_read_b64_tr_b16 a[230:231], v193 offset:512
    v_mfma_f32_16x16x32_bf16 v[108:111], a[244:247], a[220:223], v[108:111]
    ds_read_b64_tr_b16 a[232:233], v194 offset:0
    v_mfma_f32_16x16x32_bf16 v[104:107], a[244:247], a[216:219], v[104:107]
    ds_read_b64_tr_b16 a[234:235], v194 offset:512
    v_mfma_f32_16x16x32_bf16 v[100:103], a[244:247], a[212:215], v[100:103]
    ds_read_b64_tr_b16 a[236:237], v195 offset:0
    v_mfma_f32_16x16x32_bf16 v[96:99], a[244:247], a[208:211], v[96:99]
    ds_read_b64_tr_b16 a[238:239], v195 offset:512
    s_waitcnt lgkmcnt(8)
    v_mfma_f32_16x16x32_bf16 v[112:115], a[248:251], a[208:211], v[112:115]
    v_mfma_f32_16x16x32_bf16 v[116:119], a[248:251], a[212:215], v[116:119]
    v_mfma_f32_16x16x32_bf16 v[120:123], a[248:251], a[216:219], v[120:123]
    s_add_u32 m0, s14, 114688
    s_add_u32 s81, s81, 128
    buffer_load_dwordx4 v208, s[48:51], s81 offen offset:0 lds
    v_mfma_f32_16x16x32_bf16 v[124:127], a[248:251], a[220:223], v[124:127]
    v_mfma_f32_16x16x32_bf16 v[140:143], a[252:255], a[220:223], v[140:143]
    v_mfma_f32_16x16x32_bf16 v[136:139], a[252:255], a[216:219], v[136:139]
    v_mfma_f32_16x16x32_bf16 v[132:135], a[252:255], a[212:215], v[132:135]
    v_mfma_f32_16x16x32_bf16 v[128:131], a[252:255], a[208:211], v[128:131]
    s_waitcnt lgkmcnt(4)
    v_mfma_f32_16x16x32_bf16 v[16:19], a[224:227], a[0:3], 0
    ds_read_b64_tr_b16 a[240:241], v192 offset:2048
    v_mfma_f32_16x16x32_bf16 v[20:23], a[224:227], a[4:7], 0
    ds_read_b64_tr_b16 a[242:243], v192 offset:2560
    v_mfma_f32_16x16x32_bf16 v[24:27], a[224:227], a[8:11], 0
    ds_read_b64_tr_b16 a[244:245], v193 offset:2048
    buffer_load_dwordx4 v209, s[48:51], s81 offen offset:1024 lds
    s_waitcnt vmcnt(8)
    v_fma_f32 v80, -v160, v168, v80
    v_mfma_f32_16x16x32_bf16 v[28:31], a[224:227], a[12:15], 0
    ds_read_b64_tr_b16 a[246:247], v193 offset:2560
    v_fma_f32 v81, -v160, v169, v81
    v_fma_f32 v82, -v160, v170, v82
    v_mfma_f32_16x16x32_bf16 v[44:47], a[228:231], a[12:15], 0
    ds_read_b64_tr_b16 a[248:249], v194 offset:2048
    v_fma_f32 v83, -v160, v171, v83
    v_fma_f32 v96, -v160, v172, v96
    v_mfma_f32_16x16x32_bf16 v[40:43], a[228:231], a[8:11], 0
    ds_read_b64_tr_b16 a[250:251], v194 offset:2560
    v_fma_f32 v97, -v160, v173, v97
    v_fma_f32 v98, -v160, v174, v98
    v_mfma_f32_16x16x32_bf16 v[36:39], a[228:231], a[4:7], 0
    ds_read_b64_tr_b16 a[252:253], v195 offset:2048
    v_fma_f32 v99, -v160, v175, v99
    v_fma_f32 v112, -v160, v152, v112
    v_mfma_f32_16x16x32_bf16 v[32:35], a[228:231], a[0:3], 0
    ds_read_b64_tr_b16 a[254:255], v195 offset:2560
    v_fma_f32 v113, -v160, v153, v113
    v_fma_f32 v114, -v160, v154, v114
    s_waitcnt lgkmcnt(8)
    v_mfma_f32_16x16x32_bf16 v[48:51], a[232:235], a[0:3], 0
    v_fma_f32 v115, -v160, v155, v115
    v_fma_f32 v128, -v160, v156, v128
    v_mfma_f32_16x16x32_bf16 v[52:55], a[232:235], a[4:7], 0
    v_fma_f32 v129, -v160, v157, v129
    v_fma_f32 v130, -v160, v158, v130
    v_mfma_f32_16x16x32_bf16 v[56:59], a[232:235], a[8:11], 0
    buffer_load_dwordx4 v210, s[48:51], s81 offen offset:2048 lds
    v_fma_f32 v131, -v160, v159, v131
    v_mul_f32 v80, v80, v112
    v_mfma_f32_16x16x32_bf16 v[60:63], a[232:235], a[12:15], 0
    v_mul_f32 v81, v81, v113
    v_mul_f32 v82, v82, v114
    v_mfma_f32_16x16x32_bf16 v[76:79], a[236:239], a[12:15], 0
    v_mul_f32 v83, v83, v115
    v_mul_f32 v96, v96, v128
    v_mfma_f32_16x16x32_bf16 v[72:75], a[236:239], a[8:11], 0
    v_mul_f32 v97, v97, v129
    v_mul_f32 v98, v98, v130
    v_mfma_f32_16x16x32_bf16 v[68:71], a[236:239], a[4:7], 0
    v_mul_f32 v99, v99, v131
    v_cvt_pk_bf16_f32 v112, v80, v81
    v_mfma_f32_16x16x32_bf16 v[64:67], a[236:239], a[0:3], 0
    v_cvt_pk_bf16_f32 v113, v82, v83
    v_cvt_pk_bf16_f32 v114, v96, v97
    s_barrier
    s_waitcnt lgkmcnt(4)
    v_mfma_f32_16x16x32_bf16 v[16:19], a[240:243], a[16:19], v[16:19]
    ds_read_b64_tr_b16 a[224:225], v192 offset:16384
    v_cvt_pk_bf16_f32 v115, v98, v99
    s_xor_b32 s101, s13, 0
    s_add_u32 s101, s101, 8192
    buffer_store_dwordx4 v[112:115], v3, s[52:55], s101 offen offset:0 sc1
    v_mfma_f32_16x16x32_bf16 v[20:23], a[240:243], a[20:23], v[20:23]
    ds_read_b64_tr_b16 a[226:227], v192 offset:16896
    v_fma_f32 v84, -v161, v168, v84
    v_mfma_f32_16x16x32_bf16 v[24:27], a[240:243], a[24:27], v[24:27]
    ds_read_b64_tr_b16 a[228:229], v193 offset:16384
    buffer_load_dwordx4 v211, s[48:51], s81 offen offset:3072 lds
    v_fma_f32 v85, -v161, v169, v85
    v_fma_f32 v86, -v161, v170, v86
    v_mfma_f32_16x16x32_bf16 v[28:31], a[240:243], a[28:31], v[28:31]
    ds_read_b64_tr_b16 a[230:231], v193 offset:16896
    v_fma_f32 v87, -v161, v171, v87
    v_fma_f32 v100, -v161, v172, v100
    v_mfma_f32_16x16x32_bf16 v[44:47], a[244:247], a[28:31], v[44:47]
    ds_read_b64_tr_b16 a[232:233], v194 offset:16384
    v_fma_f32 v101, -v161, v173, v101
    v_fma_f32 v102, -v161, v174, v102
    v_mfma_f32_16x16x32_bf16 v[40:43], a[244:247], a[24:27], v[40:43]
    ds_read_b64_tr_b16 a[234:235], v194 offset:16896
    v_fma_f32 v103, -v161, v175, v103
    v_fma_f32 v116, -v161, v152, v116
    v_mfma_f32_16x16x32_bf16 v[36:39], a[244:247], a[20:23], v[36:39]
    ds_read_b64_tr_b16 a[236:237], v195 offset:16384
    v_fma_f32 v117, -v161, v153, v117
    v_fma_f32 v118, -v161, v154, v118
    v_mfma_f32_16x16x32_bf16 v[32:35], a[244:247], a[16:19], v[32:35]
    ds_read_b64_tr_b16 a[238:239], v195 offset:16896
    v_fma_f32 v119, -v161, v155, v119
    v_fma_f32 v132, -v161, v156, v132
    s_waitcnt lgkmcnt(8)
    v_mfma_f32_16x16x32_bf16 v[48:51], a[248:251], a[16:19], v[48:51]
    v_fma_f32 v133, -v161, v157, v133
    v_fma_f32 v134, -v161, v158, v134
    v_mfma_f32_16x16x32_bf16 v[52:55], a[248:251], a[20:23], v[52:55]
    v_fma_f32 v135, -v161, v159, v135
    v_mul_f32 v84, v84, v116
    v_mfma_f32_16x16x32_bf16 v[56:59], a[248:251], a[24:27], v[56:59]
    s_add_u32 m0, s14, 131072
    s_add_u32 s82, s82, 128
    buffer_load_dwordx4 v208, s[48:51], s82 offen offset:0 lds
    v_mul_f32 v85, v85, v117
    v_mul_f32 v86, v86, v118
    v_mfma_f32_16x16x32_bf16 v[60:63], a[248:251], a[28:31], v[60:63]
    v_mul_f32 v87, v87, v119
    v_mul_f32 v100, v100, v132
    v_mfma_f32_16x16x32_bf16 v[76:79], a[252:255], a[28:31], v[76:79]
    v_mul_f32 v101, v101, v133
    v_mul_f32 v102, v102, v134
    v_mfma_f32_16x16x32_bf16 v[72:75], a[252:255], a[24:27], v[72:75]
    v_mul_f32 v103, v103, v135
    v_cvt_pk_bf16_f32 v116, v84, v85
    v_mfma_f32_16x16x32_bf16 v[68:71], a[252:255], a[20:23], v[68:71]
    v_cvt_pk_bf16_f32 v117, v86, v87
    v_cvt_pk_bf16_f32 v118, v100, v101
    v_mfma_f32_16x16x32_bf16 v[64:67], a[252:255], a[16:19], v[64:67]
    v_cvt_pk_bf16_f32 v119, v102, v103
    s_xor_b32 s101, s13, 0
    s_add_u32 s101, s101, 8192
    buffer_store_dwordx4 v[116:119], v3, s[52:55], s101 offen offset:1024 sc1
    s_waitcnt lgkmcnt(4)
    v_mfma_f32_16x16x32_bf16 v[16:19], a[224:227], a[32:35], v[16:19]
    ds_read_b64_tr_b16 a[240:241], v192 offset:18432
    v_fma_f32 v88, -v162, v168, v88
    v_mfma_f32_16x16x32_bf16 v[20:23], a[224:227], a[36:39], v[20:23]
    ds_read_b64_tr_b16 a[242:243], v192 offset:18944
    v_fma_f32 v89, -v162, v169, v89
    v_fma_f32 v90, -v162, v170, v90
    v_mfma_f32_16x16x32_bf16 v[24:27], a[224:227], a[40:43], v[24:27]
    ds_read_b64_tr_b16 a[244:245], v193 offset:18432
    buffer_load_dwordx4 v209, s[48:51], s82 offen offset:1024 lds
    v_fma_f32 v91, -v162, v171, v91
    v_fma_f32 v104, -v162, v172, v104
    v_mfma_f32_16x16x32_bf16 v[28:31], a[224:227], a[44:47], v[28:31]
    ds_read_b64_tr_b16 a[246:247], v193 offset:18944
    v_fma_f32 v105, -v162, v173, v105
    v_fma_f32 v106, -v162, v174, v106
    v_mfma_f32_16x16x32_bf16 v[44:47], a[228:231], a[44:47], v[44:47]
    ds_read_b64_tr_b16 a[248:249], v194 offset:18432
    v_fma_f32 v107, -v162, v175, v107
    v_fma_f32 v120, -v162, v152, v120
    v_mfma_f32_16x16x32_bf16 v[40:43], a[228:231], a[40:43], v[40:43]
    ds_read_b64_tr_b16 a[250:251], v194 offset:18944
    v_fma_f32 v121, -v162, v153, v121
    v_fma_f32 v122, -v162, v154, v122
    v_mfma_f32_16x16x32_bf16 v[36:39], a[228:231], a[36:39], v[36:39]
    ds_read_b64_tr_b16 a[252:253], v195 offset:18432
    v_fma_f32 v123, -v162, v155, v123
    v_fma_f32 v136, -v162, v156, v136
    v_mfma_f32_16x16x32_bf16 v[32:35], a[228:231], a[32:35], v[32:35]
    ds_read_b64_tr_b16 a[254:255], v195 offset:18944
    v_fma_f32 v137, -v162, v157, v137
    v_fma_f32 v138, -v162, v158, v138
    s_waitcnt lgkmcnt(8)
    v_mfma_f32_16x16x32_bf16 v[48:51], a[232:235], a[32:35], v[48:51]
    v_fma_f32 v139, -v162, v159, v139
    v_mul_f32 v88, v88, v120
    v_mfma_f32_16x16x32_bf16 v[52:55], a[232:235], a[36:39], v[52:55]
    v_mul_f32 v89, v89, v121
    v_mul_f32 v90, v90, v122
    v_mfma_f32_16x16x32_bf16 v[56:59], a[232:235], a[40:43], v[56:59]
    buffer_load_dwordx4 v210, s[48:51], s82 offen offset:2048 lds
    v_mul_f32 v91, v91, v123
    v_mul_f32 v104, v104, v136
    v_mfma_f32_16x16x32_bf16 v[60:63], a[232:235], a[44:47], v[60:63]
    v_mul_f32 v105, v105, v137
    v_mul_f32 v106, v106, v138
    v_mfma_f32_16x16x32_bf16 v[76:79], a[236:239], a[44:47], v[76:79]
    v_mul_f32 v107, v107, v139
    v_cvt_pk_bf16_f32 v120, v88, v89
    v_mfma_f32_16x16x32_bf16 v[72:75], a[236:239], a[40:43], v[72:75]
    v_cvt_pk_bf16_f32 v121, v90, v91
    v_cvt_pk_bf16_f32 v122, v104, v105
    v_mfma_f32_16x16x32_bf16 v[68:71], a[236:239], a[36:39], v[68:71]
    v_cvt_pk_bf16_f32 v123, v106, v107
    s_xor_b32 s101, s13, 2048
    s_add_u32 s101, s101, 8192
    buffer_store_dwordx4 v[120:123], v3, s[52:55], s101 offen offset:0 sc1
    v_mfma_f32_16x16x32_bf16 v[64:67], a[236:239], a[32:35], v[64:67]
    v_fma_f32 v92, -v163, v168, v92
    s_waitcnt vmcnt(14)
    s_barrier
    s_waitcnt lgkmcnt(4)
    v_mfma_f32_16x16x32_bf16 v[16:19], a[240:243], a[48:51], v[16:19]
    ds_read_b64_tr_b16 a[224:225], v192 offset:32768
    v_fma_f32 v93, -v163, v169, v93
    v_fma_f32 v94, -v163, v170, v94
    v_mfma_f32_16x16x32_bf16 v[20:23], a[240:243], a[52:55], v[20:23]
    ds_read_b64_tr_b16 a[226:227], v192 offset:33280
    v_fma_f32 v95, -v163, v171, v95
    v_fma_f32 v108, -v163, v172, v108
    v_mfma_f32_16x16x32_bf16 v[24:27], a[240:243], a[56:59], v[24:27]
    ds_read_b64_tr_b16 a[228:229], v193 offset:32768
    buffer_load_dwordx4 v211, s[48:51], s82 offen offset:3072 lds
    v_fma_f32 v109, -v163, v173, v109
    v_fma_f32 v110, -v163, v174, v110
    v_mfma_f32_16x16x32_bf16 v[28:31], a[240:243], a[60:63], v[28:31]
    ds_read_b64_tr_b16 a[230:231], v193 offset:33280
    v_fma_f32 v111, -v163, v175, v111
    v_fma_f32 v124, -v163, v152, v124
    v_mfma_f32_16x16x32_bf16 v[44:47], a[244:247], a[60:63], v[44:47]
    ds_read_b64_tr_b16 a[232:233], v194 offset:32768
    v_fma_f32 v125, -v163, v153, v125
    v_fma_f32 v126, -v163, v154, v126
    v_mfma_f32_16x16x32_bf16 v[40:43], a[244:247], a[56:59], v[40:43]
    ds_read_b64_tr_b16 a[234:235], v194 offset:33280
    v_fma_f32 v127, -v163, v155, v127
    v_fma_f32 v140, -v163, v156, v140
    v_mfma_f32_16x16x32_bf16 v[36:39], a[244:247], a[52:55], v[36:39]
    ds_read_b64_tr_b16 a[236:237], v195 offset:32768
    v_fma_f32 v141, -v163, v157, v141
    v_fma_f32 v142, -v163, v158, v142
    v_mfma_f32_16x16x32_bf16 v[32:35], a[244:247], a[48:51], v[32:35]
    ds_read_b64_tr_b16 a[238:239], v195 offset:33280
    v_fma_f32 v143, -v163, v159, v143
    v_mul_f32 v92, v92, v124
    s_waitcnt lgkmcnt(8)
    v_mfma_f32_16x16x32_bf16 v[48:51], a[248:251], a[48:51], v[48:51]
    v_mul_f32 v93, v93, v125
    v_mul_f32 v94, v94, v126
    v_mfma_f32_16x16x32_bf16 v[52:55], a[248:251], a[52:55], v[52:55]
    v_mul_f32 v95, v95, v127
    v_mul_f32 v108, v108, v140
    v_mfma_f32_16x16x32_bf16 v[56:59], a[248:251], a[56:59], v[56:59]
    s_add_u32 m0, s14, 147456
    s_add_u32 s83, s83, 128
    buffer_load_dwordx4 v208, s[48:51], s83 offen offset:0 lds
    v_mul_f32 v109, v109, v141
    v_mul_f32 v110, v110, v142
    v_mfma_f32_16x16x32_bf16 v[60:63], a[248:251], a[60:63], v[60:63]
    v_mul_f32 v111, v111, v143
    v_cvt_pk_bf16_f32 v124, v92, v93
    v_mfma_f32_16x16x32_bf16 v[76:79], a[252:255], a[60:63], v[76:79]
    v_cvt_pk_bf16_f32 v125, v94, v95
    v_cvt_pk_bf16_f32 v126, v108, v109
    v_mfma_f32_16x16x32_bf16 v[72:75], a[252:255], a[56:59], v[72:75]
    v_cvt_pk_bf16_f32 v127, v110, v111
    s_xor_b32 s101, s13, 2048
    s_add_u32 s101, s101, 8192
    buffer_store_dwordx4 v[124:127], v3, s[52:55], s101 offen offset:1024 sc1
    v_mfma_f32_16x16x32_bf16 v[68:71], a[252:255], a[52:55], v[68:71]
    v_mfma_f32_16x16x32_bf16 v[64:67], a[252:255], a[48:51], v[64:67]
    s_waitcnt lgkmcnt(4)
    v_mfma_f32_16x16x32_bf16 v[16:19], a[224:227], a[64:67], v[16:19]
    ds_read_b64_tr_b16 a[240:241], v192 offset:34816
    v_mfma_f32_16x16x32_bf16 v[20:23], a[224:227], a[68:71], v[20:23]
    ds_read_b64_tr_b16 a[242:243], v192 offset:35328
    v_mfma_f32_16x16x32_bf16 v[24:27], a[224:227], a[72:75], v[24:27]
    ds_read_b64_tr_b16 a[244:245], v193 offset:34816
    buffer_load_dwordx4 v209, s[48:51], s83 offen offset:1024 lds
    v_mfma_f32_16x16x32_bf16 v[28:31], a[224:227], a[76:79], v[28:31]
    ds_read_b64_tr_b16 a[246:247], v193 offset:35328
    v_mfma_f32_16x16x32_bf16 v[44:47], a[228:231], a[76:79], v[44:47]
    ds_read_b64_tr_b16 a[248:249], v194 offset:34816
    v_mfma_f32_16x16x32_bf16 v[40:43], a[228:231], a[72:75], v[40:43]
    ds_read_b64_tr_b16 a[250:251], v194 offset:35328
    v_mfma_f32_16x16x32_bf16 v[36:39], a[228:231], a[68:71], v[36:39]
    ds_read_b64_tr_b16 a[252:253], v195 offset:34816
    v_mfma_f32_16x16x32_bf16 v[32:35], a[228:231], a[64:67], v[32:35]
    ds_read_b64_tr_b16 a[254:255], v195 offset:35328
    s_waitcnt lgkmcnt(8)
    v_mfma_f32_16x16x32_bf16 v[48:51], a[232:235], a[64:67], v[48:51]
    v_mfma_f32_16x16x32_bf16 v[52:55], a[232:235], a[68:71], v[52:55]
    v_mfma_f32_16x16x32_bf16 v[56:59], a[232:235], a[72:75], v[56:59]
    buffer_load_dwordx4 v210, s[48:51], s83 offen offset:2048 lds
    v_mfma_f32_16x16x32_bf16 v[60:63], a[232:235], a[76:79], v[60:63]
    v_mfma_f32_16x16x32_bf16 v[76:79], a[236:239], a[76:79], v[76:79]
    v_mfma_f32_16x16x32_bf16 v[72:75], a[236:239], a[72:75], v[72:75]
    v_mfma_f32_16x16x32_bf16 v[68:71], a[236:239], a[68:71], v[68:71]
    v_mfma_f32_16x16x32_bf16 v[64:67], a[236:239], a[64:67], v[64:67]
    s_waitcnt vmcnt(15)
    s_barrier
    s_waitcnt lgkmcnt(4)
    v_mfma_f32_16x16x32_bf16 v[16:19], a[240:243], a[80:83], v[16:19]
    ds_read_b64_tr_b16 a[224:225], v192 offset:49152
    v_mfma_f32_16x16x32_bf16 v[20:23], a[240:243], a[84:87], v[20:23]
    ds_read_b64_tr_b16 a[226:227], v192 offset:49664
    v_mfma_f32_16x16x32_bf16 v[24:27], a[240:243], a[88:91], v[24:27]
    ds_read_b64_tr_b16 a[228:229], v193 offset:49152
    buffer_load_dwordx4 v211, s[48:51], s83 offen offset:3072 lds
    v_mfma_f32_16x16x32_bf16 v[28:31], a[240:243], a[92:95], v[28:31]
    ds_read_b64_tr_b16 a[230:231], v193 offset:49664
    v_mfma_f32_16x16x32_bf16 v[44:47], a[244:247], a[92:95], v[44:47]
    ds_read_b64_tr_b16 a[232:233], v194 offset:49152
    v_mfma_f32_16x16x32_bf16 v[40:43], a[244:247], a[88:91], v[40:43]
    ds_read_b64_tr_b16 a[234:235], v194 offset:49664
    v_mfma_f32_16x16x32_bf16 v[36:39], a[244:247], a[84:87], v[36:39]
    ds_read_b64_tr_b16 a[236:237], v195 offset:49152
    v_mfma_f32_16x16x32_bf16 v[32:35], a[244:247], a[80:83], v[32:35]
    ds_read_b64_tr_b16 a[238:239], v195 offset:49664
    s_waitcnt lgkmcnt(8)
    v_mfma_f32_16x16x32_bf16 v[48:51], a[248:251], a[80:83], v[48:51]
    v_mfma_f32_16x16x32_bf16 v[52:55], a[248:251], a[84:87], v[52:55]
    v_mfma_f32_16x16x32_bf16 v[56:59], a[248:251], a[88:91], v[56:59]
    s_add_u32 m0, s14, 49152
    s_add_u32 s77, s77, s9
    buffer_load_dwordx4 v208, s[48:51], s77 offen offset:0 lds
    v_mfma_f32_16x16x32_bf16 v[60:63], a[248:251], a[92:95], v[60:63]
    v_mfma_f32_16x16x32_bf16 v[76:79], a[252:255], a[92:95], v[76:79]
    v_mfma_f32_16x16x32_bf16 v[72:75], a[252:255], a[88:91], v[72:75]
    v_mfma_f32_16x16x32_bf16 v[68:71], a[252:255], a[84:87], v[68:71]
    v_mfma_f32_16x16x32_bf16 v[64:67], a[252:255], a[80:83], v[64:67]
    s_waitcnt lgkmcnt(4)
    v_mfma_f32_16x16x32_bf16 v[16:19], a[224:227], a[96:99], v[16:19]
    ds_read_b64_tr_b16 a[240:241], v192 offset:51200
    buffer_load_dwordx2 v[14:15], v1, s[52:55], s24 offen offset:2048 sc1
    v_mfma_f32_16x16x32_bf16 v[20:23], a[224:227], a[100:103], v[20:23]
    ds_read_b64_tr_b16 a[242:243], v192 offset:51712
    v_mfma_f32_16x16x32_bf16 v[24:27], a[224:227], a[104:107], v[24:27]
    ds_read_b64_tr_b16 a[244:245], v193 offset:51200
    buffer_load_dwordx4 v209, s[48:51], s77 offen offset:1024 lds
    v_mfma_f32_16x16x32_bf16 v[28:31], a[224:227], a[108:111], v[28:31]
    ds_read_b64_tr_b16 a[246:247], v193 offset:51712
    v_mfma_f32_16x16x32_bf16 v[44:47], a[228:231], a[108:111], v[44:47]
    ds_read_b64_tr_b16 a[248:249], v194 offset:51200
    v_mfma_f32_16x16x32_bf16 v[40:43], a[228:231], a[104:107], v[40:43]
    ds_read_b64_tr_b16 a[250:251], v194 offset:51712
    v_mfma_f32_16x16x32_bf16 v[36:39], a[228:231], a[100:103], v[36:39]
    ds_read_b64_tr_b16 a[252:253], v195 offset:51200
    v_mfma_f32_16x16x32_bf16 v[32:35], a[228:231], a[96:99], v[32:35]
    ds_read_b64_tr_b16 a[254:255], v195 offset:51712
    s_waitcnt lgkmcnt(8)
    v_mfma_f32_16x16x32_bf16 v[48:51], a[232:235], a[96:99], v[48:51]
    v_mfma_f32_16x16x32_bf16 v[52:55], a[232:235], a[100:103], v[52:55]
    v_mfma_f32_16x16x32_bf16 v[56:59], a[232:235], a[104:107], v[56:59]
    buffer_load_dwordx4 v210, s[48:51], s77 offen offset:2048 lds
    v_mfma_f32_16x16x32_bf16 v[60:63], a[232:235], a[108:111], v[60:63]
    v_mfma_f32_16x16x32_bf16 v[76:79], a[236:239], a[108:111], v[76:79]
    v_mfma_f32_16x16x32_bf16 v[72:75], a[236:239], a[104:107], v[72:75]
    v_mfma_f32_16x16x32_bf16 v[68:71], a[236:239], a[100:103], v[68:71]
    v_mfma_f32_16x16x32_bf16 v[64:67], a[236:239], a[96:99], v[64:67]
    s_waitcnt vmcnt(7)
    s_barrier
    buffer_store_dwordx2 v[6:7], v4, s[52:55], s12 offen offset:0 sc1
    s_add_u32 s12, s12, 1024
    s_waitcnt lgkmcnt(4)
    v_mfma_f32_16x16x32_bf16 v[16:19], a[240:243], a[112:115], v[16:19]
    ds_read_b64_tr_b16 a[224:225], v196 offset:0
    v_mfma_f32_16x16x32_bf16 v[20:23], a[240:243], a[116:119], v[20:23]
    ds_read_b64_tr_b16 a[226:227], v196 offset:512
    v_mfma_f32_16x16x32_bf16 v[24:27], a[240:243], a[120:123], v[24:27]
    ds_read_b64_tr_b16 a[228:229], v197 offset:0
    buffer_load_dwordx4 v211, s[48:51], s77 offen offset:3072 lds
    v_mfma_f32_16x16x32_bf16 v[28:31], a[240:243], a[124:127], v[28:31]
    ds_read_b64_tr_b16 a[230:231], v197 offset:512
    v_mfma_f32_16x16x32_bf16 v[44:47], a[244:247], a[124:127], v[44:47]
    ds_read_b64_tr_b16 a[232:233], v198 offset:0
    v_mfma_f32_16x16x32_bf16 v[40:43], a[244:247], a[120:123], v[40:43]
    ds_read_b64_tr_b16 a[234:235], v198 offset:512
    v_mfma_f32_16x16x32_bf16 v[36:39], a[244:247], a[116:119], v[36:39]
    ds_read_b64_tr_b16 a[236:237], v199 offset:0
    v_mfma_f32_16x16x32_bf16 v[32:35], a[244:247], a[112:115], v[32:35]
    ds_read_b64_tr_b16 a[238:239], v199 offset:512
    s_waitcnt lgkmcnt(8)
    v_mfma_f32_16x16x32_bf16 v[48:51], a[248:251], a[112:115], v[48:51]
    v_mfma_f32_16x16x32_bf16 v[52:55], a[248:251], a[116:119], v[52:55]
    v_mfma_f32_16x16x32_bf16 v[56:59], a[248:251], a[120:123], v[56:59]
    s_add_u32 m0, s14, 65536
    s_add_u32 s78, s78, s9
    buffer_load_dwordx4 v208, s[48:51], s78 offen offset:0 lds
    v_mfma_f32_16x16x32_bf16 v[60:63], a[248:251], a[124:127], v[60:63]
    v_mfma_f32_16x16x32_bf16 v[76:79], a[252:255], a[124:127], v[76:79]
    v_mfma_f32_16x16x32_bf16 v[72:75], a[252:255], a[120:123], v[72:75]
    v_mfma_f32_16x16x32_bf16 v[68:71], a[252:255], a[116:119], v[68:71]
    v_mfma_f32_16x16x32_bf16 v[64:67], a[252:255], a[112:115], v[64:67]
    s_waitcnt lgkmcnt(4)
    v_mfma_f32_16x16x32_bf16 v[16:19], a[224:227], a[128:131], v[16:19]
    ds_read_b64_tr_b16 a[240:241], v196 offset:2048
    v_mfma_f32_16x16x32_bf16 v[20:23], a[224:227], a[132:135], v[20:23]
    ds_read_b64_tr_b16 a[242:243], v196 offset:2560
    v_mfma_f32_16x16x32_bf16 v[24:27], a[224:227], a[136:139], v[24:27]
    ds_read_b64_tr_b16 a[244:245], v197 offset:2048
    buffer_load_dwordx4 v209, s[48:51], s78 offen offset:1024 lds
    v_mfma_f32_16x16x32_bf16 v[28:31], a[224:227], a[140:143], v[28:31]
    ds_read_b64_tr_b16 a[246:247], v197 offset:2560
    v_mfma_f32_16x16x32_bf16 v[44:47], a[228:231], a[140:143], v[44:47]
    ds_read_b64_tr_b16 a[248:249], v198 offset:2048
    v_mfma_f32_16x16x32_bf16 v[40:43], a[228:231], a[136:139], v[40:43]
    ds_read_b64_tr_b16 a[250:251], v198 offset:2560
    v_mfma_f32_16x16x32_bf16 v[36:39], a[228:231], a[132:135], v[36:39]
    ds_read_b64_tr_b16 a[252:253], v199 offset:2048
    v_mfma_f32_16x16x32_bf16 v[32:35], a[228:231], a[128:131], v[32:35]
    ds_read_b64_tr_b16 a[254:255], v199 offset:2560
    s_waitcnt lgkmcnt(8)
    v_mfma_f32_16x16x32_bf16 v[48:51], a[232:235], a[128:131], v[48:51]
    v_mfma_f32_16x16x32_bf16 v[52:55], a[232:235], a[132:135], v[52:55]
    v_mfma_f32_16x16x32_bf16 v[56:59], a[232:235], a[136:139], v[56:59]
    buffer_load_dwordx4 v210, s[48:51], s78 offen offset:2048 lds
    v_mfma_f32_16x16x32_bf16 v[60:63], a[232:235], a[140:143], v[60:63]
    v_mfma_f32_16x16x32_bf16 v[76:79], a[236:239], a[140:143], v[76:79]
    v_mfma_f32_16x16x32_bf16 v[72:75], a[236:239], a[136:139], v[72:75]
    v_mfma_f32_16x16x32_bf16 v[68:71], a[236:239], a[132:135], v[68:71]
    v_mfma_f32_16x16x32_bf16 v[64:67], a[236:239], a[128:131], v[64:67]
    s_barrier
    s_waitcnt lgkmcnt(4)
    v_mfma_f32_16x16x32_bf16 v[16:19], a[240:243], a[144:147], v[16:19]
    ds_read_b64_tr_b16 a[224:225], v196 offset:16384
    s_waitcnt vmcnt(7)
    v_cmp_ne_u64 vcc, s[42:43], v[14:15]
    s_nop 0
    s_cmp_eq_u64 vcc, 0
    s_cbranch_scc1 L_p6_ok
L_p6_retry:
    s_add_u32 s100, s100, 1
    s_cmp_gt_u32 s100, 200000
    s_cbranch_scc1 L_p6_ok
    s_sleep 2
    buffer_load_dwordx2 v[14:15], v1, s[52:55], s24 offen offset:2048 sc1
    s_waitcnt vmcnt(0)
    v_cmp_ne_u64 vcc, s[42:43], v[14:15]
    s_nop 0
    s_cmp_eq_u64 vcc, 0
    s_cbranch_scc0 L_p6_retry
L_p6_ok:
    v_mfma_f32_16x16x32_bf16 v[20:23], a[240:243], a[148:151], v[20:23]
    ds_read_b64_tr_b16 a[226:227], v196 offset:16896
    buffer_load_dwordx4 v[168:171], v230, s[52:55], s25 offen offset:256 sc1
    v_mfma_f32_16x16x32_bf16 v[24:27], a[240:243], a[152:155], v[24:27]
    ds_read_b64_tr_b16 a[228:229], v197 offset:16384
    buffer_load_dwordx4 v211, s[48:51], s78 offen offset:3072 lds
    v_mfma_f32_16x16x32_bf16 v[28:31], a[240:243], a[156:159], v[28:31]
    ds_read_b64_tr_b16 a[230:231], v197 offset:16896
    v_mfma_f32_16x16x32_bf16 v[44:47], a[244:247], a[156:159], v[44:47]
    ds_read_b64_tr_b16 a[232:233], v198 offset:16384
    v_mfma_f32_16x16x32_bf16 v[40:43], a[244:247], a[152:155], v[40:43]
    ds_read_b64_tr_b16 a[234:235], v198 offset:16896
    v_mfma_f32_16x16x32_bf16 v[36:39], a[244:247], a[148:151], v[36:39]
    ds_read_b64_tr_b16 a[236:237], v199 offset:16384
    v_mfma_f32_16x16x32_bf16 v[32:35], a[244:247], a[144:147], v[32:35]
    ds_read_b64_tr_b16 a[238:239], v199 offset:16896
    buffer_load_dwordx4 v[172:175], v230, s[52:55], s25 offen offset:320 sc1
    s_waitcnt lgkmcnt(8)
    v_mfma_f32_16x16x32_bf16 v[48:51], a[248:251], a[144:147], v[48:51]
    v_mfma_f32_16x16x32_bf16 v[52:55], a[248:251], a[148:151], v[52:55]
    v_mfma_f32_16x16x32_bf16 v[56:59], a[248:251], a[152:155], v[56:59]
    s_add_u32 m0, s14, 81920
    s_add_u32 s79, s79, s9
    buffer_load_dwordx4 v208, s[48:51], s79 offen offset:0 lds
    v_mfma_f32_16x16x32_bf16 v[60:63], a[248:251], a[156:159], v[60:63]
    v_mfma_f32_16x16x32_bf16 v[76:79], a[252:255], a[156:159], v[76:79]
    v_mfma_f32_16x16x32_bf16 v[72:75], a[252:255], a[152:155], v[72:75]
    buffer_load_dwordx4 v[152:155], v230, s[52:55], s26 offen offset:256 sc1
    v_mfma_f32_16x16x32_bf16 v[68:71], a[252:255], a[148:151], v[68:71]
    v_mfma_f32_16x16x32_bf16 v[64:67], a[252:255], a[144:147], v[64:67]
    s_waitcnt lgkmcnt(4)
    v_mfma_f32_16x16x32_bf16 v[16:19], a[224:227], a[160:163], v[16:19]
    ds_read_b64_tr_b16 a[240:241], v196 offset:18432
    v_mfma_f32_16x16x32_bf16 v[20:23], a[224:227], a[164:167], v[20:23]
    ds_read_b64_tr_b16 a[242:243], v196 offset:18944
    v_mfma_f32_16x16x32_bf16 v[24:27], a[224:227], a[168:171], v[24:27]
    ds_read_b64_tr_b16 a[244:245], v197 offset:18432
    buffer_load_dwordx4 v209, s[48:51], s79 offen offset:1024 lds
    v_mfma_f32_16x16x32_bf16 v[28:31], a[224:227], a[172:175], v[28:31]
    ds_read_b64_tr_b16 a[246:247], v197 offset:18944
    buffer_load_dwordx4 v[156:159], v230, s[52:55], s26 offen offset:320 sc1
    v_mfma_f32_16x16x32_bf16 v[44:47], a[228:231], a[172:175], v[44:47]
    ds_read_b64_tr_b16 a[248:249], v198 offset:18432
    v_mfma_f32_16x16x32_bf16 v[40:43], a[228:231], a[168:171], v[40:43]
    ds_read_b64_tr_b16 a[250:251], v198 offset:18944
    v_mfma_f32_16x16x32_bf16 v[36:39], a[228:231], a[164:167], v[36:39]
    ds_read_b64_tr_b16 a[252:253], v199 offset:18432
    v_mfma_f32_16x16x32_bf16 v[32:35], a[228:231], a[160:163], v[32:35]
    ds_read_b64_tr_b16 a[254:255], v199 offset:18944
    s_waitcnt lgkmcnt(8)
    v_mfma_f32_16x16x32_bf16 v[48:51], a[232:235], a[160:163], v[48:51]
    v_mfma_f32_16x16x32_bf16 v[52:55], a[232:235], a[164:167], v[52:55]
    v_mfma_f32_16x16x32_bf16 v[56:59], a[232:235], a[168:171], v[56:59]
    buffer_load_dwordx4 v210, s[48:51], s79 offen offset:2048 lds
    v_mfma_f32_16x16x32_bf16 v[60:63], a[232:235], a[172:175], v[60:63]
    v_mfma_f32_16x16x32_bf16 v[76:79], a[236:239], a[172:175], v[76:79]
    v_mfma_f32_16x16x32_bf16 v[72:75], a[236:239], a[168:171], v[72:75]
    v_mfma_f32_16x16x32_bf16 v[68:71], a[236:239], a[164:167], v[68:71]
    v_mfma_f32_16x16x32_bf16 v[64:67], a[236:239], a[160:163], v[64:67]
    s_barrier
    s_waitcnt lgkmcnt(4)
    v_mfma_f32_16x16x32_bf16 v[16:19], a[240:243], a[176:179], v[16:19]
    ds_read_b64_tr_b16 a[224:225], v196 offset:32768
    v_mfma_f32_16x16x32_bf16 v[20:23], a[240:243], a[180:183], v[20:23]
    ds_read_b64_tr_b16 a[226:227], v196 offset:33280
    v_mfma_f32_16x16x32_bf16 v[24:27], a[240:243], a[184:187], v[24:27]
    ds_read_b64_tr_b16 a[228:229], v197 offset:32768
    buffer_load_dwordx4 v211, s[48:51], s79 offen offset:3072 lds
    v_mfma_f32_16x16x32_bf16 v[28:31], a[240:243], a[188:191], v[28:31]
    ds_read_b64_tr_b16 a[230:231], v197 offset:33280
    v_mfma_f32_16x16x32_bf16 v[44:47], a[244:247], a[188:191], v[44:47]
    ds_read_b64_tr_b16 a[232:233], v198 offset:32768
    v_mfma_f32_16x16x32_bf16 v[40:43], a[244:247], a[184:187], v[40:43]
    ds_read_b64_tr_b16 a[234:235], v198 offset:33280
    v_mfma_f32_16x16x32_bf16 v[36:39], a[244:247], a[180:183], v[36:39]
    ds_read_b64_tr_b16 a[236:237], v199 offset:32768
    v_mfma_f32_16x16x32_bf16 v[32:35], a[244:247], a[176:179], v[32:35]
    ds_read_b64_tr_b16 a[238:239], v199 offset:33280
    s_waitcnt lgkmcnt(8)
    v_mfma_f32_16x16x32_bf16 v[48:51], a[248:251], a[176:179], v[48:51]
    v_mfma_f32_16x16x32_bf16 v[52:55], a[248:251], a[180:183], v[52:55]
    v_mfma_f32_16x16x32_bf16 v[56:59], a[248:251], a[184:187], v[56:59]
    s_add_u32 m0, s14, 98304
    s_add_u32 s80, s80, s9
    buffer_load_dwordx4 v208, s[48:51], s80 offen offset:0 lds
    v_mfma_f32_16x16x32_bf16 v[60:63], a[248:251], a[188:191], v[60:63]
    v_mfma_f32_16x16x32_bf16 v[76:79], a[252:255], a[188:191], v[76:79]
    v_mfma_f32_16x16x32_bf16 v[72:75], a[252:255], a[184:187], v[72:75]
    v_mfma_f32_16x16x32_bf16 v[68:71], a[252:255], a[180:183], v[68:71]
    v_mfma_f32_16x16x32_bf16 v[64:67], a[252:255], a[176:179], v[64:67]
    s_waitcnt lgkmcnt(4)
    v_mfma_f32_16x16x32_bf16 v[16:19], a[224:227], a[192:195], v[16:19]
    ds_read_b64_tr_b16 a[240:241], v196 offset:34816
    v_mfma_f32_16x16x32_bf16 v[20:23], a[224:227], a[196:199], v[20:23]
    ds_read_b64_tr_b16 a[242:243], v196 offset:35328
    v_mfma_f32_16x16x32_bf16 v[24:27], a[224:227], a[200:203], v[24:27]
    ds_read_b64_tr_b16 a[244:245], v197 offset:34816
    buffer_load_dwordx4 v209, s[48:51], s80 offen offset:1024 lds
    v_mfma_f32_16x16x32_bf16 v[28:31], a[224:227], a[204:207], v[28:31]
    ds_read_b64_tr_b16 a[246:247], v197 offset:35328
    v_mfma_f32_16x16x32_bf16 v[44:47], a[228:231], a[204:207], v[44:47]
    ds_read_b64_tr_b16 a[248:249], v198 offset:34816
    v_mfma_f32_16x16x32_bf16 v[40:43], a[228:231], a[200:203], v[40:43]
    ds_read_b64_tr_b16 a[250:251], v198 offset:35328
    v_mfma_f32_16x16x32_bf16 v[36:39], a[228:231], a[196:199], v[36:39]
    ds_read_b64_tr_b16 a[252:253], v199 offset:34816
    v_mfma_f32_16x16x32_bf16 v[32:35], a[228:231], a[192:195], v[32:35]
    ds_read_b64_tr_b16 a[254:255], v199 offset:35328
    s_waitcnt lgkmcnt(8)
    v_mfma_f32_16x16x32_bf16 v[48:51], a[232:235], a[192:195], v[48:51]
    v_mfma_f32_16x16x32_bf16 v[52:55], a[232:235], a[196:199], v[52:55]
    v_mfma_f32_16x16x32_bf16 v[56:59], a[232:235], a[200:203], v[56:59]
    buffer_load_dwordx4 v210, s[48:51], s80 offen offset:2048 lds
    v_mfma_f32_16x16x32_bf16 v[60:63], a[232:235], a[204:207], v[60:63]
    v_mfma_f32_16x16x32_bf16 v[76:79], a[236:239], a[204:207], v[76:79]
    v_mfma_f32_16x16x32_bf16 v[72:75], a[236:239], a[200:203], v[72:75]
    v_mfma_f32_16x16x32_bf16 v[68:71], a[236:239], a[196:199], v[68:71]
    v_mfma_f32_16x16x32_bf16 v[64:67], a[236:239], a[192:195], v[64:67]
    s_waitcnt vmcnt(15)
    s_barrier
    s_waitcnt lgkmcnt(4)
    v_mfma_f32_16x16x32_bf16 v[16:19], a[240:243], a[208:211], v[16:19]
    ds_read_b64_tr_b16 a[224:225], v232 offset:0
    v_mfma_f32_16x16x32_bf16 v[20:23], a[240:243], a[212:215], v[20:23]
    ds_read_b64_tr_b16 a[226:227], v232 offset:512
    v_mfma_f32_16x16x32_bf16 v[24:27], a[240:243], a[216:219], v[24:27]
    ds_read_b64_tr_b16 a[228:229], v233 offset:0
    buffer_load_dwordx4 v211, s[48:51], s80 offen offset:3072 lds
    v_mfma_f32_16x16x32_bf16 v[28:31], a[240:243], a[220:223], v[28:31]
    ds_read_b64_tr_b16 a[230:231], v233 offset:512
    v_mfma_f32_16x16x32_bf16 v[44:47], a[244:247], a[220:223], v[44:47]
    ds_read_b64_tr_b16 a[232:233], v234 offset:0
    v_mfma_f32_16x16x32_bf16 v[40:43], a[244:247], a[216:219], v[40:43]
    ds_read_b64_tr_b16 a[234:235], v234 offset:512
    v_mfma_f32_16x16x32_bf16 v[36:39], a[244:247], a[212:215], v[36:39]
    ds_read_b64_tr_b16 a[236:237], v235 offset:0
    v_mfma_f32_16x16x32_bf16 v[32:35], a[244:247], a[208:211], v[32:35]
    ds_read_b64_tr_b16 a[238:239], v235 offset:512
    s_waitcnt lgkmcnt(8)
    v_mfma_f32_16x16x32_bf16 v[48:51], a[248:251], a[208:211], v[48:51]
    v_mfma_f32_16x16x32_bf16 v[52:55], a[248:251], a[212:215], v[52:55]
    v_mfma_f32_16x16x32_bf16 v[56:59], a[248:251], a[216:219], v[56:59]
    s_add_u32 m0, s14, 114688
    s_add_u32 s81, s81, s9
    buffer_load_dwordx4 v208, s[48:51], s81 offen offset:0 lds
    v_mfma_f32_16x16x32_bf16 v[60:63], a[248:251], a[220:223], v[60:63]
    v_mfma_f32_16x16x32_bf16 v[76:79], a[252:255], a[220:223], v[76:79]
    v_mfma_f32_16x16x32_bf16 v[72:75], a[252:255], a[216:219], v[72:75]
    v_mfma_f32_16x16x32_bf16 v[68:71], a[252:255], a[212:215], v[68:71]
    v_mfma_f32_16x16x32_bf16 v[64:67], a[252:255], a[208:211], v[64:67]
    s_waitcnt lgkmcnt(4)
    v_mfma_f32_16x16x32_bf16 v[80:83], a[224:227], a[0:3], 0
    ds_read_b64_tr_b16 a[240:241], v232 offset:2048
    ds_read_b64_tr_b16 a[242:243], v232 offset:2560
    v_mfma_f32_16x16x32_bf16 v[84:87], a[224:227], a[4:7], 0
    ds_read_b64_tr_b16 a[244:245], v233 offset:2048
    ds_read_b64_tr_b16 a[246:247], v233 offset:2560
    v_mfma_f32_16x16x32_bf16 v[100:103], a[228:231], a[4:7], 0
    ds_read_b64_tr_b16 a[248:249], v234 offset:2048
    buffer_load_dwordx4 v209, s[48:51], s81 offen offset:1024 lds
    s_waitcnt vmcnt(8)
    v_fma_f32 v16, -v160, v168, v16
    v_fma_f32 v17, -v160, v169, v17
    v_fma_f32 v18, -v160, v170, v18
    v_fma_f32 v19, -v160, v171, v19
    v_fma_f32 v32, -v160, v172, v32
    v_fma_f32 v33, -v160, v173, v33
    v_fma_f32 v34, -v160, v174, v34
    v_fma_f32 v35, -v160, v175, v35
    v_mfma_f32_16x16x32_bf16 v[96:99], a[228:231], a[0:3], 0
    ds_read_b64_tr_b16 a[250:251], v234 offset:2560
    v_fma_f32 v48, -v160, v152, v48
    v_fma_f32 v49, -v160, v153, v49
    v_fma_f32 v50, -v160, v154, v50
    v_fma_f32 v51, -v160, v155, v51
    v_fma_f32 v64, -v160, v156, v64
    v_fma_f32 v65, -v160, v157, v65
    v_fma_f32 v66, -v160, v158, v66
    v_fma_f32 v67, -v160, v159, v67
    v_mul_f32 v16, v16, v48
    s_waitcnt lgkmcnt(6)
    v_mfma_f32_16x16x32_bf16 v[112:115], a[232:235], a[0:3], 0
    ds_read_b64_tr_b16 a[252:253], v235 offset:2048
    v_mul_f32 v17, v17, v49
    v_mul_f32 v18, v18, v50
    v_mul_f32 v19, v19, v51
    v_mul_f32 v32, v32, v64
    v_mul_f32 v33, v33, v65
    v_mul_f32 v34, v34, v66
    v_mul_f32 v35, v35, v67
    v_cvt_pk_bf16_f32 v48, v16, v17
    v_cvt_pk_bf16_f32 v49, v18, v19
    v_mfma_f32_16x16x32_bf16 v[116:119], a[232:235], a[4:7], 0
    ds_read_b64_tr_b16 a[254:255], v235 offset:2560
    v_cvt_pk_bf16_f32 v50, v32, v33
    v_cvt_pk_bf16_f32 v51, v34, v35
    s_xor_b32 s101, s13, 0
    s_add_u32 s101, s101, 16384
    buffer_store_dwordx4 v[48:51], v3, s[52:55], s101 offen offset:0 sc1
    v_fma_f32 v20, -v161, v168, v20
    v_fma_f32 v21, -v161, v169, v21
    v_fma_f32 v22, -v161, v170, v22
    v_fma_f32 v23, -v161, v171, v23
    v_fma_f32 v36, -v161, v172, v36
    v_mfma_f32_16x16x32_bf16 v[132:135], a[236:239], a[4:7], 0
    v_fma_f32 v37, -v161, v173, v37
    v_fma_f32 v38, -v161, v174, v38
    v_fma_f32 v39, -v161, v175, v39
    v_fma_f32 v52, -v161, v152, v52
    v_fma_f32 v53, -v161, v153, v53
    v_fma_f32 v54, -v161, v154, v54
    v_fma_f32 v55, -v161, v155, v55
    v_fma_f32 v68, -v161, v156, v68
    v_fma_f32 v69, -v161, v157, v69
    v_mfma_f32_16x16x32_bf16 v[128:131], a[236:239], a[0:3], 0
    buffer_load_dwordx4 v210, s[48:51], s81 offen offset:2048 lds
    v_fma_f32 v70, -v161, v158, v70
    v_fma_f32 v71, -v161, v159, v71
    v_mul_f32 v20, v20, v52
    v_mul_f32 v21, v21, v53
    v_mul_f32 v22, v22, v54
    v_mul_f32 v23, v23, v55
    v_mul_f32 v36, v36, v68
    v_mul_f32 v37, v37, v69
    v_mul_f32 v38, v38, v70
    s_barrier
    s_waitcnt lgkmcnt(4)
    v_mfma_f32_16x16x32_bf16 v[80:83], a[240:243], a[16:19], v[80:83]
    ds_read_b64_tr_b16 a[224:225], v232 offset:16384
    ds_read_b64_tr_b16 a[226:227], v232 offset:16896
    v_mul_f32 v39, v39, v71
    v_cvt_pk_bf16_f32 v52, v20, v21
    v_cvt_pk_bf16_f32 v53, v22, v23
    v_cvt_pk_bf16_f32 v54, v36, v37
    v_cvt_pk_bf16_f32 v55, v38, v39
    s_xor_b32 s101, s13, 0
    s_add_u32 s101, s101, 16384
    buffer_store_dwordx4 v[52:55], v3, s[52:55], s101 offen offset:1024 sc1
    v_fma_f32 v24, -v162, v168, v24
    v_fma_f32 v25, -v162, v169, v25
    v_mfma_f32_16x16x32_bf16 v[84:87], a[240:243], a[20:23], v[84:87]
    ds_read_b64_tr_b16 a[228:229], v233 offset:16384
    ds_read_b64_tr_b16 a[230:231], v233 offset:16896
    v_fma_f32 v26, -v162, v170, v26
    v_fma_f32 v27, -v162, v171, v27
    v_fma_f32 v40, -v162, v172, v40
    v_fma_f32 v41, -v162, v173, v41
    v_fma_f32 v42, -v162, v174, v42
    v_fma_f32 v43, -v162, v175, v43
    v_fma_f32 v56, -v162, v152, v56
    v_fma_f32 v57, -v162, v153, v57
    v_fma_f32 v58, -v162, v154, v58
    v_mfma_f32_16x16x32_bf16 v[100:103], a[244:247], a[20:23], v[100:103]
    ds_read_b64_tr_b16 a[232:233], v234 offset:16384
    buffer_load_dwordx4 v211, s[48:51], s81 offen offset:3072 lds
    v_fma_f32 v59, -v162, v155, v59
    v_fma_f32 v72, -v162, v156, v72
    v_fma_f32 v73, -v162, v157, v73
    v_fma_f32 v74, -v162, v158, v74
    v_fma_f32 v75, -v162, v159, v75
    v_mul_f32 v24, v24, v56
    v_mul_f32 v25, v25, v57
    v_mul_f32 v26, v26, v58
    v_mul_f32 v27, v27, v59
    v_mfma_f32_16x16x32_bf16 v[96:99], a[244:247], a[16:19], v[96:99]
    ds_read_b64_tr_b16 a[234:235], v234 offset:16896
    v_mul_f32 v40, v40, v72
    v_mul_f32 v41, v41, v73
    v_mul_f32 v42, v42, v74
    v_mul_f32 v43, v43, v75
    v_cvt_pk_bf16_f32 v56, v24, v25
    v_cvt_pk_bf16_f32 v57, v26, v27
    v_cvt_pk_bf16_f32 v58, v40, v41
    v_cvt_pk_bf16_f32 v59, v42, v43
    s_xor_b32 s101, s13, 2048
    s_add_u32 s101, s101, 16384
    buffer_store_dwordx4 v[56:59], v3, s[52:55], s101 offen offset:0 sc1
    s_waitcnt lgkmcnt(6)
    v_mfma_f32_16x16x32_bf16 v[112:115], a[248:251], a[16:19], v[112:115]
    ds_read_b64_tr_b16 a[236:237], v235 offset:16384
    v_fma_f32 v28, -v163, v168, v28
    v_fma_f32 v29, -v163, v169, v29
    v_fma_f32 v30, -v163, v170, v30
    v_fma_f32 v31, -v163, v171, v31
    v_fma_f32 v44, -v163, v172, v44
    v_fma_f32 v45, -v163, v173, v45
    v_fma_f32 v46, -v163, v174, v46
    v_fma_f32 v47, -v163, v175, v47
    v_mfma_f32_16x16x32_bf16 v[116:119], a[248:251], a[20:23], v[116:119]
    ds_read_b64_tr_b16 a[238:239], v235 offset:16896
    v_fma_f32 v60, -v163, v152, v60
    v_fma_f32 v61, -v163, v153, v61
    v_fma_f32 v62, -v163, v154, v62
    v_fma_f32 v63, -v163, v155, v63
    v_fma_f32 v76, -v163, v156, v76
    v_fma_f32 v77, -v163, v157, v77
    v_fma_f32 v78, -v163, v158, v78
    v_fma_f32 v79, -v163, v159, v79
    v_mul_f32 v28, v28, v60
    v_mfma_f32_16x16x32_bf16 v[132:135], a[252:255], a[20:23], v[132:135]
    v_mul_f32 v29, v29, v61
    v_mul_f32 v30, v30, v62
    v_mul_f32 v31, v31, v63
    v_mul_f32 v44, v44, v76
    v_mul_f32 v45, v45, v77
    v_mul_f32 v46, v46, v78
    v_mul_f32 v47, v47, v79
    v_cvt_pk_bf16_f32 v60, v28, v29
    v_cvt_pk_bf16_f32 v61, v30, v31
    v_mfma_f32_16x16x32_bf16 v[128:131], a[252:255], a[16:19], v[128:131]
    s_add_u32 m0, s14, 131072
    s_add_u32 s82, s82, s9
    buffer_load_dwordx4 v208, s[48:51], s82 offen offset:0 lds
    v_cvt_pk_bf16_f32 v62, v44, v45
    v_cvt_pk_bf16_f32 v63, v46, v47
    s_xor_b32 s101, s13, 2048
    s_add_u32 s101, s101, 16384
    buffer_store_dwordx4 v[60:63], v3, s[52:55], s101 offen offset:1024 sc1
    s_waitcnt lgkmcnt(4)
    v_mfma_f32_16x16x32_bf16 v[80:83], a[224:227], a[32:35], v[80:83]
    ds_read_b64_tr_b16 a[240:241], v232 offset:18432
    ds_read_b64_tr_b16 a[242:243], v232 offset:18944
    buffer_load_dwordx4 v[168:171], v231, s[52:55], s25 offen offset:512 sc1
    v_mfma_f32_16x16x32_bf16 v[84:87], a[224:227], a[36:39], v[84:87]
    ds_read_b64_tr_b16 a[244:245], v233 offset:18432
    ds_read_b64_tr_b16 a[246:247], v233 offset:18944
    v_mfma_f32_16x16x32_bf16 v[100:103], a[228:231], a[36:39], v[100:103]
    ds_read_b64_tr_b16 a[248:249], v234 offset:18432
    buffer_load_dwordx4 v209, s[48:51], s82 offen offset:1024 lds
    v_mfma_f32_16x16x32_bf16 v[96:99], a[228:231], a[32:35], v[96:99]
    ds_read_b64_tr_b16 a[250:251], v234 offset:18944
    s_waitcnt lgkmcnt(6)
    v_mfma_f32_16x16x32_bf16 v[112:115], a[232:235], a[32:35], v[112:115]
    ds_read_b64_tr_b16 a[252:253], v235 offset:18432
    v_mfma_f32_16x16x32_bf16 v[116:119], a[232:235], a[36:39], v[116:119]
    ds_read_b64_tr_b16 a[254:255], v235 offset:18944
    v_mfma_f32_16x16x32_bf16 v[132:135], a[236:239], a[36:39], v[132:135]
    buffer_load_dwordx4 v[172:175], v231, s[52:55], s25 offen offset:576 sc1
    v_mfma_f32_16x16x32_bf16 v[128:131], a[236:239], a[32:35], v[128:131]
    buffer_load_dwordx4 v210, s[48:51], s82 offen offset:2048 lds
    s_waitcnt vmcnt(17)
    s_barrier
    s_waitcnt lgkmcnt(4)
    v_mfma_f32_16x16x32_bf16 v[80:83], a[240:243], a[48:51], v[80:83]
    ds_read_b64_tr_b16 a[224:225], v232 offset:32768
    ds_read_b64_tr_b16 a[226:227], v232 offset:33280
    v_mfma_f32_16x16x32_bf16 v[84:87], a[240:243], a[52:55], v[84:87]
    ds_read_b64_tr_b16 a[228:229], v233 offset:32768
    ds_read_b64_tr_b16 a[230:231], v233 offset:33280
    v_mfma_f32_16x16x32_bf16 v[100:103], a[244:247], a[52:55], v[100:103]
    ds_read_b64_tr_b16 a[232:233], v234 offset:32768
    buffer_load_dwordx4 v211, s[48:51], s82 offen offset:3072 lds
    v_mfma_f32_16x16x32_bf16 v[96:99], a[244:247], a[48:51], v[96:99]
    ds_read_b64_tr_b16 a[234:235], v234 offset:33280
    s_waitcnt lgkmcnt(6)
    v_mfma_f32_16x16x32_bf16 v[112:115], a[248:251], a[48:51], v[112:115]
    ds_read_b64_tr_b16 a[236:237], v235 offset:32768
    buffer_load_dwordx4 v[152:155], v231, s[52:55], s26 offen offset:512 sc1
    v_mfma_f32_16x16x32_bf16 v[116:119], a[248:251], a[52:55], v[116:119]
    ds_read_b64_tr_b16 a[238:239], v235 offset:33280
    v_mfma_f32_16x16x32_bf16 v[132:135], a[252:255], a[52:55], v[132:135]
    v_mfma_f32_16x16x32_bf16 v[128:131], a[252:255], a[48:51], v[128:131]
    s_add_u32 m0, s14, 147456
    s_add_u32 s83, s83, s9
    buffer_load_dwordx4 v208, s[48:51], s83 offen offset:0 lds
    s_waitcnt lgkmcnt(4)
    v_mfma_f32_16x16x32_bf16 v[80:83], a[224:227], a[64:67], v[80:83]
    ds_read_b64_tr_b16 a[240:241], v232 offset:34816
    ds_read_b64_tr_b16 a[242:243], v232 offset:35328
    v_mfma_f32_16x16x32_bf16 v[84:87], a[224:227], a[68:71], v[84:87]
    ds_read_b64_tr_b16 a[244:245], v233 offset:34816
    ds_read_b64_tr_b16 a[246:247], v233 offset:35328
    v_mfma_f32_16x16x32_bf16 v[100:103], a[228:231], a[68:71], v[100:103]
    ds_read_b64_tr_b16 a[248:249], v234 offset:34816
    buffer_load_dwordx4 v[156:159], v231, s[52:55], s26 offen offset:576 sc1
    buffer_load_dwordx4 v209, s[48:51], s83 offen offset:1024 lds
    v_mfma_f32_16x16x32_bf16 v[96:99], a[228:231], a[64:67], v[96:99]
    ds_read_b64_tr_b16 a[250:251], v234 offset:35328
    s_waitcnt lgkmcnt(6)
    v_mfma_f32_16x16x32_bf16 v[112:115], a[232:235], a[64:67], v[112:115]
    ds_read_b64_tr_b16 a[252:253], v235 offset:34816
    v_mfma_f32_16x16x32_bf16 v[116:119], a[232:235], a[68:71], v[116:119]
    ds_read_b64_tr_b16 a[254:255], v235 offset:35328
    v_mfma_f32_16x16x32_bf16 v[132:135], a[236:239], a[68:71], v[132:135]
    v_mfma_f32_16x16x32_bf16 v[128:131], a[236:239], a[64:67], v[128:131]
    buffer_load_dwordx4 v210, s[48:51], s83 offen offset:2048 lds
    s_waitcnt vmcnt(19)
    s_barrier
    s_waitcnt lgkmcnt(4)
    v_mfma_f32_16x16x32_bf16 v[80:83], a[240:243], a[80:83], v[80:83]
    ds_read_b64_tr_b16 a[224:225], v232 offset:49152
    ds_read_b64_tr_b16 a[226:227], v232 offset:49664
    v_mfma_f32_16x16x32_bf16 v[84:87], a[240:243], a[84:87], v[84:87]
    ds_read_b64_tr_b16 a[228:229], v233 offset:49152
    ds_read_b64_tr_b16 a[230:231], v233 offset:49664
    v_mfma_f32_16x16x32_bf16 v[100:103], a[244:247], a[84:87], v[100:103]
    ds_read_b64_tr_b16 a[232:233], v234 offset:49152
    buffer_load_dwordx4 v211, s[48:51], s83 offen offset:3072 lds
    v_mfma_f32_16x16x32_bf16 v[96:99], a[244:247], a[80:83], v[96:99]
    ds_read_b64_tr_b16 a[234:235], v234 offset:49664
    s_waitcnt lgkmcnt(6)
    v_mfma_f32_16x16x32_bf16 v[112:115], a[248:251], a[80:83], v[112:115]
    ds_read_b64_tr_b16 a[236:237], v235 offset:49152
    v_mfma_f32_16x16x32_bf16 v[116:119], a[248:251], a[84:87], v[116:119]
    ds_read_b64_tr_b16 a[238:239], v235 offset:49664
    v_mfma_f32_16x16x32_bf16 v[132:135], a[252:255], a[84:87], v[132:135]
    v_mfma_f32_16x16x32_bf16 v[128:131], a[252:255], a[80:83], v[128:131]
    s_waitcnt vmcnt(11)
    s_barrier
    buffer_store_dwordx2 v[6:7], v4, s[52:55], s12 offen offset:0 sc1
    s_add_u32 s12, s12, 1024
    s_waitcnt lgkmcnt(4)
    v_mfma_f32_16x16x32_bf16 v[80:83], a[224:227], a[96:99], v[80:83]
    ds_read_b64_tr_b16 a[240:241], v232 offset:51200
    ds_read_b64_tr_b16 a[242:243], v232 offset:51712
    v_mfma_f32_16x16x32_bf16 v[84:87], a[224:227], a[100:103], v[84:87]
    ds_read_b64_tr_b16 a[244:245], v233 offset:51200
    ds_read_b64_tr_b16 a[246:247], v233 offset:51712
    v_mfma_f32_16x16x32_bf16 v[100:103], a[228:231], a[100:103], v[100:103]
    ds_read_b64_tr_b16 a[248:249], v234 offset:51200
    v_mfma_f32_16x16x32_bf16 v[96:99], a[228:231], a[96:99], v[96:99]
    ds_read_b64_tr_b16 a[250:251], v234 offset:51712
    s_waitcnt lgkmcnt(6)
    v_mfma_f32_16x16x32_bf16 v[112:115], a[232:235], a[96:99], v[112:115]
    ds_read_b64_tr_b16 a[252:253], v235 offset:51200
    v_mfma_f32_16x16x32_bf16 v[116:119], a[232:235], a[100:103], v[116:119]
    ds_read_b64_tr_b16 a[254:255], v235 offset:51712
    v_mfma_f32_16x16x32_bf16 v[132:135], a[236:239], a[100:103], v[132:135]
    v_mfma_f32_16x16x32_bf16 v[128:131], a[236:239], a[96:99], v[128:131]
    s_barrier
    s_waitcnt lgkmcnt(4)
    v_mfma_f32_16x16x32_bf16 v[80:83], a[240:243], a[112:115], v[80:83]
    ds_read_b64_tr_b16 a[224:225], v236 offset:0
    ds_read_b64_tr_b16 a[226:227], v236 offset:512
    v_mfma_f32_16x16x32_bf16 v[84:87], a[240:243], a[116:119], v[84:87]
    ds_read_b64_tr_b16 a[228:229], v237 offset:0
    ds_read_b64_tr_b16 a[230:231], v237 offset:512
    v_mfma_f32_16x16x32_bf16 v[100:103], a[244:247], a[116:119], v[100:103]
    ds_read_b64_tr_b16 a[232:233], v238 offset:0
    v_mfma_f32_16x16x32_bf16 v[96:99], a[244:247], a[112:115], v[96:99]
    ds_read_b64_tr_b16 a[234:235], v238 offset:512
    s_waitcnt lgkmcnt(6)
    v_mfma_f32_16x16x32_bf16 v[112:115], a[248:251], a[112:115], v[112:115]
    ds_read_b64_tr_b16 a[236:237], v239 offset:0
    v_mfma_f32_16x16x32_bf16 v[116:119], a[248:251], a[116:119], v[116:119]
    ds_read_b64_tr_b16 a[238:239], v239 offset:512
    v_mfma_f32_16x16x32_bf16 v[132:135], a[252:255], a[116:119], v[132:135]
    v_mfma_f32_16x16x32_bf16 v[128:131], a[252:255], a[112:115], v[128:131]
    s_waitcnt lgkmcnt(4)
    v_mfma_f32_16x16x32_bf16 v[80:83], a[224:227], a[128:131], v[80:83]
    ds_read_b64_tr_b16 a[240:241], v236 offset:2048
    ds_read_b64_tr_b16 a[242:243], v236 offset:2560
    v_mfma_f32_16x16x32_bf16 v[84:87], a[224:227], a[132:135], v[84:87]
    ds_read_b64_tr_b16 a[244:245], v237 offset:2048
    ds_read_b64_tr_b16 a[246:247], v237 offset:2560
    v_mfma_f32_16x16x32_bf16 v[100:103], a[228:231], a[132:135], v[100:103]
    ds_read_b64_tr_b16 a[248:249], v238 offset:2048
    v_mfma_f32_16x16x32_bf16 v[96:99], a[228:231], a[128:131], v[96:99]
    ds_read_b64_tr_b16 a[250:251], v238 offset:2560
    s_waitcnt lgkmcnt(6)
    v_mfma_f32_16x16x32_bf16 v[112:115], a[232:235], a[128:131], v[112:115]
    ds_read_b64_tr_b16 a[252:253], v239 offset:2048
    v_mfma_f32_16x16x32_bf16 v[116:119], a[232:235], a[132:135], v[116:119]
    ds_read_b64_tr_b16 a[254:255], v239 offset:2560
    v_mfma_f32_16x16x32_bf16 v[132:135], a[236:239], a[132:135], v[132:135]
    v_mfma_f32_16x16x32_bf16 v[128:131], a[236:239], a[128:131], v[128:131]
    s_waitcnt vmcnt(7)
    s_barrier
    s_waitcnt lgkmcnt(4)
    v_mfma_f32_16x16x32_bf16 v[80:83], a[240:243], a[144:147], v[80:83]
    ds_read_b64_tr_b16 a[224:225], v236 offset:16384
    ds_read_b64_tr_b16 a[226:227], v236 offset:16896
    v_mfma_f32_16x16x32_bf16 v[84:87], a[240:243], a[148:151], v[84:87]
    ds_read_b64_tr_b16 a[228:229], v237 offset:16384
    ds_read_b64_tr_b16 a[230:231], v237 offset:16896
    v_mfma_f32_16x16x32_bf16 v[100:103], a[244:247], a[148:151], v[100:103]
    ds_read_b64_tr_b16 a[232:233], v238 offset:16384
    v_mfma_f32_16x16x32_bf16 v[96:99], a[244:247], a[144:147], v[96:99]
    ds_read_b64_tr_b16 a[234:235], v238 offset:16896
    s_waitcnt lgkmcnt(6)
    v_mfma_f32_16x16x32_bf16 v[112:115], a[248:251], a[144:147], v[112:115]
    ds_read_b64_tr_b16 a[236:237], v239 offset:16384
    v_mfma_f32_16x16x32_bf16 v[116:119], a[248:251], a[148:151], v[116:119]
    ds_read_b64_tr_b16 a[238:239], v239 offset:16896
    v_mfma_f32_16x16x32_bf16 v[132:135], a[252:255], a[148:151], v[132:135]
    v_mfma_f32_16x16x32_bf16 v[128:131], a[252:255], a[144:147], v[128:131]
    s_waitcnt lgkmcnt(4)
    v_mfma_f32_16x16x32_bf16 v[80:83], a[224:227], a[160:163], v[80:83]
    ds_read_b64_tr_b16 a[240:241], v236 offset:18432
    ds_read_b64_tr_b16 a[242:243], v236 offset:18944
    v_mfma_f32_16x16x32_bf16 v[84:87], a[224:227], a[164:167], v[84:87]
    ds_read_b64_tr_b16 a[244:245], v237 offset:18432
    ds_read_b64_tr_b16 a[246:247], v237 offset:18944
    v_mfma_f32_16x16x32_bf16 v[100:103], a[228:231], a[164:167], v[100:103]
    ds_read_b64_tr_b16 a[248:249], v238 offset:18432
    v_mfma_f32_16x16x32_bf16 v[96:99], a[228:231], a[160:163], v[96:99]
    ds_read_b64_tr_b16 a[250:251], v238 offset:18944
    s_waitcnt lgkmcnt(6)
    v_mfma_f32_16x16x32_bf16 v[112:115], a[232:235], a[160:163], v[112:115]
    ds_read_b64_tr_b16 a[252:253], v239 offset:18432
    v_mfma_f32_16x16x32_bf16 v[116:119], a[232:235], a[164:167], v[116:119]
    ds_read_b64_tr_b16 a[254:255], v239 offset:18944
    v_mfma_f32_16x16x32_bf16 v[132:135], a[236:239], a[164:167], v[132:135]
    v_mfma_f32_16x16x32_bf16 v[128:131], a[236:239], a[160:163], v[128:131]
    s_waitcnt vmcnt(1)
    s_barrier
    s_waitcnt lgkmcnt(4)
    v_mfma_f32_16x16x32_bf16 v[80:83], a[240:243], a[176:179], v[80:83]
    ds_read_b64_tr_b16 a[224:225], v236 offset:32768
    ds_read_b64_tr_b16 a[226:227], v236 offset:33280
    v_mfma_f32_16x16x32_bf16 v[84:87], a[240:243], a[180:183], v[84:87]
    ds_read_b64_tr_b16 a[228:229], v237 offset:32768
    ds_read_b64_tr_b16 a[230:231], v237 offset:33280
    v_mfma_f32_16x16x32_bf16 v[100:103], a[244:247], a[180:183], v[100:103]
    ds_read_b64_tr_b16 a[232:233], v238 offset:32768
    v_mfma_f32_16x16x32_bf16 v[96:99], a[244:247], a[176:179], v[96:99]
    ds_read_b64_tr_b16 a[234:235], v238 offset:33280
    s_waitcnt lgkmcnt(6)
    v_mfma_f32_16x16x32_bf16 v[112:115], a[248:251], a[176:179], v[112:115]
    ds_read_b64_tr_b16 a[236:237], v239 offset:32768
    v_mfma_f32_16x16x32_bf16 v[116:119], a[248:251], a[180:183], v[116:119]
    ds_read_b64_tr_b16 a[238:239], v239 offset:33280
    v_mfma_f32_16x16x32_bf16 v[132:135], a[252:255], a[180:183], v[132:135]
    v_mfma_f32_16x16x32_bf16 v[128:131], a[252:255], a[176:179], v[128:131]
    s_waitcnt lgkmcnt(4)
    v_mfma_f32_16x16x32_bf16 v[80:83], a[224:227], a[192:195], v[80:83]
    ds_read_b64_tr_b16 a[240:241], v236 offset:34816
    ds_read_b64_tr_b16 a[242:243], v236 offset:35328
    v_mfma_f32_16x16x32_bf16 v[84:87], a[224:227], a[196:199], v[84:87]
    ds_read_b64_tr_b16 a[244:245], v237 offset:34816
    ds_read_b64_tr_b16 a[246:247], v237 offset:35328
    v_mfma_f32_16x16x32_bf16 v[100:103], a[228:231], a[196:199], v[100:103]
    ds_read_b64_tr_b16 a[248:249], v238 offset:34816
    v_mfma_f32_16x16x32_bf16 v[96:99], a[228:231], a[192:195], v[96:99]
    ds_read_b64_tr_b16 a[250:251], v238 offset:35328
    s_waitcnt lgkmcnt(6)
    v_mfma_f32_16x16x32_bf16 v[112:115], a[232:235], a[192:195], v[112:115]
    ds_read_b64_tr_b16 a[252:253], v239 offset:34816
    v_mfma_f32_16x16x32_bf16 v[116:119], a[232:235], a[196:199], v[116:119]
    ds_read_b64_tr_b16 a[254:255], v239 offset:35328
    v_mfma_f32_16x16x32_bf16 v[132:135], a[236:239], a[196:199], v[132:135]
    v_mfma_f32_16x16x32_bf16 v[128:131], a[236:239], a[192:195], v[128:131]
    s_waitcnt lgkmcnt(4)
    v_mfma_f32_16x16x32_bf16 v[80:83], a[240:243], a[208:211], v[80:83]
    v_mfma_f32_16x16x32_bf16 v[84:87], a[240:243], a[212:215], v[84:87]
    v_mfma_f32_16x16x32_bf16 v[100:103], a[244:247], a[212:215], v[100:103]
    v_mfma_f32_16x16x32_bf16 v[96:99], a[244:247], a[208:211], v[96:99]
    s_waitcnt lgkmcnt(0)
    v_mfma_f32_16x16x32_bf16 v[112:115], a[248:251], a[208:211], v[112:115]
    v_mfma_f32_16x16x32_bf16 v[116:119], a[248:251], a[212:215], v[116:119]
    v_mfma_f32_16x16x32_bf16 v[132:135], a[252:255], a[212:215], v[132:135]
    v_mfma_f32_16x16x32_bf16 v[128:131], a[252:255], a[208:211], v[128:131]
    v_fma_f32 v80, -v160, v168, v80
    v_fma_f32 v81, -v160, v169, v81
    v_fma_f32 v82, -v160, v170, v82
    v_fma_f32 v83, -v160, v171, v83
    v_fma_f32 v96, -v160, v172, v96
    v_fma_f32 v97, -v160, v173, v97
    v_fma_f32 v98, -v160, v174, v98
    v_fma_f32 v99, -v160, v175, v99
    v_fma_f32 v112, -v160, v152, v112
    v_fma_f32 v113, -v160, v153, v113
    v_fma_f32 v114, -v160, v154, v114
    v_fma_f32 v115, -v160, v155, v115
    v_fma_f32 v128, -v160, v156, v128
    v_fma_f32 v129, -v160, v157, v129
    v_fma_f32 v130, -v160, v158, v130
    v_fma_f32 v131, -v160, v159, v131
    v_mul_f32 v80, v80, v112
    v_mul_f32 v81, v81, v113
    v_mul_f32 v82, v82, v114
    v_mul_f32 v83, v83, v115
    v_mul_f32 v96, v96, v128
    v_mul_f32 v97, v97, v129
    v_mul_f32 v98, v98, v130
    v_mul_f32 v99, v99, v131
    v_cvt_pk_bf16_f32 v112, v80, v81
    v_cvt_pk_bf16_f32 v113, v82, v83
    v_cvt_pk_bf16_f32 v114, v96, v97
    v_cvt_pk_bf16_f32 v115, v98, v99
    buffer_store_dwordx4 v[112:115], v3, s[52:55], s66 offen offset:0 sc1
    v_fma_f32 v84, -v161, v168, v84
    v_fma_f32 v85, -v161, v169, v85
    v_fma_f32 v86, -v161, v170, v86
    v_fma_f32 v87, -v161, v171, v87
    v_fma_f32 v100, -v161, v172, v100
    v_fma_f32 v101, -v161, v173, v101
    v_fma_f32 v102, -v161, v174, v102
    v_fma_f32 v103, -v161, v175, v103
    v_fma_f32 v116, -v161, v152, v116
    v_fma_f32 v117, -v161, v153, v117
    v_fma_f32 v118, -v161, v154, v118
    v_fma_f32 v119, -v161, v155, v119
    v_fma_f32 v132, -v161, v156, v132
    v_fma_f32 v133, -v161, v157, v133
    v_fma_f32 v134, -v161, v158, v134
    v_fma_f32 v135, -v161, v159, v135
    v_mul_f32 v84, v84, v116
    v_mul_f32 v85, v85, v117
    v_mul_f32 v86, v86, v118
    v_mul_f32 v87, v87, v119
    v_mul_f32 v100, v100, v132
    v_mul_f32 v101, v101, v133
    v_mul_f32 v102, v102, v134
    v_mul_f32 v103, v103, v135
    v_cvt_pk_bf16_f32 v116, v84, v85
    v_cvt_pk_bf16_f32 v117, v86, v87
    v_cvt_pk_bf16_f32 v118, v100, v101
    v_cvt_pk_bf16_f32 v119, v102, v103
    buffer_store_dwordx4 v[116:119], v3, s[52:55], s66 offen offset:1024 sc1
    s_waitcnt vmcnt(0)
    s_barrier
    buffer_store_dwordx2 v[6:7], v4, s[52:55], s12 offen offset:0 sc1
    s_add_u32 s12, s12, 1024
    s_endpgm
L_crole:
    s_sub_u32 s5, s5, 16
    s_cmp_ge_u32 s5, 7
    s_cselect_b32 s6, 1, 0
    s_lshl_b32 s64, s4, 1
    s_add_u32 s64, s64, s6
    s_mul_i32 s7, s6, 7
    s_sub_u32 s65, s5, s7
    s_mul_i32 s66, s64, 7
    s_add_u32 s66, s66, s65
    s_lshl_b32 s6, s6, 2
    s_add_u32 s8, s6, s65
    v_and_b32 v13, 15, v2
    v_lshrrev_b32 v14, 4, v2
    s_lshl_b32 s6, s64, 4
    s_lshl_b32 s7, s3, 2
    s_add_u32 s6, s6, s7
    s_mul_i32 s6, s6, 7168
    s_lshl_b32 s7, s65, 7
    s_add_u32 s6, s6, s7
    v_mul_u32_u24 v9, 7168, v14
    v_lshl_add_u32 v9, v13, 3, v9
    v_add_u32 v9, s6, v9
    v_subrev_u32 v11, 2688, v9
    v_add_u32 v10, 3584, v9
    s_lshl_b32 s7, s65, 9
    v_lshlrev_b32 v12, 5, v13
    v_add_u32 v12, s7, v12
    s_lshl_b32 s5, s66, 2
    v_mov_b32 v5, 0
    s_add_u32 s9, s5, s3
    s_lshl_b32 s12, s9, 12
    s_waitcnt lgkmcnt(0)
    s_mov_b32 s84, s18
    s_mov_b32 s85, s19
    s_mov_b32 s86, 1835008
    s_mov_b32 s87, 0x00020000
    s_mov_b32 s88, s20
    s_mov_b32 s89, s21
    s_mov_b32 s90, 1835008
    s_mov_b32 s91, 0x00020000
    s_mov_b32 s56, s22
    s_mov_b32 s57, s23
    s_mov_b32 s58, 3584
    s_mov_b32 s59, 0x00020000
    buffer_load_dwordx4 v[56:59], v12, s[56:59], 0 offen offset:0
    buffer_load_dwordx4 v[60:63], v12, s[56:59], 0 offen offset:16
    buffer_load_dwordx2 v[16:17], v11, s[84:87], 0 offen offset:0
    buffer_load_dwordx2 v[18:19], v11, s[84:87], 0 offen offset:896
    buffer_load_dwordx2 v[20:21], v11, s[84:87], 0 offen offset:1792
    buffer_load_dwordx2 v[22:23], v9, s[84:87], 0 offen offset:0
    buffer_load_dwordx2 v[38:39], v9, s[88:91], 0 offen offset:0
    buffer_load_dwordx2 v[24:25], v9, s[84:87], 0 offen offset:896
    buffer_load_dwordx2 v[40:41], v9, s[88:91], 0 offen offset:896
    buffer_load_dwordx2 v[26:27], v9, s[84:87], 0 offen offset:1792
    buffer_load_dwordx2 v[42:43], v9, s[88:91], 0 offen offset:1792
    buffer_load_dwordx2 v[28:29], v9, s[84:87], 0 offen offset:2688
    buffer_load_dwordx2 v[44:45], v9, s[88:91], 0 offen offset:2688
    s_lshr_b32 s5, s9, 1
    s_lshl_b32 s5, s5, 2
    s_add_u32 s6, s26, s5
    s_addc_u32 s7, s27, 0
    s_load_dword s13, s[6:7], 0
    s_mul_i32 s67, s3, 26992
    v_mov_b32 v128, 0
    v_mov_b32 v129, 0
    v_mov_b32 v130, 0
    v_mov_b32 v131, 0
    v_add_u32 v8, s67, v3
    s_mov_b64 exec, 0xffffff
    ds_write_b128 v8, v[128:131] offset:0
    ds_write_b128 v8, v[128:131] offset:4640
    ds_write_b128 v8, v[128:131] offset:9280
    ds_write_b128 v8, v[128:131] offset:13920
    s_mov_b64 exec, 0xff
    ds_write_b128 v8, v[128:131] offset:18560
    ds_write_b128 v8, v[128:131] offset:22768
    s_mov_b64 exec, -1
    s_mov_b32 s52, s40
    s_mov_b32 s53, s41
    s_mov_b32 s54, 11141120
    s_mov_b32 s55, 0x00020000
    s_mov_b32 s60, s38
    s_mov_b32 s61, s39
    s_mov_b32 s62, 256
    s_mov_b32 s63, 0x00020000
    s_mov_b32 s44, s16
    s_mov_b32 s45, s17
    s_mov_b32 s46, 1835008
    s_mov_b32 s47, 0x00020000
    s_mov_b32 s48, s34
    s_mov_b32 s49, s35
    s_mov_b32 s50, 1605632
    s_mov_b32 s51, 0x00020000
    s_add_u32 s5, s8, 0
    s_and_b32 s5, s5, 7
    s_lshr_b32 s6, s5, 1
    s_mul_i32 s6, s6, 14
    s_and_b32 s5, s5, 1
    s_add_u32 s7, s6, s5
    s_add_u32 s7, s7, 12
    s_lshl_b32 s16, s7, 12
    s_mul_i32 s5, s5, 6
    s_add_u32 s6, s6, s5
    s_lshl_b32 s70, s6, 12
    s_add_u32 s5, s8, 1
    s_and_b32 s5, s5, 7
    s_lshr_b32 s6, s5, 1
    s_mul_i32 s6, s6, 14
    s_and_b32 s5, s5, 1
    s_add_u32 s7, s6, s5
    s_add_u32 s7, s7, 12
    s_lshl_b32 s17, s7, 12
    s_mul_i32 s5, s5, 6
    s_add_u32 s6, s6, s5
    s_lshl_b32 s71, s6, 12
    s_add_u32 s5, s8, 2
    s_and_b32 s5, s5, 7
    s_lshr_b32 s6, s5, 1
    s_mul_i32 s6, s6, 14
    s_and_b32 s5, s5, 1
    s_add_u32 s7, s6, s5
    s_add_u32 s7, s7, 12
    s_lshl_b32 s18, s7, 12
    s_mul_i32 s5, s5, 6
    s_add_u32 s6, s6, s5
    s_lshl_b32 s72, s6, 12
    s_add_u32 s5, s8, 3
    s_and_b32 s5, s5, 7
    s_lshr_b32 s6, s5, 1
    s_mul_i32 s6, s6, 14
    s_and_b32 s5, s5, 1
    s_add_u32 s7, s6, s5
    s_add_u32 s7, s7, 12
    s_lshl_b32 s19, s7, 12
    s_mul_i32 s5, s5, 6
    s_add_u32 s6, s6, s5
    s_lshl_b32 s73, s6, 12
    s_add_u32 s5, s8, 4
    s_and_b32 s5, s5, 7
    s_lshr_b32 s6, s5, 1
    s_mul_i32 s6, s6, 14
    s_and_b32 s5, s5, 1
    s_add_u32 s7, s6, s5
    s_add_u32 s7, s7, 12
    s_lshl_b32 s20, s7, 12
    s_mul_i32 s5, s5, 6
    s_add_u32 s6, s6, s5
    s_lshl_b32 s74, s6, 12
    s_add_u32 s5, s8, 5
    s_and_b32 s5, s5, 7
    s_lshr_b32 s6, s5, 1
    s_mul_i32 s6, s6, 14
    s_and_b32 s5, s5, 1
    s_add_u32 s7, s6, s5
    s_add_u32 s7, s7, 12
    s_lshl_b32 s21, s7, 12
    s_mul_i32 s5, s5, 6
    s_add_u32 s6, s6, s5
    s_lshl_b32 s75, s6, 12
    s_add_u32 s5, s8, 6
    s_and_b32 s5, s5, 7
    s_lshr_b32 s6, s5, 1
    s_mul_i32 s6, s6, 14
    s_and_b32 s5, s5, 1
    s_add_u32 s7, s6, s5
    s_add_u32 s7, s7, 12
    s_lshl_b32 s22, s7, 12
    s_mul_i32 s5, s5, 6
    s_add_u32 s6, s6, s5
    s_lshl_b32 s76, s6, 12
    s_add_u32 s5, s8, 7
    s_and_b32 s5, s5, 7
    s_lshr_b32 s6, s5, 1
    s_mul_i32 s6, s6, 14
    s_and_b32 s5, s5, 1
    s_add_u32 s7, s6, s5
    s_add_u32 s7, s7, 12
    s_lshl_b32 s23, s7, 12
    s_mul_i32 s5, s5, 6
    s_add_u32 s6, s6, s5
    s_lshl_b32 s77, s6, 12
    v_lshrrev_b32 v1, 3, v2
    v_and_b32 v224, 2, v1
    v_lshlrev_b32 v224, 1, v224
    v_and_b32 v15, 7, v2
    v_xor_b32 v15, v224, v15
    s_lshl_b32 s5, s3, 3
    v_add_u32 v1, s5, v1
    v_mul_u32_u24 v1, 896, v1
    v_lshl_add_u32 v1, v15, 4, v1
    s_lshl_b32 s5, s65, 7
    v_add_u32 v224, s5, v1
    s_lshl_b32 s68, s3, 10
    buffer_load_dwordx2 v[30:31], v10, s[84:87], 0 offen offset:0
    buffer_load_dwordx2 v[46:47], v10, s[88:91], 0 offen offset:0
    buffer_load_dwordx2 v[32:33], v10, s[84:87], 0 offen offset:896
    buffer_load_dwordx2 v[48:49], v10, s[88:91], 0 offen offset:896
    buffer_load_dwordx2 v[34:35], v10, s[84:87], 0 offen offset:1792
    buffer_load_dwordx2 v[50:51], v10, s[88:91], 0 offen offset:1792
    buffer_load_dwordx2 v[36:37], v10, s[84:87], 0 offen offset:2688
    buffer_load_dwordx2 v[52:53], v10, s[88:91], 0 offen offset:2688
    s_add_u32 s84, s24, s12
    s_addc_u32 s85, s25, 0
    s_mov_b32 s86, 4096
    s_mov_b32 s87, 0x00020000
    buffer_load_dwordx4 v[208:211], v3, s[84:87], 0 offen offset:0
    buffer_load_dwordx4 v[212:215], v3, s[84:87], 0 offen offset:1024
    buffer_load_dwordx4 v[216:219], v3, s[84:87], 0 offen offset:2048
    buffer_load_dwordx4 v[220:223], v3, s[84:87], 0 offen offset:3072
    buffer_load_dwordx2 v[6:7], v5, s[60:63], 0 offen sc1
    s_lshl_b32 s5, s64, 1
    s_add_u32 s5, s5, s10
    s_mul_i32 s5, s5, 229376
    s_lshl_b32 s6, s11, 11
    s_add_u32 s5, s5, s6
    s_add_u32 s56, s40, s5
    s_addc_u32 s57, s41, 0
    s_mov_b32 s58, 229376
    s_mov_b32 s59, 0x00020000
    s_waitcnt vmcnt(21)
    v_lshlrev_b32 v64, 16, v56
    v_lshlrev_b32 v65, 16, v58
    v_lshlrev_b32 v66, 16, v60
    v_lshlrev_b32 v67, 16, v62
    v_and_b32 v68, s15, v56
    v_and_b32 v69, s15, v58
    v_and_b32 v70, s15, v60
    v_and_b32 v71, s15, v62
    v_lshlrev_b32 v72, 16, v57
    v_lshlrev_b32 v73, 16, v59
    v_lshlrev_b32 v74, 16, v61
    v_lshlrev_b32 v75, 16, v63
    v_and_b32 v76, s15, v57
    v_and_b32 v77, s15, v59
    v_and_b32 v78, s15, v61
    v_and_b32 v79, s15, v63
    v_lshlrev_b32 v152, 16, v16
    v_and_b32 v153, s15, v16
    v_lshlrev_b32 v154, 16, v17
    v_and_b32 v155, s15, v17
    v_lshlrev_b32 v156, 16, v18
    v_and_b32 v157, s15, v18
    v_lshlrev_b32 v158, 16, v19
    v_and_b32 v159, s15, v19
    v_lshlrev_b32 v160, 16, v20
    v_and_b32 v161, s15, v20
    v_lshlrev_b32 v162, 16, v21
    v_and_b32 v163, s15, v21
    s_waitcnt vmcnt(19)
    v_lshlrev_b32 v164, 16, v22
    v_and_b32 v165, s15, v22
    v_lshlrev_b32 v166, 16, v23
    v_and_b32 v167, s15, v23
    v_lshlrev_b32 v196, 16, v38
    v_and_b32 v197, s15, v38
    v_lshlrev_b32 v198, 16, v39
    v_and_b32 v199, s15, v39
    v_pk_mul_f32 v[80:81], v[64:65], v[164:165]
    v_pk_mul_f32 v[82:83], v[66:67], v[166:167]
    v_pk_fma_f32 v[80:81], v[68:69], v[160:161], v[80:81]
    v_pk_fma_f32 v[82:83], v[70:71], v[162:163], v[82:83]
    v_pk_fma_f32 v[80:81], v[72:73], v[156:157], v[80:81]
    v_pk_fma_f32 v[82:83], v[74:75], v[158:159], v[82:83]
    v_pk_fma_f32 v[80:81], v[76:77], v[152:153], v[80:81]
    v_pk_fma_f32 v[82:83], v[78:79], v[154:155], v[82:83]
    v_pk_mul_f32 v[80:81], v[80:81], v[196:197]
    v_pk_mul_f32 v[82:83], v[82:83], v[198:199]
    s_waitcnt vmcnt(17)
    v_lshlrev_b32 v168, 16, v24
    v_and_b32 v169, s15, v24
    v_lshlrev_b32 v170, 16, v25
    v_and_b32 v171, s15, v25
    v_lshlrev_b32 v196, 16, v40
    v_and_b32 v197, s15, v40
    v_lshlrev_b32 v198, 16, v41
    v_and_b32 v199, s15, v41
    v_pk_mul_f32 v[84:85], v[64:65], v[168:169]
    v_pk_mul_f32 v[86:87], v[66:67], v[170:171]
    v_pk_fma_f32 v[84:85], v[68:69], v[164:165], v[84:85]
    v_pk_fma_f32 v[86:87], v[70:71], v[166:167], v[86:87]
    v_pk_fma_f32 v[84:85], v[72:73], v[160:161], v[84:85]
    v_pk_fma_f32 v[86:87], v[74:75], v[162:163], v[86:87]
    v_pk_fma_f32 v[84:85], v[76:77], v[156:157], v[84:85]
    v_pk_fma_f32 v[86:87], v[78:79], v[158:159], v[86:87]
    v_pk_mul_f32 v[84:85], v[84:85], v[196:197]
    v_pk_mul_f32 v[86:87], v[86:87], v[198:199]
    s_waitcnt vmcnt(15)
    v_lshlrev_b32 v172, 16, v26
    v_and_b32 v173, s15, v26
    v_lshlrev_b32 v174, 16, v27
    v_and_b32 v175, s15, v27
    v_lshlrev_b32 v196, 16, v42
    v_and_b32 v197, s15, v42
    v_lshlrev_b32 v198, 16, v43
    v_and_b32 v199, s15, v43
    v_pk_mul_f32 v[88:89], v[64:65], v[172:173]
    v_pk_mul_f32 v[90:91], v[66:67], v[174:175]
    v_pk_fma_f32 v[88:89], v[68:69], v[168:169], v[88:89]
    v_pk_fma_f32 v[90:91], v[70:71], v[170:171], v[90:91]
    v_pk_fma_f32 v[88:89], v[72:73], v[164:165], v[88:89]
    v_pk_fma_f32 v[90:91], v[74:75], v[166:167], v[90:91]
    v_pk_fma_f32 v[88:89], v[76:77], v[160:161], v[88:89]
    v_pk_fma_f32 v[90:91], v[78:79], v[162:163], v[90:91]
    v_pk_mul_f32 v[88:89], v[88:89], v[196:197]
    v_pk_mul_f32 v[90:91], v[90:91], v[198:199]
    s_waitcnt vmcnt(13)
    v_lshlrev_b32 v176, 16, v28
    v_and_b32 v177, s15, v28
    v_lshlrev_b32 v178, 16, v29
    v_and_b32 v179, s15, v29
    v_lshlrev_b32 v196, 16, v44
    v_and_b32 v197, s15, v44
    v_lshlrev_b32 v198, 16, v45
    v_and_b32 v199, s15, v45
    v_pk_mul_f32 v[92:93], v[64:65], v[176:177]
    v_pk_mul_f32 v[94:95], v[66:67], v[178:179]
    v_pk_fma_f32 v[92:93], v[68:69], v[172:173], v[92:93]
    v_pk_fma_f32 v[94:95], v[70:71], v[174:175], v[94:95]
    v_pk_fma_f32 v[92:93], v[72:73], v[168:169], v[92:93]
    v_pk_fma_f32 v[94:95], v[74:75], v[170:171], v[94:95]
    v_pk_fma_f32 v[92:93], v[76:77], v[164:165], v[92:93]
    v_pk_fma_f32 v[94:95], v[78:79], v[166:167], v[94:95]
    v_pk_mul_f32 v[92:93], v[92:93], v[196:197]
    v_pk_mul_f32 v[94:95], v[94:95], v[198:199]
    s_waitcnt vmcnt(11)
    v_lshlrev_b32 v180, 16, v30
    v_and_b32 v181, s15, v30
    v_lshlrev_b32 v182, 16, v31
    v_and_b32 v183, s15, v31
    v_lshlrev_b32 v196, 16, v46
    v_and_b32 v197, s15, v46
    v_lshlrev_b32 v198, 16, v47
    v_and_b32 v199, s15, v47
    v_pk_mul_f32 v[96:97], v[64:65], v[180:181]
    v_pk_mul_f32 v[98:99], v[66:67], v[182:183]
    v_pk_fma_f32 v[96:97], v[68:69], v[176:177], v[96:97]
    v_pk_fma_f32 v[98:99], v[70:71], v[178:179], v[98:99]
    v_pk_fma_f32 v[96:97], v[72:73], v[172:173], v[96:97]
    v_pk_fma_f32 v[98:99], v[74:75], v[174:175], v[98:99]
    v_pk_fma_f32 v[96:97], v[76:77], v[168:169], v[96:97]
    v_pk_fma_f32 v[98:99], v[78:79], v[170:171], v[98:99]
    v_pk_mul_f32 v[96:97], v[96:97], v[196:197]
    v_pk_mul_f32 v[98:99], v[98:99], v[198:199]
    s_waitcnt vmcnt(9)
    v_lshlrev_b32 v184, 16, v32
    v_and_b32 v185, s15, v32
    v_lshlrev_b32 v186, 16, v33
    v_and_b32 v187, s15, v33
    v_lshlrev_b32 v196, 16, v48
    v_and_b32 v197, s15, v48
    v_lshlrev_b32 v198, 16, v49
    v_and_b32 v199, s15, v49
    v_pk_mul_f32 v[100:101], v[64:65], v[184:185]
    v_pk_mul_f32 v[102:103], v[66:67], v[186:187]
    v_pk_fma_f32 v[100:101], v[68:69], v[180:181], v[100:101]
    v_pk_fma_f32 v[102:103], v[70:71], v[182:183], v[102:103]
    v_pk_fma_f32 v[100:101], v[72:73], v[176:177], v[100:101]
    v_pk_fma_f32 v[102:103], v[74:75], v[178:179], v[102:103]
    v_pk_fma_f32 v[100:101], v[76:77], v[172:173], v[100:101]
    v_pk_fma_f32 v[102:103], v[78:79], v[174:175], v[102:103]
    v_pk_mul_f32 v[100:101], v[100:101], v[196:197]
    v_pk_mul_f32 v[102:103], v[102:103], v[198:199]
    s_waitcnt vmcnt(7)
    v_lshlrev_b32 v188, 16, v34
    v_and_b32 v189, s15, v34
    v_lshlrev_b32 v190, 16, v35
    v_and_b32 v191, s15, v35
    v_lshlrev_b32 v196, 16, v50
    v_and_b32 v197, s15, v50
    v_lshlrev_b32 v198, 16, v51
    v_and_b32 v199, s15, v51
    v_pk_mul_f32 v[104:105], v[64:65], v[188:189]
    v_pk_mul_f32 v[106:107], v[66:67], v[190:191]
    v_pk_fma_f32 v[104:105], v[68:69], v[184:185], v[104:105]
    v_pk_fma_f32 v[106:107], v[70:71], v[186:187], v[106:107]
    v_pk_fma_f32 v[104:105], v[72:73], v[180:181], v[104:105]
    v_pk_fma_f32 v[106:107], v[74:75], v[182:183], v[106:107]
    v_pk_fma_f32 v[104:105], v[76:77], v[176:177], v[104:105]
    v_pk_fma_f32 v[106:107], v[78:79], v[178:179], v[106:107]
    v_pk_mul_f32 v[104:105], v[104:105], v[196:197]
    v_pk_mul_f32 v[106:107], v[106:107], v[198:199]
    s_waitcnt vmcnt(5)
    v_lshlrev_b32 v192, 16, v36
    v_and_b32 v193, s15, v36
    v_lshlrev_b32 v194, 16, v37
    v_and_b32 v195, s15, v37
    v_lshlrev_b32 v196, 16, v52
    v_and_b32 v197, s15, v52
    v_lshlrev_b32 v198, 16, v53
    v_and_b32 v199, s15, v53
    v_pk_mul_f32 v[108:109], v[64:65], v[192:193]
    v_pk_mul_f32 v[110:111], v[66:67], v[194:195]
    v_pk_fma_f32 v[108:109], v[68:69], v[188:189], v[108:109]
    v_pk_fma_f32 v[110:111], v[70:71], v[190:191], v[110:111]
    v_pk_fma_f32 v[108:109], v[72:73], v[184:185], v[108:109]
    v_pk_fma_f32 v[110:111], v[74:75], v[186:187], v[110:111]
    v_pk_fma_f32 v[108:109], v[76:77], v[180:181], v[108:109]
    v_pk_fma_f32 v[110:111], v[78:79], v[182:183], v[110:111]
    v_pk_mul_f32 v[108:109], v[108:109], v[196:197]
    v_pk_mul_f32 v[110:111], v[110:111], v[198:199]
    s_lshl_b32 s5, s3, 2
    v_add_u32 v8, s5, v14
    v_and_b32 v10, 7, v13
    v_xor_b32 v8, v8, v10
    v_lshlrev_b32 v10, 10, v13
    v_lshl_add_u32 v8, v8, 4, v10
    v_add_u32 v8, 144896, v8
    v_cvt_pk_bf16_f32 v112, v108, v104
    v_cvt_pk_bf16_f32 v113, v100, v96
    v_cvt_pk_bf16_f32 v114, v92, v88
    v_cvt_pk_bf16_f32 v115, v84, v80
    ds_write_b128 v8, v[112:115] offset:0
    v_cvt_pk_bf16_f32 v116, v109, v105
    v_cvt_pk_bf16_f32 v117, v101, v97
    v_cvt_pk_bf16_f32 v118, v93, v89
    v_cvt_pk_bf16_f32 v119, v85, v81
    ds_write_b128 v8, v[116:119] offset:256
    v_cvt_pk_bf16_f32 v120, v110, v106
    v_cvt_pk_bf16_f32 v121, v102, v98
    v_cvt_pk_bf16_f32 v122, v94, v90
    v_cvt_pk_bf16_f32 v123, v86, v82
    ds_write_b128 v8, v[120:123] offset:512
    v_cvt_pk_bf16_f32 v124, v111, v107
    v_cvt_pk_bf16_f32 v125, v103, v99
    v_cvt_pk_bf16_f32 v126, v95, v91
    v_cvt_pk_bf16_f32 v127, v87, v83
    ds_write_b128 v8, v[124:127] offset:768
    s_lshl_b32 s5, s11, 6
    v_xor_b32 v12, s5, v3
    s_add_u32 s5, s14, 144896
    v_add_u32 v12, s5, v12
    v_lshlrev_b32 v11, 12, v14
    v_lshl_add_u32 v11, v13, 4, v11
    s_lshl_b32 s5, s65, 2
    s_add_u32 s5, s5, s3
    s_lshl_b32 s6, s5, 16
    s_lshl_b32 s7, s64, 8
    s_add_u32 s6, s6, s7
    s_add_u32 s6, s6, 7340032
    s_lshl_b32 s5, s65, 4
    s_add_u32 s5, s5, s64
    s_lshl_b32 s5, s5, 7
    s_add_u32 s4, s5, 11042816
    s_waitcnt lgkmcnt(0)
    s_barrier
    ds_read_b128 v[112:115], v12 offset:0
    v_xor_b32 v8, 16, v12
    ds_read_b128 v[116:119], v8 offset:1024
    v_xor_b32 v8, 32, v12
    ds_read_b128 v[120:123], v8 offset:2048
    v_xor_b32 v8, 48, v12
    ds_read_b128 v[124:127], v8 offset:3072
    s_add_u32 s7, s6, 0
    s_waitcnt lgkmcnt(3)
    buffer_store_dwordx4 v[112:115], v11, s[52:55], s7 offen sc1
    s_add_u32 s7, s6, 16384
    s_waitcnt lgkmcnt(2)
    buffer_store_dwordx4 v[116:119], v11, s[52:55], s7 offen sc1
    s_add_u32 s7, s6, 32768
    s_waitcnt lgkmcnt(1)
    buffer_store_dwordx4 v[120:123], v11, s[52:55], s7 offen sc1
    s_add_u32 s7, s6, 49152
    s_waitcnt lgkmcnt(0)
    buffer_store_dwordx4 v[124:127], v11, s[52:55], s7 offen sc1
    s_mul_i32 s101, s70, 7
    s_add_u32 s101, s101, 0
    s_add_u32 m0, s68, 108032
    s_nop 0
    buffer_load_dwordx4 v224, s[48:51], s101 offen lds
    s_mul_i32 s101, s70, 7
    s_add_u32 s101, s101, 28672
    s_add_u32 m0, s68, 112128
    s_nop 0
    buffer_load_dwordx4 v224, s[48:51], s101 offen lds
    s_mul_i32 s101, s71, 7
    s_add_u32 s101, s101, 0
    s_add_u32 m0, s68, 116224
    s_nop 0
    buffer_load_dwordx4 v224, s[48:51], s101 offen lds
    s_mul_i32 s101, s71, 7
    s_add_u32 s101, s101, 28672
    s_add_u32 m0, s68, 120320
    s_nop 0
    buffer_load_dwordx4 v224, s[48:51], s101 offen lds
    v_add_u32 v8, s67, v3
    s_waitcnt vmcnt(12)
    v_mov_b32 v164, 0
    v_mov_b32 v165, 0
    ds_write_b128 v8, v[208:211] offset:14304
    s_nop 0
    v_mov_b32_dpp v165, v211 wave_shr:1 row_mask:0xf bank_mask:0xf
    v_mov_b32_dpp v164, v210 wave_shr:1 row_mask:0xf bank_mask:0xf
    v_alignbit_b32 v153, v209, v208, 16
    v_alignbit_b32 v154, v210, v209, 16
    v_alignbit_b32 v155, v211, v210, 16
    v_alignbit_b32 v152, v208, v165, 16
    ds_write_b128 v8, v[152:155] offset:9664
    v_mov_b32 v156, v165
    v_mov_b32 v157, v208
    v_mov_b32 v158, v209
    v_mov_b32 v159, v210
    ds_write_b128 v8, v[156:159] offset:5024
    v_alignbit_b32 v160, v165, v164, 16
    v_mov_b32 v161, v152
    v_mov_b32 v162, v153
    v_mov_b32 v163, v154
    ds_write_b128 v8, v[160:163] offset:384
    s_waitcnt vmcnt(11)
    v_readlane_b32 s5, v210, 63
    v_readlane_b32 s7, v211, 63
    s_nop 1
    v_mov_b32 v184, s5
    v_mov_b32 v185, s7
    ds_write_b128 v8, v[212:215] offset:15328
    s_nop 0
    v_mov_b32_dpp v185, v215 wave_shr:1 row_mask:0xf bank_mask:0xf
    v_mov_b32_dpp v184, v214 wave_shr:1 row_mask:0xf bank_mask:0xf
    v_alignbit_b32 v173, v213, v212, 16
    v_alignbit_b32 v174, v214, v213, 16
    v_alignbit_b32 v175, v215, v214, 16
    v_alignbit_b32 v172, v212, v185, 16
    ds_write_b128 v8, v[172:175] offset:10688
    v_mov_b32 v176, v185
    v_mov_b32 v177, v212
    v_mov_b32 v178, v213
    v_mov_b32 v179, v214
    ds_write_b128 v8, v[176:179] offset:6048
    v_alignbit_b32 v180, v185, v184, 16
    v_mov_b32 v181, v172
    v_mov_b32 v182, v173
    v_mov_b32 v183, v174
    ds_write_b128 v8, v[180:183] offset:1408
    s_waitcnt vmcnt(8)
    v_readfirstlane_b32 s43, v7
    v_readfirstlane_b32 s42, v6
    s_cmp_lg_u32 s43, 0
    s_cbranch_scc1 L_ctag_ok
L_ctag_retry:
    s_add_u32 s100, s100, 1
    s_cmp_gt_u32 s100, 200000
    s_cbranch_scc1 L_ctag_ok
    s_sleep 8
    buffer_load_dwordx2 v[6:7], v5, s[60:63], 0 offen sc1
    s_waitcnt vmcnt(0)
    v_readfirstlane_b32 s43, v7
    v_readfirstlane_b32 s42, v6
    s_cmp_lg_u32 s43, 0
    s_cbranch_scc0 L_ctag_retry
L_ctag_ok:
    s_waitcnt vmcnt(4)
    s_barrier
    buffer_store_dwordx2 v[6:7], v4, s[52:55], s4 offen offset:0 sc1
    s_mul_i32 s101, s72, 7
    s_add_u32 s101, s101, 0
    s_add_u32 m0, s68, 124416
    s_nop 0
    buffer_load_dwordx4 v224, s[48:51], s101 offen lds
    s_mul_i32 s101, s72, 7
    s_add_u32 s101, s101, 28672
    s_add_u32 m0, s68, 128512
    s_nop 0
    buffer_load_dwordx4 v224, s[48:51], s101 offen lds
    s_mul_i32 s101, s73, 7
    s_add_u32 s101, s101, 0
    s_add_u32 m0, s68, 132608
    s_nop 0
    buffer_load_dwordx4 v224, s[48:51], s101 offen lds
    s_mul_i32 s101, s73, 7
    s_add_u32 s101, s101, 28672
    s_add_u32 m0, s68, 136704
    s_nop 0
    buffer_load_dwordx4 v224, s[48:51], s101 offen lds
    v_readlane_b32 s5, v214, 63
    v_readlane_b32 s7, v215, 63
    s_nop 1
    v_mov_b32 v164, s5
    v_mov_b32 v165, s7
    ds_write_b128 v8, v[216:219] offset:16352
    s_nop 0
    v_mov_b32_dpp v165, v219 wave_shr:1 row_mask:0xf bank_mask:0xf
    v_mov_b32_dpp v164, v218 wave_shr:1 row_mask:0xf bank_mask:0xf
    v_alignbit_b32 v153, v217, v216, 16
    v_alignbit_b32 v154, v218, v217, 16
    v_alignbit_b32 v155, v219, v218, 16
    v_alignbit_b32 v152, v216, v165, 16
    ds_write_b128 v8, v[152:155] offset:11712
    v_mov_b32 v156, v165
    v_mov_b32 v157, v216
    v_mov_b32 v158, v217
    v_mov_b32 v159, v218
    ds_write_b128 v8, v[156:159] offset:7072
    v_alignbit_b32 v160, v165, v164, 16
    v_mov_b32 v161, v152
    v_mov_b32 v162, v153
    v_mov_b32 v163, v154
    ds_write_b128 v8, v[160:163] offset:2432
    v_readlane_b32 s5, v218, 63
    v_readlane_b32 s7, v219, 63
    s_nop 1
    v_mov_b32 v184, s5
    v_mov_b32 v185, s7
    ds_write_b128 v8, v[220:223] offset:17376
    s_nop 0
    v_mov_b32_dpp v185, v223 wave_shr:1 row_mask:0xf bank_mask:0xf
    v_mov_b32_dpp v184, v222 wave_shr:1 row_mask:0xf bank_mask:0xf
    v_alignbit_b32 v173, v221, v220, 16
    v_alignbit_b32 v174, v222, v221, 16
    v_alignbit_b32 v175, v223, v222, 16
    v_alignbit_b32 v172, v220, v185, 16
    ds_write_b128 v8, v[172:175] offset:12736
    v_mov_b32 v176, v185
    v_mov_b32 v177, v220
    v_mov_b32 v178, v221
    v_mov_b32 v179, v222
    ds_write_b128 v8, v[176:179] offset:8096
    v_alignbit_b32 v180, v185, v184, 16
    v_mov_b32 v181, v172
    v_mov_b32 v182, v173
    v_mov_b32 v183, v174
    ds_write_b128 v8, v[180:183] offset:3456
    v_and_b32 v8, 15, v2
    v_lshrrev_b32 v9, 4, v2
    v_bfe_u32 v10, v2, 2, 2
    v_and_b32 v11, 3, v2
    v_mul_u32_u24 v225, 4640, v11
    v_lshl_add_u32 v12, v10, 3, v9
    v_lshl_add_u32 v225, v12, 4, v225
    v_add_u32 v225, s67, v225
    v_add_u32 v12, 7, v8
    v_lshrrev_b32 v12, 1, v12
    v_sub_u32 v12, v12, v9
    v_lshlrev_b32 v12, 4, v12
    v_and_b32 v13, 1, v2
    v_mul_u32_u24 v13, 4208, v13
    s_add_u32 s5, s67, 18560
    v_add3_u32 v226, v12, v13, s5
    v_lshrrev_b32 v14, 5, v2
    v_lshl_add_u32 v12, v14, 2, v10
    v_lshlrev_b32 v13, 7, v12
    v_lshl_add_u32 v13, v11, 3, v13
    v_and_b32 v12, 1, v9
    v_lshl_add_u32 v13, v12, 5, v13
    v_lshrrev_b32 v12, 1, v10
    v_lshl_add_u32 v228, v12, 6, v13
    v_xor_b32 v229, 64, v228
    v_add_u32 v230, 65536, v228
    v_add_u32 v231, 65536, v229
    v_add_u32 v232, 131072, v228
    v_add_u32 v233, 131072, v229
    v_and_b32 v12, 1, v9
    v_lshlrev_b32 v12, 10, v12
    v_lshl_add_u32 v12, v14, 8, v12
    v_lshl_add_u32 v234, v8, 4, v12
    s_mul_i32 s5, s3, 4736
    s_add_u32 s5, s5, 144896
    v_lshrrev_b32 v12, 3, v2
    v_and_b32 v13, 7, v2
    v_mul_u32_u24 v240, 144, v12
    v_lshl_add_u32 v240, v13, 4, v240
    v_add_u32 v240, s5, v240
    v_and_b32 v15, 31, v2
    v_mul_u32_u24 v241, 144, v15
    v_lshl_add_u32 v241, v14, 3, v241
    v_add_u32 v241, s5, v241
    v_mul_u32_u24 v242, 72, v12
    v_lshl_add_u32 v242, v13, 3, v242
    v_add_u32 v242, s5, v242
    v_lshl_add_u32 v14, v14, 2, v10
    v_mul_u32_u24 v243, 72, v14
    v_lshl_add_u32 v243, v11, 3, v243
    v_and_b32 v14, 1, v9
    v_lshl_add_u32 v243, v14, 5, v243
    v_add_u32 v243, s5, v243
    v_lshlrev_b32 v244, 12, v12
    v_lshl_add_u32 v244, v13, 4, v244
    v_mul_u32_u24 v245, 896, v12
    v_lshl_add_u32 v245, v13, 4, v245
    v_add_u32 v246, s68, v3
    v_add_u32 v247, 0x10000, v246
    v_add_u32 v248, 0x20000, v246
    v_lshlrev_b32 v227, 2, v15
    s_lshl_b32 s5, s64, 2
    s_add_u32 s5, s5, s3
    s_mul_i32 s78, s5, 28672
    s_lshl_b32 s6, s65, 7
    s_add_u32 s78, s78, s6
    s_lshl_b32 s80, s5, 7
    s_and_b32 s79, s80, 0x380
    s_add_u32 s80, s80, 11010048
    s_lshl_b32 s6, s65, 18
    s_add_u32 s79, s79, s6
    s_lshr_b32 s6, s64, 2
    s_lshl_b32 s6, s6, 10
    s_add_u32 s79, s79, s6
    s_and_b32 s6, s64, 2
    s_lshl_b32 s6, s6, 2
    s_add_u32 s79, s79, s6
    s_add_u32 s79, s79, 9175040
    s_lshl_b32 s5, s64, 12
    s_add_u32 s69, s5, 11057152
    s_lshr_b32 s5, s66, 4
    s_lshl_b32 s5, s5, 11
    s_add_u32 s4, s5, 11042816
    v_lshlrev_b32 v1, 7, v8
    buffer_load_dwordx2 v[14:15], v1, s[52:55], s4 offen offset:0 sc1
    s_waitcnt vmcnt(0)
    v_cmp_ne_u64 vcc, s[42:43], v[14:15]
    s_nop 0
    s_cmp_eq_u64 vcc, 0
    s_cbranch_scc1 L_p1_ok
L_p1_retry:
    s_add_u32 s100, s100, 1
    s_cmp_gt_u32 s100, 200000
    s_cbranch_scc1 L_p1_ok
    s_sleep 2
    buffer_load_dwordx2 v[14:15], v1, s[52:55], s4 offen offset:0 sc1
    s_waitcnt vmcnt(0)
    v_cmp_ne_u64 vcc, s[42:43], v[14:15]
    s_nop 0
    s_cmp_eq_u64 vcc, 0
    s_cbranch_scc0 L_p1_retry
L_p1_ok:
    s_add_u32 s5, s12, 7340032
    buffer_load_dwordx4 v[112:115], v3, s[52:55], s5 offen offset:0 sc1
    buffer_load_dwordx4 v[116:119], v3, s[52:55], s5 offen offset:1024 sc1
    buffer_load_dwordx4 v[120:123], v3, s[52:55], s5 offen offset:2048 sc1
    buffer_load_dwordx4 v[124:127], v3, s[52:55], s5 offen offset:3072 sc1
    s_add_u32 s5, s78, 0
    buffer_load_dwordx4 v[176:179], v245, s[44:47], s5 offen
    s_add_u32 s5, s78, 7168
    buffer_load_dwordx4 v[180:183], v245, s[44:47], s5 offen
    s_add_u32 s5, s78, 14336
    buffer_load_dwordx4 v[184:187], v245, s[44:47], s5 offen
    s_add_u32 s5, s78, 21504
    buffer_load_dwordx4 v[188:191], v245, s[44:47], s5 offen
    s_mul_i32 s101, s70, 7
    s_add_u32 s101, s101, 57344
    buffer_load_dwordx4 a[28:31], v224, s[48:51], s101 offen
    s_mul_i32 s101, s70, 7
    s_add_u32 s101, s101, 86016
    buffer_load_dwordx4 a[32:35], v224, s[48:51], s101 offen
    s_mul_i32 s101, s71, 7
    s_add_u32 s101, s101, 57344
    buffer_load_dwordx4 a[36:39], v224, s[48:51], s101 offen
    s_mul_i32 s101, s71, 7
    s_add_u32 s101, s101, 86016
    buffer_load_dwordx4 a[40:43], v224, s[48:51], s101 offen
    s_add_u32 s5, s67, 18672
    v_add_u32 v8, s5, v3
    v_and_b32 v1, 7, v2
    v_lshlrev_b32 v1, 7, v1
    s_waitcnt vmcnt(11)
    ds_write_b128 v8, v[112:115] offset:4224
    ds_write2_b64 v8, v[114:115], v[112:113] offset0:0 offset1:3
    v_add_u32 v8, 1024, v8
    s_waitcnt vmcnt(10)
    ds_write_b128 v8, v[116:119] offset:4224
    ds_write2_b64 v8, v[118:119], v[116:117] offset0:0 offset1:3
    v_add_u32 v8, 1024, v8
    s_waitcnt vmcnt(9)
    ds_write_b128 v8, v[120:123] offset:4224
    ds_write2_b64 v8, v[122:123], v[120:121] offset0:0 offset1:3
    v_add_u32 v8, 1024, v8
    s_waitcnt vmcnt(8)
    ds_write_b128 v8, v[124:127] offset:4224
    ds_write2_b64 v8, v[126:127], v[124:125] offset0:0 offset1:3
    ds_read_b128 a[188:191], v225 offset:0
    ds_read_b128 a[192:195], v226 offset:4032
    ds_read_b128 a[196:199], v226 offset:3520
    ds_read_b128 a[200:203], v226 offset:3008
    ds_read_b128 a[204:207], v226 offset:2496
    ds_read_b128 a[208:211], v226 offset:1984
    ds_read_b128 a[212:215], v226 offset:1472
    ds_read_b128 a[216:219], v226 offset:960
    s_waitcnt lgkmcnt(6)
    v_mfma_f32_16x16x32_bf16 v[44:47], a[188:191], a[192:195], 0
    ds_read_b128 a[220:223], v226 offset:448
    s_mul_i32 s101, s72, 7
    s_add_u32 s101, s101, 57344
    buffer_load_dwordx4 a[44:47], v224, s[48:51], s101 offen
    s_add_u32 s5, s67, 22896
    s_waitcnt lgkmcnt(6)
    v_mfma_f32_16x16x32_bf16 v[40:43], a[188:191], a[196:199], 0
    ds_read_b128 a[224:227], v225 offset:512
    v_xor_b32 v9, 1, v2
    s_waitcnt lgkmcnt(6)
    v_mfma_f32_16x16x32_bf16 v[36:39], a[188:191], a[200:203], 0
    ds_read_b128 a[228:231], v225 offset:1024
    v_lshl_add_u32 v9, v9, 3, s5
    s_waitcnt lgkmcnt(6)
    v_mfma_f32_16x16x32_bf16 v[32:35], a[188:191], a[204:207], 0
    ds_read_b128 a[232:235], v225 offset:1536
    ds_read_b64 v[208:209], v9 offset:0
    s_waitcnt lgkmcnt(7)
    v_mfma_f32_16x16x32_bf16 v[28:31], a[188:191], a[208:211], 0
    ds_read_b128 a[236:239], v225 offset:2048
    ds_read_b64 v[210:211], v9 offset:512
    s_waitcnt lgkmcnt(8)
    v_mfma_f32_16x16x32_bf16 v[24:27], a[188:191], a[212:215], 0
    ds_read_b128 a[240:243], v225 offset:2560
    ds_read_b64 v[212:213], v9 offset:1024
    s_waitcnt lgkmcnt(9)
    v_mfma_f32_16x16x32_bf16 v[20:23], a[188:191], a[216:219], 0
    ds_read_b128 a[244:247], v225 offset:3072
    ds_read_b64 v[214:215], v9 offset:1536
    s_waitcnt lgkmcnt(10)
    v_mfma_f32_16x16x32_bf16 v[16:19], a[188:191], a[220:223], 0
    ds_read_b128 a[248:251], v225 offset:3584
    s_mul_i32 s101, s72, 7
    s_add_u32 s101, s101, 86016
    buffer_load_dwordx4 a[48:51], v224, s[48:51], s101 offen
    ds_read_b64 v[216:217], v9 offset:2048
    s_waitcnt lgkmcnt(11)
    v_mfma_f32_16x16x32_bf16 v[44:47], a[224:227], a[196:199], v[44:47]
    ds_read_b128 a[252:255], v225 offset:64
    ds_read_b64 v[218:219], v9 offset:2560
    v_mfma_f32_16x16x32_bf16 v[40:43], a[224:227], a[200:203], v[40:43]
    ds_read_b128 a[192:195], v226 offset:3968
    ds_read_b64 v[220:221], v9 offset:3072
    v_mfma_f32_16x16x32_bf16 v[36:39], a[224:227], a[204:207], v[36:39]
    ds_read_b128 a[188:191], v226 offset:3456
    ds_read_b64 v[222:223], v9 offset:3584
    v_mfma_f32_16x16x32_bf16 v[32:35], a[224:227], a[208:211], v[32:35]
    ds_read_b128 a[196:199], v226 offset:2944
    s_bitcmp1_b32 s9, 0
    s_cselect_b32 s5, 0, 16
    s_lshl_b32 s13, s13, s5
    s_and_b32 s13, s13, s15
    v_mfma_f32_16x16x32_bf16 v[28:31], a[224:227], a[212:215], v[28:31]
    s_waitcnt lgkmcnt(1)
    v_mfma_f32_16x16x32_bf16 v[24:27], a[224:227], a[216:219], v[24:27]
    v_and_b32 v80, s15, v209
    v_mfma_f32_16x16x32_bf16 v[20:23], a[224:227], a[220:223], v[20:23]
    ds_read_b128 a[224:227], v226 offset:2432
    s_mul_i32 s101, s73, 7
    s_add_u32 s101, s101, 57344
    buffer_load_dwordx4 a[52:55], v224, s[48:51], s101 offen
    v_lshlrev_b32 v81, 16, v209
    v_mfma_f32_16x16x32_bf16 v[44:47], a[228:231], a[200:203], v[44:47]
    ds_read_b128 a[200:203], v226 offset:1920
    v_and_b32 v82, s15, v208
    v_mfma_f32_16x16x32_bf16 v[40:43], a[228:231], a[204:207], v[40:43]
    v_lshlrev_b32 v83, 16, v208
    v_mfma_f32_16x16x32_bf16 v[36:39], a[228:231], a[208:211], v[36:39]
    v_and_b32 v84, s15, v211
    v_mfma_f32_16x16x32_bf16 v[32:35], a[228:231], a[212:215], v[32:35]
    v_lshlrev_b32 v85, 16, v211
    v_mfma_f32_16x16x32_bf16 v[28:31], a[228:231], a[216:219], v[28:31]
    v_and_b32 v86, s15, v210
    v_mfma_f32_16x16x32_bf16 v[24:27], a[228:231], a[220:223], v[24:27]
    ds_read_b128 a[228:231], v226 offset:1408
    v_lshlrev_b32 v87, 16, v210
    v_mfma_f32_16x16x32_bf16 v[44:47], a[232:235], a[204:207], v[44:47]
    ds_read_b128 a[204:207], v226 offset:896
    s_mul_i32 s101, s73, 7
    s_add_u32 s101, s101, 86016
    buffer_load_dwordx4 a[56:59], v224, s[48:51], s101 offen
    v_and_b32 v88, s15, v213
    v_mfma_f32_16x16x32_bf16 v[40:43], a[232:235], a[208:211], v[40:43]
    v_lshlrev_b32 v89, 16, v213
    v_mfma_f32_16x16x32_bf16 v[36:39], a[232:235], a[212:215], v[36:39]
    v_and_b32 v90, s15, v212
    v_mfma_f32_16x16x32_bf16 v[32:35], a[232:235], a[216:219], v[32:35]
    v_lshlrev_b32 v91, 16, v212
    v_mfma_f32_16x16x32_bf16 v[28:31], a[232:235], a[220:223], v[28:31]
    ds_read_b128 a[232:235], v226 offset:384
    v_and_b32 v92, s15, v215
    v_mfma_f32_16x16x32_bf16 v[44:47], a[236:239], a[208:211], v[44:47]
    ds_read_b128 a[208:211], v225 offset:576
    v_lshlrev_b32 v93, 16, v215
    v_mfma_f32_16x16x32_bf16 v[40:43], a[236:239], a[212:215], v[40:43]
    v_and_b32 v94, s15, v214
    v_mfma_f32_16x16x32_bf16 v[36:39], a[236:239], a[216:219], v[36:39]
    s_mul_i32 s101, s70, 7
    s_add_u32 s101, s101, 114688
    buffer_load_dwordx4 a[92:95], v224, s[48:51], s101 offen
    v_lshlrev_b32 v95, 16, v214
    v_mfma_f32_16x16x32_bf16 v[32:35], a[236:239], a[220:223], v[32:35]
    ds_read_b128 a[236:239], v225 offset:1088
    v_and_b32 v96, s15, v217
    v_mfma_f32_16x16x32_bf16 v[44:47], a[240:243], a[212:215], v[44:47]
    ds_read_b128 a[212:215], v225 offset:1600
    v_lshlrev_b32 v97, 16, v217
    v_mfma_f32_16x16x32_bf16 v[40:43], a[240:243], a[216:219], v[40:43]
    v_and_b32 v98, s15, v216
    v_mfma_f32_16x16x32_bf16 v[36:39], a[240:243], a[220:223], v[36:39]
    ds_read_b128 a[240:243], v225 offset:2112
    v_lshlrev_b32 v99, 16, v216
    v_mfma_f32_16x16x32_bf16 v[44:47], a[244:247], a[216:219], v[44:47]
    ds_read_b128 a[216:219], v225 offset:2624
    v_and_b32 v100, s15, v219
    v_mfma_f32_16x16x32_bf16 v[40:43], a[244:247], a[220:223], v[40:43]
    ds_read_b128 a[244:247], v225 offset:3136
    v_lshlrev_b32 v101, 16, v219
    v_mfma_f32_16x16x32_bf16 v[44:47], a[248:251], a[220:223], v[44:47]
    ds_read_b128 a[248:251], v225 offset:3648
    s_mul_i32 s101, s70, 7
    s_add_u32 s101, s101, 143360
    buffer_load_dwordx4 a[96:99], v224, s[48:51], s101 offen
    v_and_b32 v102, s15, v218
    v_mfma_f32_16x16x32_bf16 v[44:47], a[252:255], a[192:195], v[44:47]
    ds_read_b128 a[220:223], v225 offset:128
    v_lshlrev_b32 v103, 16, v218
    v_mfma_f32_16x16x32_bf16 v[40:43], a[252:255], a[188:191], v[40:43]
    ds_read_b128 a[192:195], v226 offset:3904
    v_and_b32 v104, s15, v221
    s_waitcnt lgkmcnt(14)
    v_mfma_f32_16x16x32_bf16 v[36:39], a[252:255], a[196:199], v[36:39]
    v_lshlrev_b32 v105, 16, v221
    s_waitcnt lgkmcnt(13)
    v_mfma_f32_16x16x32_bf16 v[32:35], a[252:255], a[224:227], v[32:35]
    v_and_b32 v106, s15, v220
    s_waitcnt lgkmcnt(12)
    v_mfma_f32_16x16x32_bf16 v[28:31], a[252:255], a[200:203], v[28:31]
    v_lshlrev_b32 v107, 16, v220
    s_waitcnt lgkmcnt(11)
    v_mfma_f32_16x16x32_bf16 v[24:27], a[252:255], a[228:231], v[24:27]
    v_and_b32 v108, s15, v223
    s_waitcnt lgkmcnt(10)
    v_mfma_f32_16x16x32_bf16 v[20:23], a[252:255], a[204:207], v[20:23]
    s_mul_i32 s101, s71, 7
    s_add_u32 s101, s101, 114688
    buffer_load_dwordx4 a[100:103], v224, s[48:51], s101 offen
    v_lshlrev_b32 v109, 16, v223
    s_waitcnt lgkmcnt(9)
    v_mfma_f32_16x16x32_bf16 v[16:19], a[252:255], a[232:235], v[16:19]
    ds_read_b128 a[252:255], v226 offset:3392
    v_and_b32 v110, s15, v222
    s_waitcnt lgkmcnt(9)
    v_mfma_f32_16x16x32_bf16 v[44:47], a[208:211], a[188:191], v[44:47]
    ds_read_b128 a[188:191], v226 offset:2880
    v_lshlrev_b32 v111, 16, v222
    v_mfma_f32_16x16x32_bf16 v[40:43], a[208:211], a[196:199], v[40:43]
    s_add_u32 s81, s12, 9175040
    v_mfma_f32_16x16x32_bf16 v[36:39], a[208:211], a[224:227], v[36:39]
    s_lshl_b32 s82, s66, 7
    v_mfma_f32_16x16x32_bf16 v[32:35], a[208:211], a[200:203], v[32:35]
    s_add_u32 s82, s82, 11122688
    v_mfma_f32_16x16x32_bf16 v[28:31], a[208:211], a[228:231], v[28:31]
    s_lshl_b32 s83, s65, 11
    v_mfma_f32_16x16x32_bf16 v[24:27], a[208:211], a[204:207], v[24:27]
    s_mul_i32 s101, s71, 7
    s_add_u32 s101, s101, 143360
    buffer_load_dwordx4 a[104:107], v224, s[48:51], s101 offen
    s_add_u32 s83, s83, 11122688
    v_mfma_f32_16x16x32_bf16 v[20:23], a[208:211], a[232:235], v[20:23]
    ds_read_b128 a[208:211], v226 offset:2368
    s_waitcnt lgkmcnt(10)
    v_mfma_f32_16x16x32_bf16 v[44:47], a[236:239], a[196:199], v[44:47]
    ds_read_b128 a[196:199], v226 offset:1856
    v_mfma_f32_16x16x32_bf16 v[40:43], a[236:239], a[224:227], v[40:43]
    v_mfma_f32_16x16x32_bf16 v[36:39], a[236:239], a[200:203], v[36:39]
    v_mfma_f32_16x16x32_bf16 v[32:35], a[236:239], a[228:231], v[32:35]
    v_mfma_f32_16x16x32_bf16 v[28:31], a[236:239], a[204:207], v[28:31]
    v_mfma_f32_16x16x32_bf16 v[24:27], a[236:239], a[232:235], v[24:27]
    ds_read_b128 a[236:239], v226 offset:1344
    s_mul_i32 s101, s72, 7
    s_add_u32 s101, s101, 114688
    buffer_load_dwordx4 a[108:111], v224, s[48:51], s101 offen
    s_waitcnt lgkmcnt(11)
    v_mfma_f32_16x16x32_bf16 v[44:47], a[212:215], a[224:227], v[44:47]
    ds_read_b128 a[224:227], v226 offset:832
    v_mfma_f32_16x16x32_bf16 v[40:43], a[212:215], a[200:203], v[40:43]
    v_mfma_f32_16x16x32_bf16 v[36:39], a[212:215], a[228:231], v[36:39]
    v_mfma_f32_16x16x32_bf16 v[32:35], a[212:215], a[204:207], v[32:35]
    s_waitcnt vmcnt(13)
    v_mfma_f32_16x16x32_bf16 v[28:31], a[212:215], a[232:235], v[28:31]
    ds_read_b128 a[212:215], v226 offset:320
    ds_write_b128 v240, v[176:179] offset:0
    s_waitcnt lgkmcnt(13)
    v_mfma_f32_16x16x32_bf16 v[44:47], a[240:243], a[200:203], v[44:47]
    ds_read_b128 a[200:203], v225 offset:640
    v_mfma_f32_16x16x32_bf16 v[40:43], a[240:243], a[228:231], v[40:43]
    s_mul_i32 s101, s72, 7
    s_add_u32 s101, s101, 143360
    buffer_load_dwordx4 a[112:115], v224, s[48:51], s101 offen
    v_mfma_f32_16x16x32_bf16 v[36:39], a[240:243], a[204:207], v[36:39]
    v_mfma_f32_16x16x32_bf16 v[32:35], a[240:243], a[232:235], v[32:35]
    ds_read_b128 a[240:243], v225 offset:1152
    s_waitcnt lgkmcnt(14)
    v_mfma_f32_16x16x32_bf16 v[44:47], a[216:219], a[228:231], v[44:47]
    ds_read_b128 a[228:231], v225 offset:1664
    v_mfma_f32_16x16x32_bf16 v[40:43], a[216:219], a[204:207], v[40:43]
    ds_write_b128 v240, v[180:183] offset:1152
    v_mfma_f32_16x16x32_bf16 v[36:39], a[216:219], a[232:235], v[36:39]
    ds_read_b128 a[216:219], v225 offset:2176
    s_waitcnt lgkmcnt(15)
    v_mfma_f32_16x16x32_bf16 v[44:47], a[244:247], a[204:207], v[44:47]
    ds_read_b128 a[204:207], v225 offset:2688
    v_mfma_f32_16x16x32_bf16 v[40:43], a[244:247], a[232:235], v[40:43]
    ds_read_b128 a[244:247], v225 offset:3200
    s_mul_i32 s101, s73, 7
    s_add_u32 s101, s101, 114688
    buffer_load_dwordx4 a[116:119], v224, s[48:51], s101 offen
    v_mfma_f32_16x16x32_bf16 v[44:47], a[248:251], a[232:235], v[44:47]
    ds_read_b128 a[248:251], v225 offset:3712
    s_waitcnt lgkmcnt(15)
    v_mfma_f32_16x16x32_bf16 v[44:47], a[220:223], a[192:195], v[44:47]
    ds_read_b128 a[232:235], v225 offset:192
    v_mfma_f32_16x16x32_bf16 v[40:43], a[220:223], a[252:255], v[40:43]
    ds_read_b128 a[192:195], v226 offset:3840
    ds_write_b128 v240, v[184:187] offset:2304
    s_waitcnt lgkmcnt(15)
    v_mfma_f32_16x16x32_bf16 v[36:39], a[220:223], a[188:191], v[36:39]
    v_mfma_f32_16x16x32_bf16 v[32:35], a[220:223], a[208:211], v[32:35]
    v_mfma_f32_16x16x32_bf16 v[28:31], a[220:223], a[196:199], v[28:31]
    s_waitcnt lgkmcnt(14)
    v_mfma_f32_16x16x32_bf16 v[24:27], a[220:223], a[236:239], v[24:27]
    s_mul_i32 s101, s73, 7
    s_add_u32 s101, s101, 143360
    buffer_load_dwordx4 a[120:123], v224, s[48:51], s101 offen
    s_waitcnt lgkmcnt(13)
    v_mfma_f32_16x16x32_bf16 v[20:23], a[220:223], a[224:227], v[20:23]
    s_waitcnt lgkmcnt(12)
    v_mfma_f32_16x16x32_bf16 v[16:19], a[220:223], a[212:215], v[16:19]
    ds_read_b128 a[220:223], v226 offset:3328
    ds_write_b128 v240, v[188:191] offset:3456
    s_waitcnt lgkmcnt(12)
    v_mfma_f32_16x16x32_bf16 v[44:47], a[200:203], a[252:255], v[44:47]
    ds_read_b128 a[252:255], v226 offset:2816
    v_mfma_f32_16x16x32_bf16 v[40:43], a[200:203], a[188:191], v[40:43]
    v_mfma_f32_16x16x32_bf16 v[36:39], a[200:203], a[208:211], v[36:39]
    v_mfma_f32_16x16x32_bf16 v[32:35], a[200:203], a[196:199], v[32:35]
    v_mfma_f32_16x16x32_bf16 v[28:31], a[200:203], a[236:239], v[28:31]
    s_mul_i32 s101, s16, 7
    buffer_load_dwordx4 a[156:159], v224, s[48:51], s101 offen
    v_mfma_f32_16x16x32_bf16 v[24:27], a[200:203], a[224:227], v[24:27]
    ds_read_b64 v[192:193], v241 offset:0
    v_mfma_f32_16x16x32_bf16 v[20:23], a[200:203], a[212:215], v[20:23]
    ds_read_b128 a[200:203], v226 offset:2304
    ds_read_b64 v[194:195], v241 offset:16
    s_waitcnt lgkmcnt(15)
    v_mfma_f32_16x16x32_bf16 v[44:47], a[240:243], a[188:191], v[44:47]
    ds_read_b128 a[188:191], v226 offset:1792
    ds_read_b64 v[196:197], v241 offset:32
    v_mfma_f32_16x16x32_bf16 v[40:43], a[240:243], a[208:211], v[40:43]
    ds_read_b64 v[198:199], v241 offset:48
    v_mfma_f32_16x16x32_bf16 v[36:39], a[240:243], a[196:199], v[36:39]
    ds_read_b64 v[200:201], v241 offset:64
    v_mfma_f32_16x16x32_bf16 v[32:35], a[240:243], a[236:239], v[32:35]
    ds_read_b64 v[202:203], v241 offset:80
    v_mfma_f32_16x16x32_bf16 v[28:31], a[240:243], a[224:227], v[28:31]
    s_mul_i32 s101, s17, 7
    buffer_load_dwordx4 a[160:163], v224, s[48:51], s101 offen
    ds_read_b64 v[204:205], v241 offset:96
    v_mfma_f32_16x16x32_bf16 v[24:27], a[240:243], a[212:215], v[24:27]
    ds_read_b128 a[240:243], v226 offset:1280
    ds_read_b64 v[206:207], v241 offset:112
    s_waitcnt lgkmcnt(15)
    v_mfma_f32_16x16x32_bf16 v[44:47], a[228:231], a[208:211], v[44:47]
    ds_read_b128 a[208:211], v226 offset:768
    s_waitcnt lgkmcnt(1)
    v_mfma_f32_16x16x32_bf16 v[40:43], a[228:231], a[196:199], v[40:43]
    v_lshlrev_b32 v48, 16, v192
    v_mfma_f32_16x16x32_bf16 v[36:39], a[228:231], a[236:239], v[36:39]
    v_and_b32 v49, s15, v192
    v_mfma_f32_16x16x32_bf16 v[32:35], a[228:231], a[224:227], v[32:35]
    v_lshlrev_b32 v50, 16, v193
    v_mfma_f32_16x16x32_bf16 v[28:31], a[228:231], a[212:215], v[28:31]
    ds_read_b128 a[228:231], v226 offset:256
    v_and_b32 v51, s15, v193
    v_mfma_f32_16x16x32_bf16 v[44:47], a[216:219], a[196:199], v[44:47]
    ds_read_b128 a[196:199], v225 offset:704
    s_mul_i32 s101, s18, 7
    buffer_load_dwordx4 a[164:167], v224, s[48:51], s101 offen
    v_lshlrev_b32 v52, 16, v194
    v_mfma_f32_16x16x32_bf16 v[40:43], a[216:219], a[236:239], v[40:43]
    v_and_b32 v53, s15, v194
    v_mfma_f32_16x16x32_bf16 v[36:39], a[216:219], a[224:227], v[36:39]
    v_lshlrev_b32 v54, 16, v195
    v_mfma_f32_16x16x32_bf16 v[32:35], a[216:219], a[212:215], v[32:35]
    ds_read_b128 a[216:219], v225 offset:1216
    v_and_b32 v55, s15, v195
    v_mfma_f32_16x16x32_bf16 v[44:47], a[204:207], a[236:239], v[44:47]
    ds_read_b128 a[236:239], v225 offset:1728
    v_lshlrev_b32 v56, 16, v196
    v_mfma_f32_16x16x32_bf16 v[40:43], a[204:207], a[224:227], v[40:43]
    v_and_b32 v57, s15, v196
    v_mfma_f32_16x16x32_bf16 v[36:39], a[204:207], a[212:215], v[36:39]
    ds_read_b128 a[204:207], v225 offset:2240
    v_lshlrev_b32 v58, 16, v197
    v_mfma_f32_16x16x32_bf16 v[44:47], a[244:247], a[224:227], v[44:47]
    ds_read_b128 a[224:227], v225 offset:2752
    s_mul_i32 s101, s19, 7
    buffer_load_dwordx4 a[168:171], v224, s[48:51], s101 offen
    v_and_b32 v59, s15, v197
    v_mfma_f32_16x16x32_bf16 v[40:43], a[244:247], a[212:215], v[40:43]
    ds_read_b128 a[244:247], v225 offset:3264
    v_lshlrev_b32 v60, 16, v198
    v_mfma_f32_16x16x32_bf16 v[44:47], a[248:251], a[212:215], v[44:47]
    ds_read_b128 a[248:251], v225 offset:3776
    v_and_b32 v61, s15, v198
    v_mfma_f32_16x16x32_bf16 v[44:47], a[232:235], a[192:195], v[44:47]
    ds_read_b128 a[212:215], v225 offset:256
    s_mul_i32 s101, s74, 7
    s_add_u32 s101, s101, 0
    s_add_u32 m0, s68, 140800
    s_nop 0
    buffer_load_dwordx4 v224, s[48:51], s101 offen lds
    v_lshlrev_b32 v62, 16, v199
    v_mfma_f32_16x16x32_bf16 v[40:43], a[232:235], a[220:223], v[40:43]
    ds_read_b128 a[192:195], v226 offset:3776
    v_and_b32 v63, s15, v199
    v_mfma_f32_16x16x32_bf16 v[36:39], a[232:235], a[252:255], v[36:39]
    v_lshlrev_b32 v64, 16, v200
    v_mfma_f32_16x16x32_bf16 v[32:35], a[232:235], a[200:203], v[32:35]
    v_and_b32 v65, s15, v200
    v_mfma_f32_16x16x32_bf16 v[28:31], a[232:235], a[188:191], v[28:31]
    s_mul_i32 s101, s74, 7
    s_add_u32 s101, s101, 28672
    buffer_load_dwordx4 a[0:3], v224, s[48:51], s101 offen
    v_lshlrev_b32 v66, 16, v201
    v_mfma_f32_16x16x32_bf16 v[24:27], a[232:235], a[240:243], v[24:27]
    v_and_b32 v67, s15, v201
    s_waitcnt lgkmcnt(10)
    v_mfma_f32_16x16x32_bf16 v[20:23], a[232:235], a[208:211], v[20:23]
    v_lshlrev_b32 v68, 16, v202
    s_waitcnt lgkmcnt(9)
    v_mfma_f32_16x16x32_bf16 v[16:19], a[232:235], a[228:231], v[16:19]
    ds_read_b128 a[232:235], v226 offset:3264
    v_and_b32 v69, s15, v202
    s_waitcnt lgkmcnt(9)
    v_mfma_f32_16x16x32_bf16 v[44:47], a[196:199], a[220:223], v[44:47]
    ds_read_b128 a[220:223], v226 offset:2752
    s_mul_i32 s101, s75, 7
    s_add_u32 s101, s101, 0
    buffer_load_dwordx4 a[4:7], v224, s[48:51], s101 offen
    v_lshlrev_b32 v70, 16, v203
    v_mfma_f32_16x16x32_bf16 v[40:43], a[196:199], a[252:255], v[40:43]
    v_and_b32 v71, s15, v203
    v_mfma_f32_16x16x32_bf16 v[36:39], a[196:199], a[200:203], v[36:39]
    v_lshlrev_b32 v72, 16, v204
    v_mfma_f32_16x16x32_bf16 v[32:35], a[196:199], a[188:191], v[32:35]
    v_and_b32 v73, s15, v204
    v_mfma_f32_16x16x32_bf16 v[28:31], a[196:199], a[240:243], v[28:31]
    s_mul_i32 s101, s75, 7
    s_add_u32 s101, s101, 28672
    buffer_load_dwordx4 a[8:11], v224, s[48:51], s101 offen
    v_lshlrev_b32 v74, 16, v205
    v_mfma_f32_16x16x32_bf16 v[24:27], a[196:199], a[208:211], v[24:27]
    v_and_b32 v75, s15, v205
    v_mfma_f32_16x16x32_bf16 v[20:23], a[196:199], a[228:231], v[20:23]
    ds_read_b128 a[196:199], v226 offset:2240
    v_lshlrev_b32 v76, 16, v206
    s_waitcnt lgkmcnt(10)
    v_mfma_f32_16x16x32_bf16 v[44:47], a[216:219], a[252:255], v[44:47]
    ds_read_b128 a[252:255], v226 offset:1728
    v_and_b32 v77, s15, v206
    v_mfma_f32_16x16x32_bf16 v[40:43], a[216:219], a[200:203], v[40:43]
    s_mul_i32 s101, s76, 7
    s_add_u32 s101, s101, 0
    buffer_load_dwordx4 a[12:15], v224, s[48:51], s101 offen
    v_lshlrev_b32 v78, 16, v207
    v_mfma_f32_16x16x32_bf16 v[36:39], a[216:219], a[188:191], v[36:39]
    v_and_b32 v79, s15, v207
    v_mfma_f32_16x16x32_bf16 v[32:35], a[216:219], a[240:243], v[32:35]
    v_mfma_f32_16x16x32_bf16 v[28:31], a[216:219], a[208:211], v[28:31]
    v_mfma_f32_16x16x32_bf16 v[24:27], a[216:219], a[228:231], v[24:27]
    ds_read_b128 a[216:219], v226 offset:1216
    s_mul_i32 s101, s76, 7
    s_add_u32 s101, s101, 28672
    buffer_load_dwordx4 a[16:19], v224, s[48:51], s101 offen
    s_waitcnt lgkmcnt(11)
    v_mfma_f32_16x16x32_bf16 v[44:47], a[236:239], a[200:203], v[44:47]
    ds_read_b128 a[200:203], v226 offset:704
    v_mfma_f32_16x16x32_bf16 v[40:43], a[236:239], a[188:191], v[40:43]
    v_mfma_f32_16x16x32_bf16 v[36:39], a[236:239], a[240:243], v[36:39]
    v_mfma_f32_16x16x32_bf16 v[32:35], a[236:239], a[208:211], v[32:35]
    s_mul_i32 s101, s77, 7
    s_add_u32 s101, s101, 0
    buffer_load_dwordx4 a[20:23], v224, s[48:51], s101 offen
    v_mfma_f32_16x16x32_bf16 v[28:31], a[236:239], a[228:231], v[28:31]
    ds_read_b128 a[236:239], v226 offset:192
    s_waitcnt lgkmcnt(12)
    v_mfma_f32_16x16x32_bf16 v[44:47], a[204:207], a[188:191], v[44:47]
    ds_read_b128 a[188:191], v225 offset:768
    v_mfma_f32_16x16x32_bf16 v[40:43], a[204:207], a[240:243], v[40:43]
    v_mfma_f32_16x16x32_bf16 v[36:39], a[204:207], a[208:211], v[36:39]
    s_mul_i32 s101, s77, 7
    s_add_u32 s101, s101, 28672
    buffer_load_dwordx4 a[24:27], v224, s[48:51], s101 offen
    v_mfma_f32_16x16x32_bf16 v[32:35], a[204:207], a[228:231], v[32:35]
    ds_read_b128 a[204:207], v225 offset:1280
    s_waitcnt lgkmcnt(13)
    v_mfma_f32_16x16x32_bf16 v[44:47], a[224:227], a[240:243], v[44:47]
    ds_read_b128 a[240:243], v225 offset:1792
    v_mfma_f32_16x16x32_bf16 v[40:43], a[224:227], a[208:211], v[40:43]
    v_mfma_f32_16x16x32_bf16 v[36:39], a[224:227], a[228:231], v[36:39]
    ds_read_b128 a[224:227], v225 offset:2304
    s_mul_i32 s101, s74, 7
    s_add_u32 s101, s101, 57344
    buffer_load_dwordx4 a[60:63], v224, s[48:51], s101 offen
    s_waitcnt lgkmcnt(14)
    v_mfma_f32_16x16x32_bf16 v[44:47], a[244:247], a[208:211], v[44:47]
    ds_read_b128 a[208:211], v225 offset:2816
    v_mfma_f32_16x16x32_bf16 v[40:43], a[244:247], a[228:231], v[40:43]
    ds_read_b128 a[244:247], v225 offset:3328
    s_waitcnt lgkmcnt(15)
    v_mfma_f32_16x16x32_bf16 v[44:47], a[248:251], a[228:231], v[44:47]
    ds_read_b128 a[248:251], v225 offset:3840
    s_waitcnt lgkmcnt(14)
    v_mfma_f32_16x16x32_bf16 v[44:47], a[212:215], a[192:195], v[44:47]
    ds_read_b128 a[228:231], v225 offset:320
    s_mul_i32 s101, s74, 7
    s_add_u32 s101, s101, 86016
    buffer_load_dwordx4 a[64:67], v224, s[48:51], s101 offen
    s_waitcnt lgkmcnt(14)
    v_mfma_f32_16x16x32_bf16 v[40:43], a[212:215], a[232:235], v[40:43]
    ds_read_b128 a[192:195], v226 offset:3712
    s_waitcnt lgkmcnt(14)
    v_mfma_f32_16x16x32_bf16 v[36:39], a[212:215], a[220:223], v[36:39]
    s_waitcnt lgkmcnt(13)
    v_mfma_f32_16x16x32_bf16 v[32:35], a[212:215], a[196:199], v[32:35]
    s_waitcnt lgkmcnt(12)
    v_mfma_f32_16x16x32_bf16 v[28:31], a[212:215], a[252:255], v[28:31]
    s_mul_i32 s101, s75, 7
    s_add_u32 s101, s101, 57344
    buffer_load_dwordx4 a[68:71], v224, s[48:51], s101 offen
    s_waitcnt lgkmcnt(11)
    v_mfma_f32_16x16x32_bf16 v[24:27], a[212:215], a[216:219], v[24:27]
    s_waitcnt lgkmcnt(10)
    v_mfma_f32_16x16x32_bf16 v[20:23], a[212:215], a[200:203], v[20:23]
    s_waitcnt lgkmcnt(9)
    v_mfma_f32_16x16x32_bf16 v[16:19], a[212:215], a[236:239], v[16:19]
    ds_read_b128 a[212:215], v226 offset:3200
    s_waitcnt lgkmcnt(9)
    v_mfma_f32_16x16x32_bf16 v[44:47], a[188:191], a[232:235], v[44:47]
    ds_read_b128 a[232:235], v226 offset:2688
    s_mul_i32 s101, s75, 7
    s_add_u32 s101, s101, 86016
    buffer_load_dwordx4 a[72:75], v224, s[48:51], s101 offen
    v_mfma_f32_16x16x32_bf16 v[40:43], a[188:191], a[220:223], v[40:43]
    v_mfma_f32_16x16x32_bf16 v[36:39], a[188:191], a[196:199], v[36:39]
    v_mfma_f32_16x16x32_bf16 v[32:35], a[188:191], a[252:255], v[32:35]
    v_mfma_f32_16x16x32_bf16 v[28:31], a[188:191], a[216:219], v[28:31]
    s_mul_i32 s101, s76, 7
    s_add_u32 s101, s101, 57344
    buffer_load_dwordx4 a[76:79], v224, s[48:51], s101 offen
    v_mfma_f32_16x16x32_bf16 v[24:27], a[188:191], a[200:203], v[24:27]
    v_mfma_f32_16x16x32_bf16 v[20:23], a[188:191], a[236:239], v[20:23]
    ds_read_b128 a[188:191], v226 offset:2176
    s_waitcnt lgkmcnt(10)
    v_mfma_f32_16x16x32_bf16 v[44:47], a[204:207], a[220:223], v[44:47]
    ds_read_b128 a[220:223], v226 offset:1664
    v_mfma_f32_16x16x32_bf16 v[40:43], a[204:207], a[196:199], v[40:43]
    s_mul_i32 s101, s76, 7
    s_add_u32 s101, s101, 86016
    buffer_load_dwordx4 a[80:83], v224, s[48:51], s101 offen
    v_mfma_f32_16x16x32_bf16 v[36:39], a[204:207], a[252:255], v[36:39]
    v_mfma_f32_16x16x32_bf16 v[32:35], a[204:207], a[216:219], v[32:35]
    v_mfma_f32_16x16x32_bf16 v[28:31], a[204:207], a[200:203], v[28:31]
    v_mfma_f32_16x16x32_bf16 v[24:27], a[204:207], a[236:239], v[24:27]
    ds_read_b128 a[204:207], v226 offset:1152
    s_mul_i32 s101, s77, 7
    s_add_u32 s101, s101, 57344
    buffer_load_dwordx4 a[84:87], v224, s[48:51], s101 offen
    s_waitcnt lgkmcnt(11)
    v_mfma_f32_16x16x32_bf16 v[44:47], a[240:243], a[196:199], v[44:47]
    ds_read_b128 a[196:199], v226 offset:640
    v_mfma_f32_16x16x32_bf16 v[40:43], a[240:243], a[252:255], v[40:43]
    v_mfma_f32_16x16x32_bf16 v[36:39], a[240:243], a[216:219], v[36:39]
    v_mfma_f32_16x16x32_bf16 v[32:35], a[240:243], a[200:203], v[32:35]
    s_mul_i32 s101, s77, 7
    s_add_u32 s101, s101, 86016
    buffer_load_dwordx4 a[88:91], v224, s[48:51], s101 offen
    v_mfma_f32_16x16x32_bf16 v[28:31], a[240:243], a[236:239], v[28:31]
    ds_read_b128 a[240:243], v226 offset:128
    s_waitcnt lgkmcnt(12)
    v_mfma_f32_16x16x32_bf16 v[44:47], a[224:227], a[252:255], v[44:47]
    ds_read_b128 a[252:255], v225 offset:832
    v_mfma_f32_16x16x32_bf16 v[40:43], a[224:227], a[216:219], v[40:43]
    v_mfma_f32_16x16x32_bf16 v[36:39], a[224:227], a[200:203], v[36:39]
    s_mul_i32 s101, s74, 7
    s_add_u32 s101, s101, 114688
    buffer_load_dwordx4 a[124:127], v224, s[48:51], s101 offen
    v_mfma_f32_16x16x32_bf16 v[32:35], a[224:227], a[236:239], v[32:35]
    ds_read_b128 a[224:227], v225 offset:1344
    s_waitcnt lgkmcnt(13)
    v_mfma_f32_16x16x32_bf16 v[44:47], a[208:211], a[216:219], v[44:47]
    ds_read_b128 a[216:219], v225 offset:1856
    v_mfma_f32_16x16x32_bf16 v[40:43], a[208:211], a[200:203], v[40:43]
    v_mfma_f32_16x16x32_bf16 v[36:39], a[208:211], a[236:239], v[36:39]
    ds_read_b128 a[208:211], v225 offset:2368
    s_mul_i32 s101, s74, 7
    s_add_u32 s101, s101, 143360
    buffer_load_dwordx4 a[128:131], v224, s[48:51], s101 offen
    s_waitcnt lgkmcnt(14)
    v_mfma_f32_16x16x32_bf16 v[44:47], a[244:247], a[200:203], v[44:47]
    ds_read_b128 a[200:203], v225 offset:2880
    v_mfma_f32_16x16x32_bf16 v[40:43], a[244:247], a[236:239], v[40:43]
    ds_read_b128 a[244:247], v225 offset:3392
    s_waitcnt lgkmcnt(15)
    v_mfma_f32_16x16x32_bf16 v[44:47], a[248:251], a[236:239], v[44:47]
    ds_read_b128 a[248:251], v225 offset:3904
    s_waitcnt lgkmcnt(14)
    v_mfma_f32_16x16x32_bf16 v[44:47], a[228:231], a[192:195], v[44:47]
    ds_read_b128 a[236:239], v225 offset:384
    s_mul_i32 s101, s75, 7
    s_add_u32 s101, s101, 114688
    buffer_load_dwordx4 a[132:135], v224, s[48:51], s101 offen
    s_waitcnt lgkmcnt(14)
    v_mfma_f32_16x16x32_bf16 v[40:43], a[228:231], a[212:215], v[40:43]
    ds_read_b128 a[192:195], v226 offset:3648
    s_waitcnt lgkmcnt(14)
    v_mfma_f32_16x16x32_bf16 v[36:39], a[228:231], a[232:235], v[36:39]
    s_waitcnt lgkmcnt(13)
    v_mfma_f32_16x16x32_bf16 v[32:35], a[228:231], a[188:191], v[32:35]
    s_waitcnt lgkmcnt(12)
    v_mfma_f32_16x16x32_bf16 v[28:31], a[228:231], a[220:223], v[28:31]
    s_mul_i32 s101, s75, 7
    s_add_u32 s101, s101, 143360
    buffer_load_dwordx4 a[136:139], v224, s[48:51], s101 offen
    s_waitcnt lgkmcnt(11)
    v_mfma_f32_16x16x32_bf16 v[24:27], a[228:231], a[204:207], v[24:27]
    s_waitcnt lgkmcnt(10)
    v_mfma_f32_16x16x32_bf16 v[20:23], a[228:231], a[196:199], v[20:23]
    s_waitcnt lgkmcnt(9)
    v_mfma_f32_16x16x32_bf16 v[16:19], a[228:231], a[240:243], v[16:19]
    ds_read_b128 a[228:231], v226 offset:3136
    s_waitcnt lgkmcnt(9)
    v_mfma_f32_16x16x32_bf16 v[44:47], a[252:255], a[212:215], v[44:47]
    ds_read_b128 a[212:215], v226 offset:2624
    s_mul_i32 s101, s76, 7
    s_add_u32 s101, s101, 114688
    buffer_load_dwordx4 a[140:143], v224, s[48:51], s101 offen
    v_mfma_f32_16x16x32_bf16 v[40:43], a[252:255], a[232:235], v[40:43]
    v_mfma_f32_16x16x32_bf16 v[36:39], a[252:255], a[188:191], v[36:39]
    v_mfma_f32_16x16x32_bf16 v[32:35], a[252:255], a[220:223], v[32:35]
    v_mfma_f32_16x16x32_bf16 v[28:31], a[252:255], a[204:207], v[28:31]
    s_mul_i32 s101, s76, 7
    s_add_u32 s101, s101, 143360
    buffer_load_dwordx4 a[144:147], v224, s[48:51], s101 offen
    v_mfma_f32_16x16x32_bf16 v[24:27], a[252:255], a[196:199], v[24:27]
    v_mfma_f32_16x16x32_bf16 v[20:23], a[252:255], a[240:243], v[20:23]
    ds_read_b128 a[252:255], v226 offset:2112
    s_waitcnt lgkmcnt(10)
    v_mfma_f32_16x16x32_bf16 v[44:47], a[224:227], a[232:235], v[44:47]
    ds_read_b128 a[232:235], v226 offset:1600
    v_mfma_f32_16x16x32_bf16 v[40:43], a[224:227], a[188:191], v[40:43]
    s_mul_i32 s101, s77, 7
    s_add_u32 s101, s101, 114688
    buffer_load_dwordx4 a[148:151], v224, s[48:51], s101 offen
    v_mfma_f32_16x16x32_bf16 v[36:39], a[224:227], a[220:223], v[36:39]
    v_mfma_f32_16x16x32_bf16 v[32:35], a[224:227], a[204:207], v[32:35]
    v_mfma_f32_16x16x32_bf16 v[28:31], a[224:227], a[196:199], v[28:31]
    v_mfma_f32_16x16x32_bf16 v[24:27], a[224:227], a[240:243], v[24:27]
    ds_read_b128 a[224:227], v226 offset:1088
    s_mul_i32 s101, s77, 7
    s_add_u32 s101, s101, 143360
    buffer_load_dwordx4 a[152:155], v224, s[48:51], s101 offen
    buffer_load_dwordx2 v[14:15], v1, s[52:55], s69 offen offset:0 sc1
    s_waitcnt lgkmcnt(11)
    v_mfma_f32_16x16x32_bf16 v[44:47], a[216:219], a[188:191], v[44:47]
    ds_read_b128 a[188:191], v226 offset:576
    v_mfma_f32_16x16x32_bf16 v[40:43], a[216:219], a[220:223], v[40:43]
    v_mfma_f32_16x16x32_bf16 v[36:39], a[216:219], a[204:207], v[36:39]
    v_mfma_f32_16x16x32_bf16 v[32:35], a[216:219], a[196:199], v[32:35]
    s_mul_i32 s101, s20, 7
    buffer_load_dwordx4 a[172:175], v224, s[48:51], s101 offen
    v_mfma_f32_16x16x32_bf16 v[28:31], a[216:219], a[240:243], v[28:31]
    ds_read_b128 a[216:219], v226 offset:64
    s_waitcnt lgkmcnt(12)
    v_mfma_f32_16x16x32_bf16 v[44:47], a[208:211], a[220:223], v[44:47]
    ds_read_b128 a[220:223], v225 offset:896
    v_mfma_f32_16x16x32_bf16 v[40:43], a[208:211], a[204:207], v[40:43]
    v_mfma_f32_16x16x32_bf16 v[36:39], a[208:211], a[196:199], v[36:39]
    s_mul_i32 s101, s21, 7
    buffer_load_dwordx4 a[176:179], v224, s[48:51], s101 offen
    v_mfma_f32_16x16x32_bf16 v[32:35], a[208:211], a[240:243], v[32:35]
    ds_read_b128 a[208:211], v225 offset:1408
    s_waitcnt lgkmcnt(13)
    v_mfma_f32_16x16x32_bf16 v[44:47], a[200:203], a[204:207], v[44:47]
    ds_read_b128 a[204:207], v225 offset:1920
    v_mfma_f32_16x16x32_bf16 v[40:43], a[200:203], a[196:199], v[40:43]
    v_mfma_f32_16x16x32_bf16 v[36:39], a[200:203], a[240:243], v[36:39]
    ds_read_b128 a[200:203], v225 offset:2432
    s_mul_i32 s101, s22, 7
    buffer_load_dwordx4 a[180:183], v224, s[48:51], s101 offen
    s_waitcnt lgkmcnt(14)
    v_mfma_f32_16x16x32_bf16 v[44:47], a[244:247], a[196:199], v[44:47]
    ds_read_b128 a[196:199], v225 offset:2944
    v_mfma_f32_16x16x32_bf16 v[40:43], a[244:247], a[240:243], v[40:43]
    ds_read_b128 a[244:247], v225 offset:3456
    s_waitcnt lgkmcnt(15)
    v_mfma_f32_16x16x32_bf16 v[44:47], a[248:251], a[240:243], v[44:47]
    ds_read_b128 a[248:251], v225 offset:3968
    s_waitcnt lgkmcnt(14)
    v_mfma_f32_16x16x32_bf16 v[44:47], a[236:239], a[192:195], v[44:47]
    ds_read_b128 a[240:243], v225 offset:448
    s_mul_i32 s101, s23, 7
    buffer_load_dwordx4 a[184:187], v224, s[48:51], s101 offen
    s_waitcnt lgkmcnt(14)
    v_mfma_f32_16x16x32_bf16 v[40:43], a[236:239], a[228:231], v[40:43]
    ds_read_b128 a[192:195], v226 offset:3584
    s_waitcnt lgkmcnt(14)
    v_mfma_f32_16x16x32_bf16 v[36:39], a[236:239], a[212:215], v[36:39]
    s_waitcnt lgkmcnt(13)
    v_mfma_f32_16x16x32_bf16 v[32:35], a[236:239], a[252:255], v[32:35]
    s_waitcnt lgkmcnt(12)
    v_mfma_f32_16x16x32_bf16 v[28:31], a[236:239], a[232:235], v[28:31]
    s_waitcnt lgkmcnt(11)
    v_mfma_f32_16x16x32_bf16 v[24:27], a[236:239], a[224:227], v[24:27]
    s_waitcnt lgkmcnt(10)
    v_mfma_f32_16x16x32_bf16 v[20:23], a[236:239], a[188:191], v[20:23]
    s_waitcnt lgkmcnt(9)
    v_mfma_f32_16x16x32_bf16 v[16:19], a[236:239], a[216:219], v[16:19]
    ds_read_b128 a[236:239], v226 offset:3072
    s_waitcnt lgkmcnt(9)
    v_mfma_f32_16x16x32_bf16 v[44:47], a[220:223], a[228:231], v[44:47]
    ds_read_b128 a[228:231], v226 offset:2560
    v_mfma_f32_16x16x32_bf16 v[40:43], a[220:223], a[212:215], v[40:43]
    v_mfma_f32_16x16x32_bf16 v[36:39], a[220:223], a[252:255], v[36:39]
    v_mfma_f32_16x16x32_bf16 v[32:35], a[220:223], a[232:235], v[32:35]
    v_mfma_f32_16x16x32_bf16 v[28:31], a[220:223], a[224:227], v[28:31]
    v_mfma_f32_16x16x32_bf16 v[24:27], a[220:223], a[188:191], v[24:27]
    v_mfma_f32_16x16x32_bf16 v[20:23], a[220:223], a[216:219], v[20:23]
    ds_read_b128 a[220:223], v226 offset:2048
    s_waitcnt lgkmcnt(10)
    v_mfma_f32_16x16x32_bf16 v[44:47], a[208:211], a[212:215], v[44:47]
    ds_read_b128 a[212:215], v226 offset:1536
    v_mfma_f32_16x16x32_bf16 v[40:43], a[208:211], a[252:255], v[40:43]
    v_mfma_f32_16x16x32_bf16 v[36:39], a[208:211], a[232:235], v[36:39]
    v_mfma_f32_16x16x32_bf16 v[32:35], a[208:211], a[224:227], v[32:35]
    v_mfma_f32_16x16x32_bf16 v[28:31], a[208:211], a[188:191], v[28:31]
    v_mfma_f32_16x16x32_bf16 v[24:27], a[208:211], a[216:219], v[24:27]
    ds_read_b128 a[208:211], v226 offset:1024
    s_waitcnt lgkmcnt(11)
    v_mfma_f32_16x16x32_bf16 v[44:47], a[204:207], a[252:255], v[44:47]
    ds_read_b128 a[252:255], v226 offset:512
    v_mfma_f32_16x16x32_bf16 v[40:43], a[204:207], a[232:235], v[40:43]
    v_mfma_f32_16x16x32_bf16 v[36:39], a[204:207], a[224:227], v[36:39]
    v_mfma_f32_16x16x32_bf16 v[32:35], a[204:207], a[188:191], v[32:35]
    v_mfma_f32_16x16x32_bf16 v[28:31], a[204:207], a[216:219], v[28:31]
    ds_read_b128 a[204:207], v226 offset:0
    s_waitcnt lgkmcnt(12)
    v_mfma_f32_16x16x32_bf16 v[44:47], a[200:203], a[232:235], v[44:47]
    ds_read_b128 a[232:235], v225 offset:960
    v_mfma_f32_16x16x32_bf16 v[40:43], a[200:203], a[224:227], v[40:43]
    v_mfma_f32_16x16x32_bf16 v[36:39], a[200:203], a[188:191], v[36:39]
    s_waitcnt vmcnt(4)
    v_cmp_ne_u64 vcc, s[42:43], v[14:15]
    s_nop 0
    s_cmp_eq_u64 vcc, 0
    s_cbranch_scc1 L_p30_ok
L_p30_retry:
    s_add_u32 s100, s100, 1
    s_cmp_gt_u32 s100, 200000
    s_cbranch_scc1 L_p30_ok
    s_sleep 2
    buffer_load_dwordx2 v[14:15], v1, s[52:55], s69 offen offset:0 sc1
    s_waitcnt vmcnt(0)
    v_cmp_ne_u64 vcc, s[42:43], v[14:15]
    s_nop 0
    s_cmp_eq_u64 vcc, 0
    s_cbranch_scc0 L_p30_retry
L_p30_ok:
    v_mfma_f32_16x16x32_bf16 v[32:35], a[200:203], a[216:219], v[32:35]
    ds_read_b128 a[200:203], v225 offset:1472
    s_waitcnt lgkmcnt(13)
    v_mfma_f32_16x16x32_bf16 v[44:47], a[196:199], a[224:227], v[44:47]
    ds_read_b128 a[224:227], v225 offset:1984
    v_mfma_f32_16x16x32_bf16 v[40:43], a[196:199], a[188:191], v[40:43]
    v_mfma_f32_16x16x32_bf16 v[36:39], a[196:199], a[216:219], v[36:39]
    ds_read_b128 a[196:199], v225 offset:2496
    s_waitcnt lgkmcnt(14)
    v_mfma_f32_16x16x32_bf16 v[44:47], a[244:247], a[188:191], v[44:47]
    ds_read_b128 a[188:191], v225 offset:3008
    s_add_u32 s101, s70, 0
    buffer_load_dwordx4 v[176:179], v234, s[56:59], s101 offen offset:0 sc1
    buffer_load_dwordx4 v[180:183], v234, s[56:59], s101 offen offset:512 sc1
    v_mfma_f32_16x16x32_bf16 v[40:43], a[244:247], a[216:219], v[40:43]
    ds_read_b128 a[244:247], v225 offset:3520
    s_waitcnt lgkmcnt(15)
    v_mfma_f32_16x16x32_bf16 v[44:47], a[248:251], a[216:219], v[44:47]
    ds_read_b128 a[248:251], v225 offset:4032
    s_waitcnt lgkmcnt(14)
    v_mfma_f32_16x16x32_bf16 v[44:47], a[240:243], a[192:195], v[44:47]
    s_waitcnt lgkmcnt(13)
    v_mfma_f32_16x16x32_bf16 v[40:43], a[240:243], a[236:239], v[40:43]
    s_waitcnt lgkmcnt(12)
    v_mfma_f32_16x16x32_bf16 v[36:39], a[240:243], a[228:231], v[36:39]
    s_add_u32 s101, s70, 4096
    buffer_load_dwordx4 v[184:187], v234, s[56:59], s101 offen offset:0 sc1
    buffer_load_dwordx4 v[188:191], v234, s[56:59], s101 offen offset:512 sc1
    s_waitcnt lgkmcnt(11)
    v_mfma_f32_16x16x32_bf16 v[32:35], a[240:243], a[220:223], v[32:35]
    s_waitcnt lgkmcnt(10)
    v_mfma_f32_16x16x32_bf16 v[28:31], a[240:243], a[212:215], v[28:31]
    s_waitcnt lgkmcnt(9)
    v_mfma_f32_16x16x32_bf16 v[24:27], a[240:243], a[208:211], v[24:27]
    s_waitcnt lgkmcnt(8)
    v_mfma_f32_16x16x32_bf16 v[20:23], a[240:243], a[252:255], v[20:23]
    s_waitcnt lgkmcnt(7)
    v_mfma_f32_16x16x32_bf16 v[16:19], a[240:243], a[204:207], v[16:19]
    s_add_u32 s101, s71, 0
    buffer_load_dwordx4 v[192:195], v234, s[56:59], s101 offen offset:0 sc1
    buffer_load_dwordx4 v[196:199], v234, s[56:59], s101 offen offset:512 sc1
    s_waitcnt lgkmcnt(6)
    v_mfma_f32_16x16x32_bf16 v[44:47], a[232:235], a[236:239], v[44:47]
    v_mfma_f32_16x16x32_bf16 v[40:43], a[232:235], a[228:231], v[40:43]
    v_mfma_f32_16x16x32_bf16 v[36:39], a[232:235], a[220:223], v[36:39]
    s_nop 0
    v_fmac_f32 v16, s13, v80
    v_fmac_f32 v17, s13, v81
    v_mfma_f32_16x16x32_bf16 v[32:35], a[232:235], a[212:215], v[32:35]
    v_fmac_f32 v18, s13, v82
    v_fmac_f32 v19, s13, v83
    v_mfma_f32_16x16x32_bf16 v[28:31], a[232:235], a[208:211], v[28:31]
    s_add_u32 s5, s80, 8192
    buffer_load_dword v250, v227, s[52:55], s80 offen sc1
    buffer_load_dword v252, v227, s[52:55], s5 offen sc1
    v_cvt_pk_bf16_f32 v208, v16, v17
    v_cvt_pk_bf16_f32 v209, v18, v19
    v_mfma_f32_16x16x32_bf16 v[24:27], a[232:235], a[252:255], v[24:27]
    v_mfma_f32_16x16x32_bf16 v[20:23], a[232:235], a[204:207], v[20:23]
    s_waitcnt lgkmcnt(5)
    v_mfma_f32_16x16x32_bf16 v[44:47], a[200:203], a[228:231], v[44:47]
    v_mfma_f32_16x16x32_bf16 v[40:43], a[200:203], a[220:223], v[40:43]
    v_mfma_f32_16x16x32_bf16 v[36:39], a[200:203], a[212:215], v[36:39]
    s_add_u32 s101, s71, 4096
    buffer_load_dwordx4 v[200:203], v234, s[56:59], s101 offen offset:0 sc1
    buffer_load_dwordx4 v[204:207], v234, s[56:59], s101 offen offset:512 sc1
    s_nop 0
    v_fmac_f32 v20, s13, v84
    v_fmac_f32 v21, s13, v85
    v_mfma_f32_16x16x32_bf16 v[32:35], a[200:203], a[208:211], v[32:35]
    v_fmac_f32 v22, s13, v86
    v_fmac_f32 v23, s13, v87
    v_mfma_f32_16x16x32_bf16 v[28:31], a[200:203], a[252:255], v[28:31]
    v_cvt_pk_bf16_f32 v210, v20, v21
    v_cvt_pk_bf16_f32 v211, v22, v23
    v_mfma_f32_16x16x32_bf16 v[24:27], a[200:203], a[204:207], v[24:27]
    buffer_store_dwordx4 v[208:211], v3, s[52:55], s81 offen offset:0 sc1
    s_waitcnt lgkmcnt(4)
    v_mfma_f32_16x16x32_bf16 v[44:47], a[224:227], a[220:223], v[44:47]
    v_mfma_f32_16x16x32_bf16 v[40:43], a[224:227], a[212:215], v[40:43]
    s_add_u32 s101, s72, 0
    buffer_load_dwordx4 v[112:115], v234, s[56:59], s101 offen offset:0 sc1
    buffer_load_dwordx4 v[116:119], v234, s[56:59], s101 offen offset:512 sc1
    v_mfma_f32_16x16x32_bf16 v[36:39], a[224:227], a[208:211], v[36:39]
    v_fmac_f32 v24, s13, v88
    v_fmac_f32 v25, s13, v89
    v_mfma_f32_16x16x32_bf16 v[32:35], a[224:227], a[252:255], v[32:35]
    v_fmac_f32 v26, s13, v90
    v_fmac_f32 v27, s13, v91
    v_mfma_f32_16x16x32_bf16 v[28:31], a[224:227], a[204:207], v[28:31]
    v_cvt_pk_bf16_f32 v212, v24, v25
    v_cvt_pk_bf16_f32 v213, v26, v27
    s_waitcnt lgkmcnt(3)
    v_mfma_f32_16x16x32_bf16 v[44:47], a[196:199], a[212:215], v[44:47]
    v_mfma_f32_16x16x32_bf16 v[40:43], a[196:199], a[208:211], v[40:43]
    s_add_u32 s101, s72, 4096
    buffer_load_dwordx4 v[120:123], v234, s[56:59], s101 offen offset:0 sc1
    buffer_load_dwordx4 v[124:127], v234, s[56:59], s101 offen offset:512 sc1
    v_mfma_f32_16x16x32_bf16 v[36:39], a[196:199], a[252:255], v[36:39]
    v_fmac_f32 v28, s13, v92
    v_fmac_f32 v29, s13, v93
    v_mfma_f32_16x16x32_bf16 v[32:35], a[196:199], a[204:207], v[32:35]
    v_fmac_f32 v30, s13, v94
    v_fmac_f32 v31, s13, v95
    s_waitcnt lgkmcnt(2)
    v_mfma_f32_16x16x32_bf16 v[44:47], a[188:191], a[208:211], v[44:47]
    v_cvt_pk_bf16_f32 v214, v28, v29
    v_cvt_pk_bf16_f32 v215, v30, v31
    v_mfma_f32_16x16x32_bf16 v[40:43], a[188:191], a[252:255], v[40:43]
    buffer_store_dwordx4 v[212:215], v3, s[52:55], s81 offen offset:1024 sc1
    v_mfma_f32_16x16x32_bf16 v[36:39], a[188:191], a[204:207], v[36:39]
    s_add_u32 s101, s73, 0
    buffer_load_dwordx4 v[128:131], v234, s[56:59], s101 offen offset:0 sc1
    buffer_load_dwordx4 v[132:135], v234, s[56:59], s101 offen offset:512 sc1
    v_fmac_f32 v32, s13, v96
    v_fmac_f32 v33, s13, v97
    s_waitcnt lgkmcnt(1)
    v_mfma_f32_16x16x32_bf16 v[44:47], a[244:247], a[252:255], v[44:47]
    v_fmac_f32 v34, s13, v98
    v_fmac_f32 v35, s13, v99
    v_mfma_f32_16x16x32_bf16 v[40:43], a[244:247], a[204:207], v[40:43]
    v_cvt_pk_bf16_f32 v216, v32, v33
    v_cvt_pk_bf16_f32 v217, v34, v35
    s_waitcnt lgkmcnt(0)
    v_mfma_f32_16x16x32_bf16 v[44:47], a[248:251], a[204:207], v[44:47]
    v_fmac_f32 v36, s13, v100
    v_fmac_f32 v37, s13, v101
    v_fmac_f32 v38, s13, v102
    v_fmac_f32 v39, s13, v103
    v_cvt_pk_bf16_f32 v218, v36, v37
    v_cvt_pk_bf16_f32 v219, v38, v39
    buffer_store_dwordx4 v[216:219], v3, s[52:55], s81 offen offset:2048 sc1
    v_fmac_f32 v40, s13, v104
    v_fmac_f32 v41, s13, v105
    v_fmac_f32 v42, s13, v106
    v_fmac_f32 v43, s13, v107
    v_cvt_pk_bf16_f32 v220, v40, v41
    v_cvt_pk_bf16_f32 v221, v42, v43
    v_fmac_f32 v44, s13, v108
    v_fmac_f32 v45, s13, v109
    v_fmac_f32 v46, s13, v110
    v_fmac_f32 v47, s13, v111
    v_cvt_pk_bf16_f32 v222, v44, v45
    v_cvt_pk_bf16_f32 v223, v46, v47
    buffer_store_dwordx4 v[220:223], v3, s[52:55], s81 offen offset:3072 sc1
    s_barrier
    ds_read_b64_tr_b16 v[80:81], v230 offset:42496
    ds_read_b64_tr_b16 v[82:83], v230 offset:44544
    ds_read_b64_tr_b16 v[84:85], v231 offset:42496
    ds_read_b64_tr_b16 v[86:87], v231 offset:44544
    ds_read_b64_tr_b16 v[88:89], v230 offset:43520
    ds_read_b64_tr_b16 v[90:91], v230 offset:45568
    ds_read_b64_tr_b16 v[92:93], v231 offset:43520
    ds_read_b64_tr_b16 v[94:95], v231 offset:45568
    s_waitcnt vmcnt(18) lgkmcnt(4)
    v_mfma_f32_32x32x16_bf16 v[16:31], v[80:83], v[176:179], 0
    ds_read_b64_tr_b16 v[96:97], v230 offset:46592
    ds_read_b64_tr_b16 v[98:99], v230 offset:48640
    ds_read_b64_tr_b16 v[100:101], v231 offset:46592
    ds_write_b128 v246, a[0:3] offset:0
    v_mfma_f32_32x32x16_bf16 v[32:47], v[84:87], v[176:179], 0
    ds_read_b64_tr_b16 v[102:103], v231 offset:48640
    ds_read_b64_tr_b16 v[104:105], v230 offset:47616
    ds_read_b64_tr_b16 v[106:107], v230 offset:49664
    s_waitcnt lgkmcnt(7)
    v_mfma_f32_32x32x16_bf16 v[16:31], v[88:91], v[180:183], v[16:31]
    ds_read_b64_tr_b16 v[108:109], v231 offset:47616
    ds_read_b64_tr_b16 v[110:111], v231 offset:49664
    ds_write_b128 v246, a[4:7] offset:4096
    v_mfma_f32_32x32x16_bf16 v[32:47], v[92:95], v[180:183], v[32:47]
    s_add_u32 s101, s73, 4096
    buffer_load_dwordx4 v[136:139], v234, s[56:59], s101 offen offset:0 sc1
    buffer_load_dwordx4 v[140:143], v234, s[56:59], s101 offen offset:512 sc1
    s_add_u32 s101, s74, 0
    buffer_load_dwordx4 v[144:147], v234, s[56:59], s101 offen offset:0 sc1
    buffer_load_dwordx4 v[148:151], v234, s[56:59], s101 offen offset:512 sc1
    s_waitcnt vmcnt(20) lgkmcnt(5)
    v_mfma_f32_32x32x16_bf16 v[16:31], v[96:99], v[184:187], v[16:31]
    ds_read_b64_tr_b16 v[80:81], v230 offset:50688
    ds_read_b64_tr_b16 v[82:83], v230 offset:52736
    ds_read_b64_tr_b16 v[84:85], v231 offset:50688
    ds_write_b128 v246, a[8:11] offset:8192
    v_mfma_f32_32x32x16_bf16 v[32:47], v[100:103], v[184:187], v[32:47]
    ds_read_b64_tr_b16 v[86:87], v231 offset:52736
    ds_read_b64_tr_b16 v[88:89], v230 offset:51712
    ds_read_b64_tr_b16 v[90:91], v230 offset:53760
    s_waitcnt lgkmcnt(8)
    v_mfma_f32_32x32x16_bf16 v[16:31], v[104:107], v[188:191], v[16:31]
    ds_read_b64_tr_b16 v[92:93], v231 offset:51712
    ds_read_b64_tr_b16 v[94:95], v231 offset:53760
    ds_write_b128 v246, a[12:15] offset:12288
    v_mfma_f32_32x32x16_bf16 v[32:47], v[108:111], v[188:191], v[32:47]
    s_add_u32 s101, s74, 4096
    buffer_load_dwordx4 v[152:155], v234, s[56:59], s101 offen offset:0 sc1
    buffer_load_dwordx4 v[156:159], v234, s[56:59], s101 offen offset:512 sc1
    s_waitcnt vmcnt(20) lgkmcnt(5)
    v_mfma_f32_32x32x16_bf16 v[16:31], v[80:83], v[192:195], v[16:31]
    ds_read_b64_tr_b16 v[96:97], v230 offset:54784
    ds_read_b64_tr_b16 v[98:99], v230 offset:56832
    ds_read_b64_tr_b16 v[100:101], v231 offset:54784
    ds_write_b128 v246, a[16:19] offset:16384
    v_mfma_f32_32x32x16_bf16 v[32:47], v[84:87], v[192:195], v[32:47]
    ds_read_b64_tr_b16 v[102:103], v231 offset:56832
    ds_read_b64_tr_b16 v[104:105], v230 offset:55808
    ds_read_b64_tr_b16 v[106:107], v230 offset:57856
    s_waitcnt lgkmcnt(8)
    v_mfma_f32_32x32x16_bf16 v[16:31], v[88:91], v[196:199], v[16:31]
    ds_read_b64_tr_b16 v[108:109], v231 offset:55808
    ds_read_b64_tr_b16 v[110:111], v231 offset:57856
    ds_write_b128 v246, a[20:23] offset:20480
    v_mfma_f32_32x32x16_bf16 v[32:47], v[92:95], v[196:199], v[32:47]
    s_add_u32 s101, s75, 0
    buffer_load_dwordx4 v[160:163], v234, s[56:59], s101 offen offset:0 sc1
    buffer_load_dwordx4 v[164:167], v234, s[56:59], s101 offen offset:512 sc1
    s_waitcnt vmcnt(18) lgkmcnt(5)
    v_mfma_f32_32x32x16_bf16 v[16:31], v[96:99], v[200:203], v[16:31]
    ds_read_b64_tr_b16 v[80:81], v230 offset:58880
    ds_read_b64_tr_b16 v[82:83], v230 offset:60928
    ds_read_b64_tr_b16 v[84:85], v231 offset:58880
    ds_write_b128 v246, a[24:27] offset:24576
    v_mfma_f32_32x32x16_bf16 v[32:47], v[100:103], v[200:203], v[32:47]
    ds_read_b64_tr_b16 v[86:87], v231 offset:60928
    ds_read_b64_tr_b16 v[88:89], v230 offset:59904
    ds_read_b64_tr_b16 v[90:91], v230 offset:61952
    s_waitcnt lgkmcnt(8)
    v_mfma_f32_32x32x16_bf16 v[16:31], v[104:107], v[204:207], v[16:31]
    ds_read_b64_tr_b16 v[92:93], v231 offset:59904
    ds_read_b64_tr_b16 v[94:95], v231 offset:61952
    ds_write_b128 v246, a[28:31] offset:28672
    v_mfma_f32_32x32x16_bf16 v[32:47], v[108:111], v[204:207], v[32:47]
    s_add_u32 s101, s75, 4096
    buffer_load_dwordx4 v[168:171], v234, s[56:59], s101 offen offset:0 sc1
    buffer_load_dwordx4 v[172:175], v234, s[56:59], s101 offen offset:512 sc1
    s_waitcnt vmcnt(17) lgkmcnt(5)
    v_mfma_f32_32x32x16_bf16 v[16:31], v[80:83], v[112:115], v[16:31]
    ds_read_b64_tr_b16 v[96:97], v230 offset:62976
    ds_read_b64_tr_b16 v[98:99], v230 offset:65024
    ds_read_b64_tr_b16 v[100:101], v231 offset:62976
    ds_write_b128 v246, a[32:35] offset:32768
    v_mfma_f32_32x32x16_bf16 v[32:47], v[84:87], v[112:115], v[32:47]
    ds_read_b64_tr_b16 v[102:103], v231 offset:65024
    ds_read_b64_tr_b16 v[104:105], v230 offset:64000
    ds_read_b64_tr_b16 v[106:107], v232 offset:512
    s_waitcnt lgkmcnt(8)
    v_mfma_f32_32x32x16_bf16 v[16:31], v[88:91], v[116:119], v[16:31]
    ds_read_b64_tr_b16 v[108:109], v231 offset:64000
    ds_read_b64_tr_b16 v[110:111], v233 offset:512
    ds_write_b128 v246, a[36:39] offset:36864
    v_mfma_f32_32x32x16_bf16 v[32:47], v[92:95], v[116:119], v[32:47]
    s_add_u32 s101, s76, 0
    buffer_load_dwordx4 a[188:191], v234, s[56:59], s101 offen offset:0 sc1
    buffer_load_dwordx4 a[192:195], v234, s[56:59], s101 offen offset:512 sc1
    s_waitcnt vmcnt(17) lgkmcnt(5)
    v_mfma_f32_32x32x16_bf16 v[16:31], v[96:99], v[120:123], v[16:31]
    ds_read_b64_tr_b16 v[80:81], v232 offset:1536
    ds_read_b64_tr_b16 v[82:83], v232 offset:3584
    ds_read_b64_tr_b16 v[84:85], v233 offset:1536
    s_add_u32 s69, s69, 1024
    buffer_load_dwordx2 v[14:15], v1, s[52:55], s69 offen offset:0 sc1
    ds_write_b128 v246, a[40:43] offset:40960
    v_mfma_f32_32x32x16_bf16 v[32:47], v[100:103], v[120:123], v[32:47]
    ds_read_b64_tr_b16 v[86:87], v233 offset:3584
    ds_read_b64_tr_b16 v[88:89], v232 offset:2560
    ds_read_b64_tr_b16 v[90:91], v232 offset:4608
    s_waitcnt lgkmcnt(8)
    v_mfma_f32_32x32x16_bf16 v[16:31], v[104:107], v[124:127], v[16:31]
    ds_read_b64_tr_b16 v[92:93], v233 offset:2560
    ds_read_b64_tr_b16 v[94:95], v233 offset:4608
    ds_write_b128 v246, a[44:47] offset:45056
    v_mfma_f32_32x32x16_bf16 v[32:47], v[108:111], v[124:127], v[32:47]
    s_add_u32 s101, s76, 4096
    buffer_load_dwordx4 a[196:199], v234, s[56:59], s101 offen offset:0 sc1
    buffer_load_dwordx4 a[200:203], v234, s[56:59], s101 offen offset:512 sc1
    s_waitcnt vmcnt(17) lgkmcnt(5)
    v_mfma_f32_32x32x16_bf16 v[16:31], v[80:83], v[128:131], v[16:31]
    ds_read_b64_tr_b16 v[96:97], v232 offset:5632
    ds_read_b64_tr_b16 v[98:99], v232 offset:7680
    ds_read_b64_tr_b16 v[100:101], v233 offset:5632
    ds_write_b128 v246, a[48:51] offset:49152
    v_mul_f32 v254, v250, v250
    v_mfma_f32_32x32x16_bf16 v[32:47], v[84:87], v[128:131], v[32:47]
    ds_read_b64_tr_b16 v[102:103], v233 offset:7680
    ds_read_b64_tr_b16 v[104:105], v232 offset:6656
    ds_read_b64_tr_b16 v[106:107], v232 offset:8704
    v_mul_f32 v252, 0x3b124925, v252
    v_cvt_pk_bf16_f32 v250, v250, v250
    s_waitcnt lgkmcnt(8)
    v_mfma_f32_32x32x16_bf16 v[16:31], v[88:91], v[132:135], v[16:31]
    ds_read_b64_tr_b16 v[108:109], v233 offset:6656
    ds_read_b64_tr_b16 v[110:111], v233 offset:8704
    ds_write_b128 v246, a[52:55] offset:53248
    v_sub_f32 v252, v252, v254
    v_lshlrev_b32 v250, 16, v250
    v_mfma_f32_32x32x16_bf16 v[32:47], v[92:95], v[132:135], v[32:47]
    s_add_u32 s101, s77, 0
    buffer_load_dwordx4 a[204:207], v234, s[56:59], s101 offen offset:0 sc1
    buffer_load_dwordx4 a[208:211], v234, s[56:59], s101 offen offset:512 sc1
    v_max_f32 v252, 0, v252
    v_cvt_pk_bf16_f32 v252, v252, v252
    s_waitcnt vmcnt(15) lgkmcnt(5)
    v_mfma_f32_32x32x16_bf16 v[16:31], v[96:99], v[136:139], v[16:31]
    ds_read_b64_tr_b16 v[80:81], v232 offset:9728
    ds_read_b64_tr_b16 v[82:83], v232 offset:11776
    ds_read_b64_tr_b16 v[84:85], v233 offset:9728
    ds_write_b128 v246, a[56:59] offset:57344
    v_lshlrev_b32 v252, 16, v252
    v_add_f32 v252, 0x3727c5ac, v252
    v_mfma_f32_32x32x16_bf16 v[32:47], v[100:103], v[136:139], v[32:47]
    ds_read_b64_tr_b16 v[86:87], v233 offset:11776
    ds_read_b64_tr_b16 v[88:89], v232 offset:10752
    ds_read_b64_tr_b16 v[90:91], v232 offset:12800
    v_cvt_pk_bf16_f32 v252, v252, v252
    v_lshlrev_b32 v252, 16, v252
    s_waitcnt lgkmcnt(8)
    v_mfma_f32_32x32x16_bf16 v[16:31], v[104:107], v[140:143], v[16:31]
    ds_read_b64_tr_b16 v[92:93], v233 offset:10752
    ds_read_b64_tr_b16 v[94:95], v233 offset:12800
    ds_write_b128 v246, a[60:63] offset:61440
    v_sqrt_f32 v252, v252
    s_nop 0
    v_cvt_pk_bf16_f32 v252, v252, v252
    v_mfma_f32_32x32x16_bf16 v[32:47], v[108:111], v[140:143], v[32:47]
    s_add_u32 s101, s77, 4096
    buffer_load_dwordx4 a[212:215], v234, s[56:59], s101 offen offset:0 sc1
    buffer_load_dwordx4 a[216:219], v234, s[56:59], s101 offen offset:512 sc1
    v_lshlrev_b32 v252, 16, v252
    v_rcp_f32 v252, v252
    s_waitcnt lgkmcnt(1)
    s_barrier
    buffer_store_dwordx2 v[6:7], v4, s[52:55], s82 offen offset:0 sc1
    s_waitcnt vmcnt(16)
    v_mfma_f32_32x32x16_bf16 v[16:31], v[80:83], v[144:147], v[16:31]
    ds_read_b64_tr_b16 v[96:97], v228 offset:0
    ds_read_b64_tr_b16 v[98:99], v228 offset:2048
    ds_read_b64_tr_b16 v[100:101], v229 offset:0
    ds_write_b128 v247, a[64:67] offset:0
    v_mul_f32 v254, v252, v252
    v_mul_f32 v250, v250, v252
    v_mfma_f32_32x32x16_bf16 v[32:47], v[84:87], v[144:147], v[32:47]
    ds_read_b64_tr_b16 v[102:103], v229 offset:2048
    ds_read_b64_tr_b16 v[104:105], v228 offset:1024
    ds_read_b64_tr_b16 v[106:107], v228 offset:3072
    v_mfma_f32_32x32x16_bf16 v[16:31], v[88:91], v[148:151], v[16:31]
    ds_read_b64_tr_b16 v[108:109], v229 offset:1024
    ds_read_b64_tr_b16 v[110:111], v229 offset:3072
    ds_write_b128 v247, a[68:71] offset:4096
    v_mfma_f32_32x32x16_bf16 v[32:47], v[92:95], v[148:151], v[32:47]
    s_waitcnt vmcnt(14) lgkmcnt(5)
    v_mfma_f32_32x32x16_bf16 v[16:31], v[96:99], v[152:155], v[16:31]
    ds_read_b64_tr_b16 v[80:81], v228 offset:4096
    ds_read_b64_tr_b16 v[82:83], v228 offset:6144
    ds_read_b64_tr_b16 v[84:85], v229 offset:4096
    ds_write_b128 v247, a[72:75] offset:8192
    v_mfma_f32_32x32x16_bf16 v[32:47], v[100:103], v[152:155], v[32:47]
    ds_read_b64_tr_b16 v[86:87], v229 offset:6144
    ds_read_b64_tr_b16 v[88:89], v228 offset:5120
    ds_read_b64_tr_b16 v[90:91], v228 offset:7168
    s_waitcnt lgkmcnt(8)
    v_mfma_f32_32x32x16_bf16 v[16:31], v[104:107], v[156:159], v[16:31]
    ds_read_b64_tr_b16 v[92:93], v229 offset:5120
    ds_read_b64_tr_b16 v[94:95], v229 offset:7168
    ds_write_b128 v247, a[76:79] offset:12288
    v_mfma_f32_32x32x16_bf16 v[32:47], v[108:111], v[156:159], v[32:47]
    s_waitcnt vmcnt(12) lgkmcnt(5)
    v_mfma_f32_32x32x16_bf16 v[16:31], v[80:83], v[160:163], v[16:31]
    ds_read_b64_tr_b16 v[96:97], v228 offset:8192
    ds_read_b64_tr_b16 v[98:99], v228 offset:10240
    ds_read_b64_tr_b16 v[100:101], v229 offset:8192
    ds_write_b128 v247, a[80:83] offset:16384
    v_mfma_f32_32x32x16_bf16 v[32:47], v[84:87], v[160:163], v[32:47]
    ds_read_b64_tr_b16 v[102:103], v229 offset:10240
    ds_read_b64_tr_b16 v[104:105], v228 offset:9216
    ds_read_b64_tr_b16 v[106:107], v228 offset:11264
    s_waitcnt lgkmcnt(8)
    v_mfma_f32_32x32x16_bf16 v[16:31], v[88:91], v[164:167], v[16:31]
    ds_read_b64_tr_b16 v[108:109], v229 offset:9216
    ds_read_b64_tr_b16 v[110:111], v229 offset:11264
    ds_write_b128 v247, a[84:87] offset:20480
    v_mfma_f32_32x32x16_bf16 v[32:47], v[92:95], v[164:167], v[32:47]
    s_waitcnt vmcnt(7)
    v_cmp_ne_u64 vcc, s[42:43], v[14:15]
    s_nop 0
    s_cmp_eq_u64 vcc, 0
    s_cbranch_scc1 L_p31_ok
L_p31_retry:
    s_add_u32 s100, s100, 1
    s_cmp_gt_u32 s100, 200000
    s_cbranch_scc1 L_p31_ok
    s_sleep 2
    buffer_load_dwordx2 v[14:15], v1, s[52:55], s69 offen offset:0 sc1
    s_waitcnt vmcnt(0)
    v_cmp_ne_u64 vcc, s[42:43], v[14:15]
    s_nop 0
    s_cmp_eq_u64 vcc, 0
    s_cbranch_scc0 L_p31_retry
L_p31_ok:
    s_add_u32 s101, s70, 8192
    buffer_load_dwordx4 a[220:223], v234, s[56:59], s101 offen offset:0 sc1
    buffer_load_dwordx4 a[224:227], v234, s[56:59], s101 offen offset:512 sc1
    s_add_u32 s101, s70, 12288
    buffer_load_dwordx4 a[228:231], v234, s[56:59], s101 offen offset:0 sc1
    buffer_load_dwordx4 a[232:235], v234, s[56:59], s101 offen offset:512 sc1
    s_add_u32 s101, s71, 8192
    buffer_load_dwordx4 a[236:239], v234, s[56:59], s101 offen offset:0 sc1
    buffer_load_dwordx4 a[240:243], v234, s[56:59], s101 offen offset:512 sc1
    s_waitcnt lgkmcnt(5)
    v_mfma_f32_32x32x16_bf16 v[16:31], v[96:99], v[168:171], v[16:31]
    ds_read_b64_tr_b16 v[80:81], v228 offset:12288
    ds_read_b64_tr_b16 v[82:83], v228 offset:14336
    ds_read_b64_tr_b16 v[84:85], v229 offset:12288
    ds_write_b128 v247, a[88:91] offset:24576
    v_mfma_f32_32x32x16_bf16 v[32:47], v[100:103], v[168:171], v[32:47]
    ds_read_b64_tr_b16 v[86:87], v229 offset:14336
    ds_read_b64_tr_b16 v[88:89], v228 offset:13312
    ds_read_b64_tr_b16 v[90:91], v228 offset:15360
    s_waitcnt lgkmcnt(8)
    v_mfma_f32_32x32x16_bf16 v[16:31], v[104:107], v[172:175], v[16:31]
    ds_read_b64_tr_b16 v[92:93], v229 offset:13312
    ds_read_b64_tr_b16 v[94:95], v229 offset:15360
    ds_write_b128 v247, a[92:95] offset:28672
    v_mfma_f32_32x32x16_bf16 v[32:47], v[108:111], v[172:175], v[32:47]
    s_add_u32 s101, s71, 12288
    buffer_load_dwordx4 a[244:247], v234, s[56:59], s101 offen offset:0 sc1
    buffer_load_dwordx4 a[248:251], v234, s[56:59], s101 offen offset:512 sc1
    s_waitcnt lgkmcnt(5)
    v_mfma_f32_32x32x16_bf16 v[16:31], v[80:83], a[188:191], v[16:31]
    ds_read_b64_tr_b16 v[96:97], v228 offset:16384
    ds_read_b64_tr_b16 v[98:99], v228 offset:18432
    ds_read_b64_tr_b16 v[100:101], v229 offset:16384
    ds_write_b128 v247, a[96:99] offset:32768
    v_mfma_f32_32x32x16_bf16 v[32:47], v[84:87], a[188:191], v[32:47]
    ds_read_b64_tr_b16 v[102:103], v229 offset:18432
    ds_read_b64_tr_b16 v[104:105], v228 offset:17408
    ds_read_b64_tr_b16 v[106:107], v228 offset:19456
    s_waitcnt lgkmcnt(8)
    v_mfma_f32_32x32x16_bf16 v[16:31], v[88:91], a[192:195], v[16:31]
    ds_read_b64_tr_b16 v[108:109], v229 offset:17408
    ds_read_b64_tr_b16 v[110:111], v229 offset:19456
    ds_write_b128 v247, a[100:103] offset:36864
    v_mfma_f32_32x32x16_bf16 v[32:47], v[92:95], a[192:195], v[32:47]
    s_add_u32 s101, s72, 8192
    buffer_load_dwordx4 a[252:255], v234, s[56:59], s101 offen offset:0 sc1
    buffer_load_dwordx4 a[0:3], v234, s[56:59], s101 offen offset:512 sc1
    s_waitcnt vmcnt(15) lgkmcnt(5)
    v_mfma_f32_32x32x16_bf16 v[16:31], v[96:99], a[196:199], v[16:31]
    ds_read_b64_tr_b16 v[80:81], v228 offset:20480
    ds_read_b64_tr_b16 v[82:83], v228 offset:22528
    ds_read_b64_tr_b16 v[84:85], v229 offset:20480
    ds_write_b128 v247, a[104:107] offset:42496
    v_mfma_f32_32x32x16_bf16 v[32:47], v[100:103], a[196:199], v[32:47]
    ds_read_b64_tr_b16 v[86:87], v229 offset:22528
    ds_read_b64_tr_b16 v[88:89], v228 offset:21504
    ds_read_b64_tr_b16 v[90:91], v228 offset:23552
    s_waitcnt lgkmcnt(8)
    v_mfma_f32_32x32x16_bf16 v[16:31], v[104:107], a[200:203], v[16:31]
    ds_read_b64_tr_b16 v[92:93], v229 offset:21504
    ds_read_b64_tr_b16 v[94:95], v229 offset:23552
    ds_write_b128 v247, a[108:111] offset:46592
    v_mfma_f32_32x32x16_bf16 v[32:47], v[108:111], a[200:203], v[32:47]
    s_add_u32 s101, s72, 12288
    buffer_load_dwordx4 a[4:7], v234, s[56:59], s101 offen offset:0 sc1
    buffer_load_dwordx4 a[8:11], v234, s[56:59], s101 offen offset:512 sc1
    s_waitcnt vmcnt(15) lgkmcnt(5)
    v_mfma_f32_32x32x16_bf16 v[16:31], v[80:83], a[204:207], v[16:31]
    ds_read_b64_tr_b16 v[96:97], v228 offset:24576
    ds_read_b64_tr_b16 v[98:99], v228 offset:26624
    ds_read_b64_tr_b16 v[100:101], v229 offset:24576
    ds_write_b128 v247, a[112:115] offset:50688
    v_mfma_f32_32x32x16_bf16 v[32:47], v[84:87], a[204:207], v[32:47]
    ds_read_b64_tr_b16 v[102:103], v229 offset:26624
    ds_read_b64_tr_b16 v[104:105], v228 offset:25600
    ds_read_b64_tr_b16 v[106:107], v228 offset:27648
    s_waitcnt lgkmcnt(8)
    v_mfma_f32_32x32x16_bf16 v[16:31], v[88:91], a[208:211], v[16:31]
    ds_read_b64_tr_b16 v[108:109], v229 offset:25600
    ds_read_b64_tr_b16 v[110:111], v229 offset:27648
    ds_write_b128 v247, a[116:119] offset:54784
    v_mfma_f32_32x32x16_bf16 v[32:47], v[92:95], a[208:211], v[32:47]
    s_add_u32 s101, s73, 8192
    buffer_load_dwordx4 a[12:15], v234, s[56:59], s101 offen offset:0 sc1
    buffer_load_dwordx4 a[16:19], v234, s[56:59], s101 offen offset:512 sc1
    s_waitcnt lgkmcnt(1)
    s_barrier
    s_waitcnt vmcnt(15)
    v_mfma_f32_32x32x16_bf16 v[16:31], v[96:99], a[212:215], v[16:31]
    ds_read_b64_tr_b16 v[80:81], v228 offset:28672
    ds_read_b64_tr_b16 v[82:83], v228 offset:30720
    ds_read_b64_tr_b16 v[84:85], v229 offset:28672
    ds_write_b128 v247, a[120:123] offset:58880
    v_mfma_f32_32x32x16_bf16 v[32:47], v[100:103], a[212:215], v[32:47]
    ds_read_b64_tr_b16 v[86:87], v229 offset:30720
    ds_read_b64_tr_b16 v[88:89], v228 offset:29696
    ds_read_b64_tr_b16 v[90:91], v228 offset:31744
    v_mfma_f32_32x32x16_bf16 v[16:31], v[104:107], a[216:219], v[16:31]
    ds_read_b64_tr_b16 v[92:93], v229 offset:29696
    ds_read_b64_tr_b16 v[94:95], v229 offset:31744
    ds_write_b128 v247, a[124:127] offset:62976
    v_mfma_f32_32x32x16_bf16 v[32:47], v[108:111], a[216:219], v[32:47]
    s_add_u32 s101, s73, 12288
    buffer_load_dwordx4 a[20:23], v234, s[56:59], s101 offen offset:0 sc1
    buffer_load_dwordx4 a[24:27], v234, s[56:59], s101 offen offset:512 sc1
    s_waitcnt vmcnt(14) lgkmcnt(5)
    v_mfma_f32_32x32x16_bf16 v[16:31], v[80:83], a[220:223], v[16:31]
    ds_read_b64_tr_b16 v[96:97], v228 offset:32768
    ds_read_b64_tr_b16 v[98:99], v228 offset:34816
    ds_read_b64_tr_b16 v[100:101], v229 offset:32768
    ds_write_b128 v248, a[128:131] offset:1536
    v_mfma_f32_32x32x16_bf16 v[32:47], v[84:87], a[220:223], v[32:47]
    ds_read_b64_tr_b16 v[102:103], v229 offset:34816
    ds_read_b64_tr_b16 v[104:105], v228 offset:33792
    ds_read_b64_tr_b16 v[106:107], v228 offset:35840
    s_waitcnt lgkmcnt(8)
    v_mfma_f32_32x32x16_bf16 v[16:31], v[88:91], a[224:227], v[16:31]
    ds_read_b64_tr_b16 v[108:109], v229 offset:33792
    ds_read_b64_tr_b16 v[110:111], v229 offset:35840
    ds_write_b128 v248, a[132:135] offset:5632
    v_mfma_f32_32x32x16_bf16 v[32:47], v[92:95], a[224:227], v[32:47]
    s_add_u32 s101, s74, 8192
    buffer_load_dwordx4 a[28:31], v234, s[56:59], s101 offen offset:0 sc1
    buffer_load_dwordx4 a[32:35], v234, s[56:59], s101 offen offset:512 sc1
    s_waitcnt vmcnt(14) lgkmcnt(5)
    v_mfma_f32_32x32x16_bf16 v[16:31], v[96:99], a[228:231], v[16:31]
    ds_read_b64_tr_b16 v[80:81], v228 offset:36864
    ds_read_b64_tr_b16 v[82:83], v228 offset:38912
    ds_read_b64_tr_b16 v[84:85], v229 offset:36864
    ds_write_b128 v248, a[136:139] offset:9728
    v_mfma_f32_32x32x16_bf16 v[32:47], v[100:103], a[228:231], v[32:47]
    ds_read_b64_tr_b16 v[86:87], v229 offset:38912
    ds_read_b64_tr_b16 v[88:89], v228 offset:37888
    ds_read_b64_tr_b16 v[90:91], v228 offset:39936
    s_waitcnt lgkmcnt(8)
    v_mfma_f32_32x32x16_bf16 v[16:31], v[104:107], a[232:235], v[16:31]
    ds_read_b64_tr_b16 v[92:93], v229 offset:37888
    ds_read_b64_tr_b16 v[94:95], v229 offset:39936
    ds_write_b128 v246, a[140:143] offset:0
    v_mfma_f32_32x32x16_bf16 v[32:47], v[108:111], a[232:235], v[32:47]
    s_add_u32 s101, s74, 12288
    buffer_load_dwordx4 a[36:39], v234, s[56:59], s101 offen offset:0 sc1
    buffer_load_dwordx4 v[112:115], v234, s[56:59], s101 offen offset:512 sc1
    s_waitcnt vmcnt(14) lgkmcnt(5)
    v_mfma_f32_32x32x16_bf16 v[16:31], v[80:83], a[236:239], v[16:31]
    ds_read_b64_tr_b16 v[96:97], v228 offset:40960
    ds_read_b64_tr_b16 v[98:99], v228 offset:43008
    ds_read_b64_tr_b16 v[100:101], v229 offset:40960
    ds_write_b128 v246, a[144:147] offset:4096
    v_mfma_f32_32x32x16_bf16 v[32:47], v[84:87], a[236:239], v[32:47]
    ds_read_b64_tr_b16 v[102:103], v229 offset:43008
    ds_read_b64_tr_b16 v[104:105], v228 offset:41984
    ds_read_b64_tr_b16 v[106:107], v228 offset:44032
    s_waitcnt lgkmcnt(8)
    v_mfma_f32_32x32x16_bf16 v[16:31], v[88:91], a[240:243], v[16:31]
    ds_read_b64_tr_b16 v[108:109], v229 offset:41984
    ds_read_b64_tr_b16 v[110:111], v229 offset:44032
    ds_write_b128 v246, a[148:151] offset:8192
    v_mfma_f32_32x32x16_bf16 v[32:47], v[92:95], a[240:243], v[32:47]
    s_add_u32 s101, s75, 8192
    buffer_load_dwordx4 v[116:119], v234, s[56:59], s101 offen offset:0 sc1
    buffer_load_dwordx4 a[40:43], v234, s[56:59], s101 offen offset:512 sc1
    s_waitcnt vmcnt(14) lgkmcnt(5)
    v_mfma_f32_32x32x16_bf16 v[16:31], v[96:99], a[244:247], v[16:31]
    ds_read_b64_tr_b16 v[80:81], v228 offset:45056
    ds_read_b64_tr_b16 v[82:83], v228 offset:47104
    ds_read_b64_tr_b16 v[84:85], v229 offset:45056
    ds_write_b128 v246, a[152:155] offset:12288
    v_mfma_f32_32x32x16_bf16 v[32:47], v[100:103], a[244:247], v[32:47]
    ds_read_b64_tr_b16 v[86:87], v229 offset:47104
    ds_read_b64_tr_b16 v[88:89], v228 offset:46080
    ds_read_b64_tr_b16 v[90:91], v228 offset:48128
    s_waitcnt lgkmcnt(8)
    v_mfma_f32_32x32x16_bf16 v[16:31], v[104:107], a[248:251], v[16:31]
    ds_read_b64_tr_b16 v[92:93], v229 offset:46080
    ds_read_b64_tr_b16 v[94:95], v229 offset:48128
    ds_write_b128 v246, a[156:159] offset:16384
    v_mfma_f32_32x32x16_bf16 v[32:47], v[108:111], a[248:251], v[32:47]
    s_add_u32 s101, s75, 12288
    buffer_load_dwordx4 a[44:47], v234, s[56:59], s101 offen offset:0 sc1
    buffer_load_dwordx4 v[120:123], v234, s[56:59], s101 offen offset:512 sc1
    s_waitcnt vmcnt(14) lgkmcnt(5)
    v_mfma_f32_32x32x16_bf16 v[16:31], v[80:83], a[252:255], v[16:31]
    ds_read_b64_tr_b16 v[96:97], v228 offset:49152
    ds_read_b64_tr_b16 v[98:99], v228 offset:51200
    ds_read_b64_tr_b16 v[100:101], v229 offset:49152
    ds_write_b128 v246, a[160:163] offset:20480
    v_mfma_f32_32x32x16_bf16 v[32:47], v[84:87], a[252:255], v[32:47]
    ds_read_b64_tr_b16 v[102:103], v229 offset:51200
    ds_read_b64_tr_b16 v[104:105], v228 offset:50176
    ds_read_b64_tr_b16 v[106:107], v228 offset:52224
    v_and_b32 v10, 15, v2
    v_lshlrev_b32 v10, 7, v10
    buffer_load_dwordx2 v[12:13], v10, s[52:55], s83 offen sc1
    s_waitcnt lgkmcnt(8)
    v_mfma_f32_32x32x16_bf16 v[16:31], v[88:91], a[0:3], v[16:31]
    ds_read_b64_tr_b16 v[108:109], v229 offset:50176
    ds_read_b64_tr_b16 v[110:111], v229 offset:52224
    ds_write_b128 v246, a[164:167] offset:24576
    v_mfma_f32_32x32x16_bf16 v[32:47], v[92:95], a[0:3], v[32:47]
    s_add_u32 s101, s76, 8192
    buffer_load_dwordx4 v[124:127], v234, s[56:59], s101 offen offset:0 sc1
    buffer_load_dwordx4 a[48:51], v234, s[56:59], s101 offen offset:512 sc1
    s_waitcnt vmcnt(15) lgkmcnt(5)
    v_mfma_f32_32x32x16_bf16 v[16:31], v[96:99], a[4:7], v[16:31]
    ds_read_b64_tr_b16 v[80:81], v228 offset:53248
    ds_read_b64_tr_b16 v[82:83], v228 offset:55296
    ds_read_b64_tr_b16 v[84:85], v229 offset:53248
    v_mfma_f32_32x32x16_bf16 v[32:47], v[100:103], a[4:7], v[32:47]
    ds_read_b64_tr_b16 v[86:87], v229 offset:55296
    ds_read_b64_tr_b16 v[88:89], v228 offset:54272
    ds_read_b64_tr_b16 v[90:91], v228 offset:56320
    s_waitcnt lgkmcnt(7)
    v_mfma_f32_32x32x16_bf16 v[16:31], v[104:107], a[8:11], v[16:31]
    ds_read_b64_tr_b16 v[92:93], v229 offset:54272
    ds_read_b64_tr_b16 v[94:95], v229 offset:56320
    v_mfma_f32_32x32x16_bf16 v[32:47], v[108:111], a[8:11], v[32:47]
    s_add_u32 s101, s76, 12288
    buffer_load_dwordx4 a[52:55], v234, s[56:59], s101 offen offset:0 sc1
    buffer_load_dwordx4 v[128:131], v234, s[56:59], s101 offen offset:512 sc1
    s_waitcnt vmcnt(15) lgkmcnt(4)
    v_mfma_f32_32x32x16_bf16 v[16:31], v[80:83], a[12:15], v[16:31]
    ds_read_b64_tr_b16 v[96:97], v228 offset:57344
    ds_read_b64_tr_b16 v[98:99], v228 offset:59392
    ds_read_b64_tr_b16 v[100:101], v229 offset:57344
    v_mfma_f32_32x32x16_bf16 v[32:47], v[84:87], a[12:15], v[32:47]
    ds_read_b64_tr_b16 v[102:103], v229 offset:59392
    ds_read_b64_tr_b16 v[104:105], v228 offset:58368
    ds_read_b64_tr_b16 v[106:107], v228 offset:60416
    s_waitcnt lgkmcnt(6)
    v_mfma_f32_32x32x16_bf16 v[16:31], v[88:91], a[16:19], v[16:31]
    ds_read_b64_tr_b16 v[108:109], v229 offset:58368
    ds_read_b64_tr_b16 v[110:111], v229 offset:60416
    v_mfma_f32_32x32x16_bf16 v[32:47], v[92:95], a[16:19], v[32:47]
    s_add_u32 s101, s77, 8192
    buffer_load_dwordx4 v[132:135], v234, s[56:59], s101 offen offset:0 sc1
    buffer_load_dwordx4 a[56:59], v234, s[56:59], s101 offen offset:512 sc1
    s_waitcnt lgkmcnt(0)
    s_barrier
    s_waitcnt vmcnt(15)
    v_mfma_f32_32x32x16_bf16 v[16:31], v[96:99], a[20:23], v[16:31]
    ds_read_b64_tr_b16 v[80:81], v228 offset:61440
    ds_read_b64_tr_b16 v[82:83], v228 offset:63488
    ds_read_b64_tr_b16 v[84:85], v229 offset:61440
    ds_write_b128 v246, a[168:171] offset:28672
    v_mfma_f32_32x32x16_bf16 v[32:47], v[100:103], a[20:23], v[32:47]
    ds_read_b64_tr_b16 v[86:87], v229 offset:63488
    ds_read_b64_tr_b16 v[88:89], v228 offset:62464
    ds_read_b64_tr_b16 v[90:91], v228 offset:64512
    v_mfma_f32_32x32x16_bf16 v[16:31], v[104:107], a[24:27], v[16:31]
    ds_read_b64_tr_b16 v[92:93], v229 offset:62464
    ds_read_b64_tr_b16 v[94:95], v229 offset:64512
    ds_write_b128 v246, a[172:175] offset:32768
    v_mfma_f32_32x32x16_bf16 v[32:47], v[108:111], a[24:27], v[32:47]
    s_add_u32 s101, s77, 12288
    buffer_load_dwordx4 a[60:63], v234, s[56:59], s101 offen offset:0 sc1
    buffer_load_dwordx4 v[136:139], v234, s[56:59], s101 offen offset:512 sc1
    s_waitcnt vmcnt(15) lgkmcnt(5)
    v_mfma_f32_32x32x16_bf16 v[16:31], v[80:83], a[28:31], v[16:31]
    ds_read_b64_tr_b16 v[96:97], v230 offset:0
    ds_read_b64_tr_b16 v[98:99], v230 offset:2048
    ds_read_b64_tr_b16 v[100:101], v231 offset:0
    ds_write_b128 v246, a[176:179] offset:36864
    v_mfma_f32_32x32x16_bf16 v[32:47], v[84:87], a[28:31], v[32:47]
    ds_read_b64_tr_b16 v[102:103], v231 offset:2048
    ds_read_b64_tr_b16 v[104:105], v230 offset:1024
    ds_read_b64_tr_b16 v[106:107], v230 offset:3072
    s_waitcnt lgkmcnt(8)
    v_mfma_f32_32x32x16_bf16 v[16:31], v[88:91], a[32:35], v[16:31]
    ds_read_b64_tr_b16 v[108:109], v231 offset:1024
    ds_read_b64_tr_b16 v[110:111], v231 offset:3072
    ds_write_b128 v246, a[180:183] offset:40960
    v_mfma_f32_32x32x16_bf16 v[32:47], v[92:95], a[32:35], v[32:47]
    s_waitcnt vmcnt(13) lgkmcnt(5)
    v_mfma_f32_32x32x16_bf16 v[16:31], v[96:99], a[36:39], v[16:31]
    ds_read_b64_tr_b16 v[80:81], v230 offset:4096
    ds_read_b64_tr_b16 v[82:83], v230 offset:6144
    ds_read_b64_tr_b16 v[84:85], v231 offset:4096
    ds_write_b128 v246, a[184:187] offset:45056
    v_mfma_f32_32x32x16_bf16 v[32:47], v[100:103], a[36:39], v[32:47]
    ds_read_b64_tr_b16 v[86:87], v231 offset:6144
    ds_read_b64_tr_b16 v[88:89], v230 offset:5120
    ds_read_b64_tr_b16 v[90:91], v230 offset:7168
    s_waitcnt vmcnt(8)
    v_cmp_ne_u64 vcc, s[42:43], v[12:13]
    s_nop 0
    s_cmp_eq_u64 vcc, 0
    s_cbranch_scc1 L_p4_ok
L_p4_retry:
    s_add_u32 s100, s100, 1
    s_cmp_gt_u32 s100, 200000
    s_cbranch_scc1 L_p4_ok
    s_sleep 8
    buffer_load_dwordx2 v[12:13], v10, s[52:55], s83 offen sc1
    s_waitcnt vmcnt(0)
    v_cmp_ne_u64 vcc, s[42:43], v[12:13]
    s_nop 0
    s_cmp_eq_u64 vcc, 0
    s_cbranch_scc0 L_p4_retry
L_p4_ok:
    s_waitcnt lgkmcnt(8)
    v_mfma_f32_32x32x16_bf16 v[16:31], v[104:107], v[112:115], v[16:31]
    ds_read_b64_tr_b16 v[92:93], v231 offset:5120
    ds_read_b64_tr_b16 v[94:95], v231 offset:7168
    v_mfma_f32_32x32x16_bf16 v[32:47], v[108:111], v[112:115], v[32:47]
    s_waitcnt lgkmcnt(4)
    v_mfma_f32_32x32x16_bf16 v[16:31], v[80:83], v[116:119], v[16:31]
    ds_read_b64_tr_b16 v[96:97], v230 offset:8192
    ds_read_b64_tr_b16 v[98:99], v230 offset:10240
    ds_read_b64_tr_b16 v[100:101], v231 offset:8192
    s_add_u32 s69, s69, 1024
    buffer_load_dwordx2 v[14:15], v1, s[52:55], s69 offen offset:0 sc1
    v_mfma_f32_32x32x16_bf16 v[32:47], v[84:87], v[116:119], v[32:47]
    ds_read_b64_tr_b16 v[102:103], v231 offset:10240
    ds_read_b64_tr_b16 v[104:105], v230 offset:9216
    ds_read_b64_tr_b16 v[106:107], v230 offset:11264
    s_add_u32 s5, s79, 0
    buffer_load_dwordx2 v[176:177], v244, s[52:55], s5 offen sc1
    s_add_u32 s5, s79, 32768
    buffer_load_dwordx2 v[178:179], v244, s[52:55], s5 offen sc1
    s_waitcnt lgkmcnt(6)
    v_mfma_f32_32x32x16_bf16 v[16:31], v[88:91], a[40:43], v[16:31]
    ds_read_b64_tr_b16 v[108:109], v231 offset:9216
    ds_read_b64_tr_b16 v[110:111], v231 offset:11264
    v_mfma_f32_32x32x16_bf16 v[32:47], v[92:95], a[40:43], v[32:47]
    s_waitcnt lgkmcnt(4)
    v_mfma_f32_32x32x16_bf16 v[16:31], v[96:99], a[44:47], v[16:31]
    ds_read_b64_tr_b16 v[80:81], v230 offset:12288
    ds_read_b64_tr_b16 v[82:83], v230 offset:14336
    ds_read_b64_tr_b16 v[84:85], v231 offset:12288
    v_mfma_f32_32x32x16_bf16 v[32:47], v[100:103], a[44:47], v[32:47]
    ds_read_b64_tr_b16 v[86:87], v231 offset:14336
    ds_read_b64_tr_b16 v[88:89], v230 offset:13312
    ds_read_b64_tr_b16 v[90:91], v230 offset:15360
    s_add_u32 s5, s79, 65536
    buffer_load_dwordx2 v[180:181], v244, s[52:55], s5 offen sc1
    s_add_u32 s5, s79, 98304
    buffer_load_dwordx2 v[182:183], v244, s[52:55], s5 offen sc1
    s_waitcnt lgkmcnt(6)
    v_mfma_f32_32x32x16_bf16 v[16:31], v[104:107], v[120:123], v[16:31]
    ds_read_b64_tr_b16 v[92:93], v231 offset:13312
    ds_read_b64_tr_b16 v[94:95], v231 offset:15360
    v_mfma_f32_32x32x16_bf16 v[32:47], v[108:111], v[120:123], v[32:47]
    s_waitcnt vmcnt(11) lgkmcnt(4)
    v_mfma_f32_32x32x16_bf16 v[16:31], v[80:83], v[124:127], v[16:31]
    ds_read_b64_tr_b16 v[96:97], v230 offset:16384
    ds_read_b64_tr_b16 v[98:99], v230 offset:18432
    ds_read_b64_tr_b16 v[100:101], v231 offset:16384
    v_mfma_f32_32x32x16_bf16 v[32:47], v[84:87], v[124:127], v[32:47]
    ds_read_b64_tr_b16 v[102:103], v231 offset:18432
    ds_read_b64_tr_b16 v[104:105], v230 offset:17408
    ds_read_b64_tr_b16 v[106:107], v230 offset:19456
    s_add_u32 s5, s79, 131072
    buffer_load_dwordx2 v[184:185], v244, s[52:55], s5 offen sc1
    s_add_u32 s5, s79, 163840
    buffer_load_dwordx2 v[186:187], v244, s[52:55], s5 offen sc1
    s_waitcnt lgkmcnt(6)
    v_mfma_f32_32x32x16_bf16 v[16:31], v[88:91], a[48:51], v[16:31]
    ds_read_b64_tr_b16 v[108:109], v231 offset:17408
    ds_read_b64_tr_b16 v[110:111], v231 offset:19456
    v_mfma_f32_32x32x16_bf16 v[32:47], v[92:95], a[48:51], v[32:47]
    s_waitcnt vmcnt(11) lgkmcnt(4)
    v_mfma_f32_32x32x16_bf16 v[16:31], v[96:99], a[52:55], v[16:31]
    ds_read_b64_tr_b16 v[80:81], v230 offset:20480
    ds_read_b64_tr_b16 v[82:83], v230 offset:22528
    ds_read_b64_tr_b16 v[84:85], v231 offset:20480
    v_mfma_f32_32x32x16_bf16 v[32:47], v[100:103], a[52:55], v[32:47]
    ds_read_b64_tr_b16 v[86:87], v231 offset:22528
    ds_read_b64_tr_b16 v[88:89], v230 offset:21504
    ds_read_b64_tr_b16 v[90:91], v230 offset:23552
    s_add_u32 s5, s79, 196608
    buffer_load_dwordx2 v[188:189], v244, s[52:55], s5 offen sc1
    s_add_u32 s5, s79, 229376
    buffer_load_dwordx2 v[190:191], v244, s[52:55], s5 offen sc1
    s_waitcnt lgkmcnt(6)
    v_mfma_f32_32x32x16_bf16 v[16:31], v[104:107], v[128:131], v[16:31]
    ds_read_b64_tr_b16 v[92:93], v231 offset:21504
    ds_read_b64_tr_b16 v[94:95], v231 offset:23552
    v_mfma_f32_32x32x16_bf16 v[32:47], v[108:111], v[128:131], v[32:47]
    s_waitcnt vmcnt(11) lgkmcnt(4)
    v_mfma_f32_32x32x16_bf16 v[16:31], v[80:83], v[132:135], v[16:31]
    ds_read_b64_tr_b16 v[96:97], v230 offset:24576
    ds_read_b64_tr_b16 v[98:99], v230 offset:26624
    ds_read_b64_tr_b16 v[100:101], v231 offset:24576
    v_mfma_f32_32x32x16_bf16 v[32:47], v[84:87], v[132:135], v[32:47]
    ds_read_b64_tr_b16 v[102:103], v231 offset:26624
    ds_read_b64_tr_b16 v[104:105], v230 offset:25600
    ds_read_b64_tr_b16 v[106:107], v230 offset:27648
    s_waitcnt lgkmcnt(6)
    v_mfma_f32_32x32x16_bf16 v[16:31], v[88:91], a[56:59], v[16:31]
    ds_read_b64_tr_b16 v[108:109], v231 offset:25600
    ds_read_b64_tr_b16 v[110:111], v231 offset:27648
    v_mfma_f32_32x32x16_bf16 v[32:47], v[92:95], a[56:59], v[32:47]
    s_waitcnt lgkmcnt(0)
    s_barrier
    s_waitcnt vmcnt(9)
    v_mfma_f32_32x32x16_bf16 v[16:31], v[96:99], a[60:63], v[16:31]
    ds_read_b64_tr_b16 v[80:81], v230 offset:28672
    ds_read_b64_tr_b16 v[82:83], v230 offset:30720
    ds_read_b64_tr_b16 v[84:85], v231 offset:28672
    v_mfma_f32_32x32x16_bf16 v[32:47], v[100:103], a[60:63], v[32:47]
    ds_read_b64_tr_b16 v[86:87], v231 offset:30720
    ds_read_b64_tr_b16 v[88:89], v230 offset:29696
    ds_read_b64_tr_b16 v[90:91], v230 offset:31744
    v_mfma_f32_32x32x16_bf16 v[16:31], v[104:107], v[136:139], v[16:31]
    ds_read_b64_tr_b16 v[92:93], v231 offset:29696
    ds_read_b64_tr_b16 v[94:95], v231 offset:31744
    v_mfma_f32_32x32x16_bf16 v[32:47], v[108:111], v[136:139], v[32:47]
    s_waitcnt vmcnt(8)
    v_cmp_ne_u64 vcc, s[42:43], v[14:15]
    s_nop 0
    s_cmp_eq_u64 vcc, 0
    s_cbranch_scc1 L_p32_ok
L_p32_retry:
    s_add_u32 s100, s100, 1
    s_cmp_gt_u32 s100, 200000
    s_cbranch_scc1 L_p32_ok
    s_sleep 2
    buffer_load_dwordx2 v[14:15], v1, s[52:55], s69 offen offset:0 sc1
    s_waitcnt vmcnt(0)
    v_cmp_ne_u64 vcc, s[42:43], v[14:15]
    s_nop 0
    s_cmp_eq_u64 vcc, 0
    s_cbranch_scc0 L_p32_retry
L_p32_ok:
    s_add_u32 s101, s70, 16384
    buffer_load_dwordx4 v[140:143], v234, s[56:59], s101 offen offset:0 sc1
    buffer_load_dwordx4 a[64:67], v234, s[56:59], s101 offen offset:512 sc1
    s_add_u32 s101, s70, 20480
    buffer_load_dwordx4 a[68:71], v234, s[56:59], s101 offen offset:0 sc1
    buffer_load_dwordx4 v[144:147], v234, s[56:59], s101 offen offset:512 sc1
    s_add_u32 s101, s71, 16384
    buffer_load_dwordx4 v[148:151], v234, s[56:59], s101 offen offset:0 sc1
    buffer_load_dwordx4 a[72:75], v234, s[56:59], s101 offen offset:512 sc1
    s_waitcnt vmcnt(6)
    ds_write_b64 v242, v[176:177] offset:0
    ds_write_b64 v242, v[178:179] offset:576
    ds_write_b64 v242, v[180:181] offset:1152
    ds_write_b64 v242, v[182:183] offset:1728
    ds_write_b64 v242, v[184:185] offset:2304
    ds_write_b64 v242, v[186:187] offset:2880
    ds_write_b64 v242, v[188:189] offset:3456
    ds_write_b64 v242, v[190:191] offset:4032
    ds_read_b64_tr_b16 v[192:193], v243 offset:0
    ds_read_b64_tr_b16 v[194:195], v243 offset:576
    ds_read_b64_tr_b16 v[196:197], v243 offset:1152
    ds_read_b64_tr_b16 v[198:199], v243 offset:1728
    ds_read_b64_tr_b16 v[200:201], v243 offset:2304
    ds_read_b64_tr_b16 v[202:203], v243 offset:2880
    ds_read_b64_tr_b16 v[204:205], v243 offset:3456
    ds_read_b64_tr_b16 v[206:207], v243 offset:4032
    s_waitcnt lgkmcnt(0)
    v_lshlrev_b32 v176, 16, v192
    v_and_b32 v177, s15, v192
    v_lshlrev_b32 v178, 16, v193
    v_and_b32 v179, s15, v193
    s_add_u32 s101, s71, 20480
    buffer_load_dwordx4 a[76:79], v234, s[56:59], s101 offen offset:0 sc1
    buffer_load_dwordx4 v[152:155], v234, s[56:59], s101 offen offset:512 sc1
    v_fma_f32 v180, v48, v252, -v250
    v_fma_f32 v181, v49, v252, -v250
    v_fma_f32 v182, v50, v252, -v250
    v_fma_f32 v183, v51, v252, -v250
    v_fmac_f32 v48, v180, v176
    v_fmac_f32 v49, v181, v177
    v_fmac_f32 v50, v182, v178
    v_fmac_f32 v51, v183, v179
    v_lshlrev_b32 v176, 16, v194
    v_and_b32 v177, s15, v194
    v_lshlrev_b32 v178, 16, v195
    v_and_b32 v179, s15, v195
    v_fma_f32 v180, v52, v252, -v250
    v_fma_f32 v181, v53, v252, -v250
    v_fma_f32 v182, v54, v252, -v250
    v_fma_f32 v183, v55, v252, -v250
    v_fmac_f32 v52, v180, v176
    v_fmac_f32 v53, v181, v177
    v_fmac_f32 v54, v182, v178
    v_fmac_f32 v55, v183, v179
    v_lshlrev_b32 v176, 16, v196
    v_and_b32 v177, s15, v196
    s_add_u32 s101, s72, 16384
    buffer_load_dwordx4 v[156:159], v234, s[56:59], s101 offen offset:0 sc1
    buffer_load_dwordx4 a[80:83], v234, s[56:59], s101 offen offset:512 sc1
    v_lshlrev_b32 v178, 16, v197
    v_and_b32 v179, s15, v197
    v_fma_f32 v180, v56, v252, -v250
    v_fma_f32 v181, v57, v252, -v250
    v_fma_f32 v182, v58, v252, -v250
    v_fma_f32 v183, v59, v252, -v250
    v_fmac_f32 v56, v180, v176
    v_fmac_f32 v57, v181, v177
    v_fmac_f32 v58, v182, v178
    v_fmac_f32 v59, v183, v179
    v_lshlrev_b32 v176, 16, v198
    v_and_b32 v177, s15, v198
    v_lshlrev_b32 v178, 16, v199
    v_and_b32 v179, s15, v199
    v_fma_f32 v180, v60, v252, -v250
    v_fma_f32 v181, v61, v252, -v250
    v_fma_f32 v182, v62, v252, -v250
    v_fma_f32 v183, v63, v252, -v250
    v_fmac_f32 v60, v180, v176
    v_fmac_f32 v61, v181, v177
    v_fmac_f32 v62, v182, v178
    v_fmac_f32 v63, v183, v179
    s_add_u32 s101, s72, 20480
    buffer_load_dwordx4 a[84:87], v234, s[56:59], s101 offen offset:0 sc1
    buffer_load_dwordx4 v[160:163], v234, s[56:59], s101 offen offset:512 sc1
    v_lshlrev_b32 v176, 16, v200
    v_and_b32 v177, s15, v200
    v_lshlrev_b32 v178, 16, v201
    v_and_b32 v179, s15, v201
    v_fma_f32 v180, v64, v252, -v250
    v_fma_f32 v181, v65, v252, -v250
    v_fma_f32 v182, v66, v252, -v250
    v_fma_f32 v183, v67, v252, -v250
    v_fmac_f32 v64, v180, v176
    v_fmac_f32 v65, v181, v177
    v_fmac_f32 v66, v182, v178
    v_fmac_f32 v67, v183, v179
    v_lshlrev_b32 v176, 16, v202
    v_and_b32 v177, s15, v202
    v_lshlrev_b32 v178, 16, v203
    v_and_b32 v179, s15, v203
    v_fma_f32 v180, v68, v252, -v250
    v_fma_f32 v181, v69, v252, -v250
    v_fma_f32 v182, v70, v252, -v250
    v_fma_f32 v183, v71, v252, -v250
    v_fmac_f32 v68, v180, v176
    v_fmac_f32 v69, v181, v177
    s_add_u32 s101, s73, 16384
    buffer_load_dwordx4 v[164:167], v234, s[56:59], s101 offen offset:0 sc1
    buffer_load_dwordx4 a[88:91], v234, s[56:59], s101 offen offset:512 sc1
    v_fmac_f32 v70, v182, v178
    v_fmac_f32 v71, v183, v179
    v_lshlrev_b32 v176, 16, v204
    v_and_b32 v177, s15, v204
    v_lshlrev_b32 v178, 16, v205
    v_and_b32 v179, s15, v205
    v_fma_f32 v180, v72, v252, -v250
    v_fma_f32 v181, v73, v252, -v250
    v_fma_f32 v182, v74, v252, -v250
    v_fma_f32 v183, v75, v252, -v250
    v_fmac_f32 v72, v180, v176
    v_fmac_f32 v73, v181, v177
    v_fmac_f32 v74, v182, v178
    v_fmac_f32 v75, v183, v179
    v_lshlrev_b32 v176, 16, v206
    v_and_b32 v177, s15, v206
    v_lshlrev_b32 v178, 16, v207
    v_and_b32 v179, s15, v207
    v_fma_f32 v180, v76, v252, -v250
    v_fma_f32 v181, v77, v252, -v250
    v_fma_f32 v182, v78, v252, -v250
    v_fma_f32 v183, v79, v252, -v250
    s_add_u32 s101, s73, 20480
    buffer_load_dwordx4 a[92:95], v234, s[56:59], s101 offen offset:0 sc1
    buffer_load_dwordx4 v[168:171], v234, s[56:59], s101 offen offset:512 sc1
    v_fmac_f32 v76, v180, v176
    v_fmac_f32 v77, v181, v177
    v_fmac_f32 v78, v182, v178
    v_fmac_f32 v79, v183, v179
    s_mov_b32 s84, s36
    s_mov_b32 s85, s37
    s_mov_b32 s86, 1835008
    s_mov_b32 s87, 0x00020000
    s_waitcnt vmcnt(14)
    v_mfma_f32_32x32x16_bf16 v[16:31], v[80:83], v[140:143], v[16:31]
    ds_read_b64_tr_b16 v[96:97], v230 offset:32768
    ds_read_b64_tr_b16 v[98:99], v230 offset:34816
    ds_read_b64_tr_b16 v[100:101], v231 offset:32768
    v_mfma_f32_32x32x16_bf16 v[32:47], v[84:87], v[140:143], v[32:47]
    ds_read_b64_tr_b16 v[102:103], v231 offset:34816
    ds_read_b64_tr_b16 v[104:105], v230 offset:33792
    ds_read_b64_tr_b16 v[106:107], v230 offset:35840
    v_mfma_f32_32x32x16_bf16 v[16:31], v[88:91], a[64:67], v[16:31]
    ds_read_b64_tr_b16 v[108:109], v231 offset:33792
    ds_read_b64_tr_b16 v[110:111], v231 offset:35840
    v_mfma_f32_32x32x16_bf16 v[32:47], v[92:95], a[64:67], v[32:47]
    s_add_u32 s101, s74, 16384
    buffer_load_dwordx4 v[172:175], v234, s[56:59], s101 offen offset:0 sc1
    buffer_load_dwordx4 a[96:99], v234, s[56:59], s101 offen offset:512 sc1
    s_waitcnt vmcnt(14) lgkmcnt(4)
    v_mfma_f32_32x32x16_bf16 v[16:31], v[96:99], a[68:71], v[16:31]
    ds_read_b64_tr_b16 v[80:81], v230 offset:36864
    ds_read_b64_tr_b16 v[82:83], v230 offset:38912
    ds_read_b64_tr_b16 v[84:85], v231 offset:36864
    v_mfma_f32_32x32x16_bf16 v[32:47], v[100:103], a[68:71], v[32:47]
    ds_read_b64_tr_b16 v[86:87], v231 offset:38912
    ds_read_b64_tr_b16 v[88:89], v230 offset:37888
    ds_read_b64_tr_b16 v[90:91], v230 offset:39936
    s_waitcnt lgkmcnt(6)
    v_mfma_f32_32x32x16_bf16 v[16:31], v[104:107], v[144:147], v[16:31]
    ds_read_b64_tr_b16 v[92:93], v231 offset:37888
    ds_read_b64_tr_b16 v[94:95], v231 offset:39936
    v_mfma_f32_32x32x16_bf16 v[32:47], v[108:111], v[144:147], v[32:47]
    s_add_u32 s101, s74, 20480
    buffer_load_dwordx4 a[100:103], v234, s[56:59], s101 offen offset:0 sc1
    buffer_load_dwordx4 a[188:191], v234, s[56:59], s101 offen offset:512 sc1
    s_waitcnt vmcnt(14) lgkmcnt(4)
    v_mfma_f32_32x32x16_bf16 v[16:31], v[80:83], v[148:151], v[16:31]
    ds_read_b64_tr_b16 v[96:97], v230 offset:42496
    ds_read_b64_tr_b16 v[98:99], v230 offset:44544
    ds_read_b64_tr_b16 v[100:101], v231 offset:42496
    v_mfma_f32_32x32x16_bf16 v[32:47], v[84:87], v[148:151], v[32:47]
    ds_read_b64_tr_b16 v[102:103], v231 offset:44544
    ds_read_b64_tr_b16 v[104:105], v230 offset:43520
    ds_read_b64_tr_b16 v[106:107], v230 offset:45568
    s_waitcnt lgkmcnt(6)
    v_mfma_f32_32x32x16_bf16 v[16:31], v[88:91], a[72:75], v[16:31]
    ds_read_b64_tr_b16 v[108:109], v231 offset:43520
    ds_read_b64_tr_b16 v[110:111], v231 offset:45568
    v_mfma_f32_32x32x16_bf16 v[32:47], v[92:95], a[72:75], v[32:47]
    s_add_u32 s101, s75, 16384
    buffer_load_dwordx4 a[192:195], v234, s[56:59], s101 offen offset:0 sc1
    buffer_load_dwordx4 a[104:107], v234, s[56:59], s101 offen offset:512 sc1
    s_waitcnt vmcnt(14) lgkmcnt(4)
    v_mfma_f32_32x32x16_bf16 v[16:31], v[96:99], a[76:79], v[16:31]
    ds_read_b64_tr_b16 v[80:81], v230 offset:46592
    ds_read_b64_tr_b16 v[82:83], v230 offset:48640
    ds_read_b64_tr_b16 v[84:85], v231 offset:46592
    v_mfma_f32_32x32x16_bf16 v[32:47], v[100:103], a[76:79], v[32:47]
    ds_read_b64_tr_b16 v[86:87], v231 offset:48640
    ds_read_b64_tr_b16 v[88:89], v230 offset:47616
    ds_read_b64_tr_b16 v[90:91], v230 offset:49664
    s_waitcnt lgkmcnt(6)
    v_mfma_f32_32x32x16_bf16 v[16:31], v[104:107], v[152:155], v[16:31]
    ds_read_b64_tr_b16 v[92:93], v231 offset:47616
    ds_read_b64_tr_b16 v[94:95], v231 offset:49664
    v_mfma_f32_32x32x16_bf16 v[32:47], v[108:111], v[152:155], v[32:47]
    s_add_u32 s101, s75, 20480
    buffer_load_dwordx4 a[108:111], v234, s[56:59], s101 offen offset:0 sc1
    buffer_load_dwordx4 a[196:199], v234, s[56:59], s101 offen offset:512 sc1
    s_waitcnt vmcnt(14) lgkmcnt(4)
    v_mfma_f32_32x32x16_bf16 v[16:31], v[80:83], v[156:159], v[16:31]
    ds_read_b64_tr_b16 v[96:97], v230 offset:50688
    ds_read_b64_tr_b16 v[98:99], v230 offset:52736
    ds_read_b64_tr_b16 v[100:101], v231 offset:50688
    v_mfma_f32_32x32x16_bf16 v[32:47], v[84:87], v[156:159], v[32:47]
    ds_read_b64_tr_b16 v[102:103], v231 offset:52736
    ds_read_b64_tr_b16 v[104:105], v230 offset:51712
    ds_read_b64_tr_b16 v[106:107], v230 offset:53760
    s_waitcnt lgkmcnt(6)
    v_mfma_f32_32x32x16_bf16 v[16:31], v[88:91], a[80:83], v[16:31]
    ds_read_b64_tr_b16 v[108:109], v231 offset:51712
    ds_read_b64_tr_b16 v[110:111], v231 offset:53760
    v_mfma_f32_32x32x16_bf16 v[32:47], v[92:95], a[80:83], v[32:47]
    s_add_u32 s101, s76, 16384
    buffer_load_dwordx4 a[200:203], v234, s[56:59], s101 offen offset:0 sc1
    buffer_load_dwordx4 a[112:115], v234, s[56:59], s101 offen offset:512 sc1
    s_waitcnt vmcnt(14) lgkmcnt(4)
    v_mfma_f32_32x32x16_bf16 v[16:31], v[96:99], a[84:87], v[16:31]
    ds_read_b64_tr_b16 v[80:81], v230 offset:54784
    ds_read_b64_tr_b16 v[82:83], v230 offset:56832
    ds_read_b64_tr_b16 v[84:85], v231 offset:54784
    s_add_u32 s69, s69, 1024
    buffer_load_dwordx2 v[14:15], v1, s[52:55], s69 offen offset:0 sc1
    v_mfma_f32_32x32x16_bf16 v[32:47], v[100:103], a[84:87], v[32:47]
    ds_read_b64_tr_b16 v[86:87], v231 offset:56832
    ds_read_b64_tr_b16 v[88:89], v230 offset:55808
    ds_read_b64_tr_b16 v[90:91], v230 offset:57856
    s_waitcnt lgkmcnt(6)
    v_mfma_f32_32x32x16_bf16 v[16:31], v[104:107], v[160:163], v[16:31]
    ds_read_b64_tr_b16 v[92:93], v231 offset:55808
    ds_read_b64_tr_b16 v[94:95], v231 offset:57856
    v_mfma_f32_32x32x16_bf16 v[32:47], v[108:111], v[160:163], v[32:47]
    s_add_u32 s101, s76, 20480
    buffer_load_dwordx4 a[116:119], v234, s[56:59], s101 offen offset:0 sc1
    buffer_load_dwordx4 a[204:207], v234, s[56:59], s101 offen offset:512 sc1
    s_waitcnt vmcnt(15) lgkmcnt(4)
    v_mfma_f32_32x32x16_bf16 v[16:31], v[80:83], v[164:167], v[16:31]
    ds_read_b64_tr_b16 v[96:97], v230 offset:58880
    ds_read_b64_tr_b16 v[98:99], v230 offset:60928
    ds_read_b64_tr_b16 v[100:101], v231 offset:58880
    v_mfma_f32_32x32x16_bf16 v[32:47], v[84:87], v[164:167], v[32:47]
    ds_read_b64_tr_b16 v[102:103], v231 offset:60928
    ds_read_b64_tr_b16 v[104:105], v230 offset:59904
    ds_read_b64_tr_b16 v[106:107], v230 offset:61952
    s_waitcnt lgkmcnt(6)
    v_mfma_f32_32x32x16_bf16 v[16:31], v[88:91], a[88:91], v[16:31]
    ds_read_b64_tr_b16 v[108:109], v231 offset:59904
    ds_read_b64_tr_b16 v[110:111], v231 offset:61952
    v_mfma_f32_32x32x16_bf16 v[32:47], v[92:95], a[88:91], v[32:47]
    s_add_u32 s101, s77, 16384
    buffer_load_dwordx4 a[208:211], v234, s[56:59], s101 offen offset:0 sc1
    buffer_load_dwordx4 a[120:123], v234, s[56:59], s101 offen offset:512 sc1
    s_waitcnt vmcnt(15) lgkmcnt(4)
    v_mfma_f32_32x32x16_bf16 v[16:31], v[96:99], a[92:95], v[16:31]
    ds_read_b64_tr_b16 v[80:81], v230 offset:62976
    ds_read_b64_tr_b16 v[82:83], v230 offset:65024
    ds_read_b64_tr_b16 v[84:85], v231 offset:62976
    v_mfma_f32_32x32x16_bf16 v[32:47], v[100:103], a[92:95], v[32:47]
    ds_read_b64_tr_b16 v[86:87], v231 offset:65024
    ds_read_b64_tr_b16 v[88:89], v230 offset:64000
    ds_read_b64_tr_b16 v[90:91], v232 offset:512
    s_waitcnt lgkmcnt(6)
    v_mfma_f32_32x32x16_bf16 v[16:31], v[104:107], v[168:171], v[16:31]
    ds_read_b64_tr_b16 v[92:93], v231 offset:64000
    ds_read_b64_tr_b16 v[94:95], v233 offset:512
    v_mfma_f32_32x32x16_bf16 v[32:47], v[108:111], v[168:171], v[32:47]
    s_add_u32 s101, s77, 20480
    buffer_load_dwordx4 a[124:127], v234, s[56:59], s101 offen offset:0 sc1
    buffer_load_dwordx4 a[212:215], v234, s[56:59], s101 offen offset:512 sc1
    s_waitcnt vmcnt(15) lgkmcnt(4)
    v_mfma_f32_32x32x16_bf16 v[16:31], v[80:83], v[172:175], v[16:31]
    ds_read_b64_tr_b16 v[96:97], v232 offset:1536
    ds_read_b64_tr_b16 v[98:99], v232 offset:3584
    ds_read_b64_tr_b16 v[100:101], v233 offset:1536
    v_mfma_f32_32x32x16_bf16 v[32:47], v[84:87], v[172:175], v[32:47]
    ds_read_b64_tr_b16 v[102:103], v233 offset:3584
    ds_read_b64_tr_b16 v[104:105], v232 offset:2560
    ds_read_b64_tr_b16 v[106:107], v232 offset:4608
    s_waitcnt lgkmcnt(6)
    v_mfma_f32_32x32x16_bf16 v[16:31], v[88:91], a[96:99], v[16:31]
    ds_read_b64_tr_b16 v[108:109], v233 offset:2560
    ds_read_b64_tr_b16 v[110:111], v233 offset:4608
    v_mfma_f32_32x32x16_bf16 v[32:47], v[92:95], a[96:99], v[32:47]
    s_waitcnt vmcnt(13) lgkmcnt(4)
    v_mfma_f32_32x32x16_bf16 v[16:31], v[96:99], a[100:103], v[16:31]
    ds_read_b64_tr_b16 v[80:81], v232 offset:5632
    ds_read_b64_tr_b16 v[82:83], v232 offset:7680
    ds_read_b64_tr_b16 v[84:85], v233 offset:5632
    v_mfma_f32_32x32x16_bf16 v[32:47], v[100:103], a[100:103], v[32:47]
    ds_read_b64_tr_b16 v[86:87], v233 offset:7680
    ds_read_b64_tr_b16 v[88:89], v232 offset:6656
    ds_read_b64_tr_b16 v[90:91], v232 offset:8704
    s_waitcnt lgkmcnt(6)
    v_mfma_f32_32x32x16_bf16 v[16:31], v[104:107], a[188:191], v[16:31]
    ds_read_b64_tr_b16 v[92:93], v233 offset:6656
    ds_read_b64_tr_b16 v[94:95], v233 offset:8704
    v_mfma_f32_32x32x16_bf16 v[32:47], v[108:111], a[188:191], v[32:47]
    s_waitcnt vmcnt(11) lgkmcnt(4)
    v_mfma_f32_32x32x16_bf16 v[16:31], v[80:83], a[192:195], v[16:31]
    ds_read_b64_tr_b16 v[96:97], v232 offset:9728
    ds_read_b64_tr_b16 v[98:99], v232 offset:11776
    ds_read_b64_tr_b16 v[100:101], v233 offset:9728
    v_mfma_f32_32x32x16_bf16 v[32:47], v[84:87], a[192:195], v[32:47]
    ds_read_b64_tr_b16 v[102:103], v233 offset:11776
    ds_read_b64_tr_b16 v[104:105], v232 offset:10752
    ds_read_b64_tr_b16 v[106:107], v232 offset:12800
    s_waitcnt lgkmcnt(6)
    v_mfma_f32_32x32x16_bf16 v[16:31], v[88:91], a[104:107], v[16:31]
    ds_read_b64_tr_b16 v[108:109], v233 offset:10752
    ds_read_b64_tr_b16 v[110:111], v233 offset:12800
    v_mfma_f32_32x32x16_bf16 v[32:47], v[92:95], a[104:107], v[32:47]
    s_waitcnt vmcnt(6)
    v_cmp_ne_u64 vcc, s[42:43], v[14:15]
    s_nop 0
    s_cmp_eq_u64 vcc, 0
    s_cbranch_scc1 L_p33_ok
L_p33_retry:
    s_add_u32 s100, s100, 1
    s_cmp_gt_u32 s100, 200000
    s_cbranch_scc1 L_p33_ok
    s_sleep 2
    buffer_load_dwordx2 v[14:15], v1, s[52:55], s69 offen offset:0 sc1
    s_waitcnt vmcnt(0)
    v_cmp_ne_u64 vcc, s[42:43], v[14:15]
    s_nop 0
    s_cmp_eq_u64 vcc, 0
    s_cbranch_scc0 L_p33_retry
L_p33_ok:
    s_mul_i32 s101, s16, 1
    buffer_load_dwordx4 a[216:219], v234, s[56:59], s101 offen offset:0 sc1
    buffer_load_dwordx4 a[128:131], v234, s[56:59], s101 offen offset:512 sc1
    s_mul_i32 s101, s17, 1
    buffer_load_dwordx4 a[132:135], v234, s[56:59], s101 offen offset:0 sc1
    buffer_load_dwordx4 a[220:223], v234, s[56:59], s101 offen offset:512 sc1
    s_mul_i32 s101, s18, 1
    buffer_load_dwordx4 a[224:227], v234, s[56:59], s101 offen offset:0 sc1
    buffer_load_dwordx4 a[136:139], v234, s[56:59], s101 offen offset:512 sc1
    s_waitcnt lgkmcnt(4)
    v_mfma_f32_32x32x16_bf16 v[16:31], v[96:99], a[108:111], v[16:31]
    ds_read_b64_tr_b16 v[80:81], v228 offset:0
    ds_read_b64_tr_b16 v[82:83], v228 offset:2048
    ds_read_b64_tr_b16 v[84:85], v229 offset:0
    v_mfma_f32_32x32x16_bf16 v[32:47], v[100:103], a[108:111], v[32:47]
    ds_read_b64_tr_b16 v[86:87], v229 offset:2048
    ds_read_b64_tr_b16 v[88:89], v228 offset:1024
    ds_read_b64_tr_b16 v[90:91], v228 offset:3072
    s_waitcnt lgkmcnt(6)
    v_mfma_f32_32x32x16_bf16 v[16:31], v[104:107], a[196:199], v[16:31]
    ds_read_b64_tr_b16 v[92:93], v229 offset:1024
    ds_read_b64_tr_b16 v[94:95], v229 offset:3072
    v_mfma_f32_32x32x16_bf16 v[32:47], v[108:111], a[196:199], v[32:47]
    s_mul_i32 s101, s19, 1
    buffer_load_dwordx4 a[140:143], v234, s[56:59], s101 offen offset:0 sc1
    buffer_load_dwordx4 a[228:231], v234, s[56:59], s101 offen offset:512 sc1
    s_waitcnt lgkmcnt(4)
    v_mfma_f32_32x32x16_bf16 v[16:31], v[80:83], a[200:203], v[16:31]
    ds_read_b64_tr_b16 v[96:97], v228 offset:4096
    ds_read_b64_tr_b16 v[98:99], v228 offset:6144
    ds_read_b64_tr_b16 v[100:101], v229 offset:4096
    v_mfma_f32_32x32x16_bf16 v[32:47], v[84:87], a[200:203], v[32:47]
    ds_read_b64_tr_b16 v[102:103], v229 offset:6144
    ds_read_b64_tr_b16 v[104:105], v228 offset:5120
    ds_read_b64_tr_b16 v[106:107], v228 offset:7168
    s_waitcnt lgkmcnt(6)
    v_mfma_f32_32x32x16_bf16 v[16:31], v[88:91], a[112:115], v[16:31]
    ds_read_b64_tr_b16 v[108:109], v229 offset:5120
    ds_read_b64_tr_b16 v[110:111], v229 offset:7168
    v_mfma_f32_32x32x16_bf16 v[32:47], v[92:95], a[112:115], v[32:47]
    s_mul_i32 s101, s20, 1
    buffer_load_dwordx4 a[232:235], v234, s[56:59], s101 offen offset:0 sc1
    buffer_load_dwordx4 a[144:147], v234, s[56:59], s101 offen offset:512 sc1
    s_waitcnt vmcnt(14) lgkmcnt(4)
    v_mfma_f32_32x32x16_bf16 v[16:31], v[96:99], a[116:119], v[16:31]
    ds_read_b64_tr_b16 v[80:81], v228 offset:8192
    ds_read_b64_tr_b16 v[82:83], v228 offset:10240
    ds_read_b64_tr_b16 v[84:85], v229 offset:8192
    v_mfma_f32_32x32x16_bf16 v[32:47], v[100:103], a[116:119], v[32:47]
    ds_read_b64_tr_b16 v[86:87], v229 offset:10240
    ds_read_b64_tr_b16 v[88:89], v228 offset:9216
    ds_read_b64_tr_b16 v[90:91], v228 offset:11264
    s_waitcnt lgkmcnt(6)
    v_mfma_f32_32x32x16_bf16 v[16:31], v[104:107], a[204:207], v[16:31]
    ds_read_b64_tr_b16 v[92:93], v229 offset:9216
    ds_read_b64_tr_b16 v[94:95], v229 offset:11264
    v_mfma_f32_32x32x16_bf16 v[32:47], v[108:111], a[204:207], v[32:47]
    s_mul_i32 s101, s21, 1
    buffer_load_dwordx4 a[148:151], v234, s[56:59], s101 offen offset:0 sc1
    buffer_load_dwordx4 a[236:239], v234, s[56:59], s101 offen offset:512 sc1
    s_waitcnt vmcnt(14) lgkmcnt(4)
    v_mfma_f32_32x32x16_bf16 v[16:31], v[80:83], a[208:211], v[16:31]
    ds_read_b64_tr_b16 v[96:97], v228 offset:12288
    ds_read_b64_tr_b16 v[98:99], v228 offset:14336
    ds_read_b64_tr_b16 v[100:101], v229 offset:12288
    v_mfma_f32_32x32x16_bf16 v[32:47], v[84:87], a[208:211], v[32:47]
    ds_read_b64_tr_b16 v[102:103], v229 offset:14336
    ds_read_b64_tr_b16 v[104:105], v228 offset:13312
    ds_read_b64_tr_b16 v[106:107], v228 offset:15360
    s_waitcnt lgkmcnt(6)
    v_mfma_f32_32x32x16_bf16 v[16:31], v[88:91], a[120:123], v[16:31]
    ds_read_b64_tr_b16 v[108:109], v229 offset:13312
    ds_read_b64_tr_b16 v[110:111], v229 offset:15360
    v_mfma_f32_32x32x16_bf16 v[32:47], v[92:95], a[120:123], v[32:47]
    s_mul_i32 s101, s22, 1
    buffer_load_dwordx4 a[240:243], v234, s[56:59], s101 offen offset:0 sc1
    buffer_load_dwordx4 a[152:155], v234, s[56:59], s101 offen offset:512 sc1
    s_waitcnt vmcnt(14) lgkmcnt(4)
    v_mfma_f32_32x32x16_bf16 v[16:31], v[96:99], a[124:127], v[16:31]
    ds_read_b64_tr_b16 v[80:81], v228 offset:16384
    ds_read_b64_tr_b16 v[82:83], v228 offset:18432
    ds_read_b64_tr_b16 v[84:85], v229 offset:16384
    v_mfma_f32_32x32x16_bf16 v[32:47], v[100:103], a[124:127], v[32:47]
    ds_read_b64_tr_b16 v[86:87], v229 offset:18432
    ds_read_b64_tr_b16 v[88:89], v228 offset:17408
    ds_read_b64_tr_b16 v[90:91], v228 offset:19456
    s_waitcnt lgkmcnt(6)
    v_mfma_f32_32x32x16_bf16 v[16:31], v[104:107], a[212:215], v[16:31]
    ds_read_b64_tr_b16 v[92:93], v229 offset:17408
    ds_read_b64_tr_b16 v[94:95], v229 offset:19456
    v_mfma_f32_32x32x16_bf16 v[32:47], v[108:111], a[212:215], v[32:47]
    s_mul_i32 s101, s23, 1
    buffer_load_dwordx4 a[156:159], v234, s[56:59], s101 offen offset:0 sc1
    buffer_load_dwordx4 a[244:247], v234, s[56:59], s101 offen offset:512 sc1
    s_waitcnt vmcnt(14) lgkmcnt(4)
    v_mfma_f32_32x32x16_bf16 v[16:31], v[80:83], a[216:219], v[16:31]
    ds_read_b64_tr_b16 v[96:97], v228 offset:20480
    ds_read_b64_tr_b16 v[98:99], v228 offset:22528
    ds_read_b64_tr_b16 v[100:101], v229 offset:20480
    v_mfma_f32_32x32x16_bf16 v[32:47], v[84:87], a[216:219], v[32:47]
    ds_read_b64_tr_b16 v[102:103], v229 offset:22528
    ds_read_b64_tr_b16 v[104:105], v228 offset:21504
    ds_read_b64_tr_b16 v[106:107], v228 offset:23552
    s_waitcnt lgkmcnt(6)
    v_mfma_f32_32x32x16_bf16 v[16:31], v[88:91], a[128:131], v[16:31]
    ds_read_b64_tr_b16 v[108:109], v229 offset:21504
    ds_read_b64_tr_b16 v[110:111], v229 offset:23552
    v_mfma_f32_32x32x16_bf16 v[32:47], v[92:95], a[128:131], v[32:47]
    s_waitcnt vmcnt(12) lgkmcnt(4)
    v_mfma_f32_32x32x16_bf16 v[16:31], v[96:99], a[132:135], v[16:31]
    ds_read_b64_tr_b16 v[80:81], v228 offset:24576
    ds_read_b64_tr_b16 v[82:83], v228 offset:26624
    ds_read_b64_tr_b16 v[84:85], v229 offset:24576
    v_mfma_f32_32x32x16_bf16 v[32:47], v[100:103], a[132:135], v[32:47]
    ds_read_b64_tr_b16 v[86:87], v229 offset:26624
    ds_read_b64_tr_b16 v[88:89], v228 offset:25600
    ds_read_b64_tr_b16 v[90:91], v228 offset:27648
    s_waitcnt lgkmcnt(6)
    v_mfma_f32_32x32x16_bf16 v[16:31], v[104:107], a[220:223], v[16:31]
    ds_read_b64_tr_b16 v[92:93], v229 offset:25600
    ds_read_b64_tr_b16 v[94:95], v229 offset:27648
    v_mfma_f32_32x32x16_bf16 v[32:47], v[108:111], a[220:223], v[32:47]
    s_waitcnt vmcnt(10) lgkmcnt(4)
    v_mfma_f32_32x32x16_bf16 v[16:31], v[80:83], a[224:227], v[16:31]
    ds_read_b64_tr_b16 v[96:97], v228 offset:28672
    ds_read_b64_tr_b16 v[98:99], v228 offset:30720
    ds_read_b64_tr_b16 v[100:101], v229 offset:28672
    v_mfma_f32_32x32x16_bf16 v[32:47], v[84:87], a[224:227], v[32:47]
    ds_read_b64_tr_b16 v[102:103], v229 offset:30720
    ds_read_b64_tr_b16 v[104:105], v228 offset:29696
    ds_read_b64_tr_b16 v[106:107], v228 offset:31744
    s_waitcnt lgkmcnt(6)
    v_mfma_f32_32x32x16_bf16 v[16:31], v[88:91], a[136:139], v[16:31]
    ds_read_b64_tr_b16 v[108:109], v229 offset:29696
    ds_read_b64_tr_b16 v[110:111], v229 offset:31744
    v_mfma_f32_32x32x16_bf16 v[32:47], v[92:95], a[136:139], v[32:47]
    s_waitcnt vmcnt(8) lgkmcnt(4)
    v_mfma_f32_32x32x16_bf16 v[16:31], v[96:99], a[140:143], v[16:31]
    ds_read_b64_tr_b16 v[80:81], v228 offset:32768
    ds_read_b64_tr_b16 v[82:83], v228 offset:34816
    ds_read_b64_tr_b16 v[84:85], v229 offset:32768
    v_mfma_f32_32x32x16_bf16 v[32:47], v[100:103], a[140:143], v[32:47]
    ds_read_b64_tr_b16 v[86:87], v229 offset:34816
    ds_read_b64_tr_b16 v[88:89], v228 offset:33792
    ds_read_b64_tr_b16 v[90:91], v228 offset:35840
    s_waitcnt lgkmcnt(6)
    v_mfma_f32_32x32x16_bf16 v[16:31], v[104:107], a[228:231], v[16:31]
    ds_read_b64_tr_b16 v[92:93], v229 offset:33792
    ds_read_b64_tr_b16 v[94:95], v229 offset:35840
    v_mfma_f32_32x32x16_bf16 v[32:47], v[108:111], a[228:231], v[32:47]
    s_waitcnt vmcnt(6) lgkmcnt(4)
    v_mfma_f32_32x32x16_bf16 v[16:31], v[80:83], a[232:235], v[16:31]
    ds_read_b64_tr_b16 v[96:97], v228 offset:36864
    ds_read_b64_tr_b16 v[98:99], v228 offset:38912
    ds_read_b64_tr_b16 v[100:101], v229 offset:36864
    v_mfma_f32_32x32x16_bf16 v[32:47], v[84:87], a[232:235], v[32:47]
    ds_read_b64_tr_b16 v[102:103], v229 offset:38912
    ds_read_b64_tr_b16 v[104:105], v228 offset:37888
    ds_read_b64_tr_b16 v[106:107], v228 offset:39936
    s_waitcnt lgkmcnt(6)
    v_mfma_f32_32x32x16_bf16 v[16:31], v[88:91], a[144:147], v[16:31]
    ds_read_b64_tr_b16 v[108:109], v229 offset:37888
    ds_read_b64_tr_b16 v[110:111], v229 offset:39936
    v_mfma_f32_32x32x16_bf16 v[32:47], v[92:95], a[144:147], v[32:47]
    s_waitcnt vmcnt(4) lgkmcnt(4)
    v_mfma_f32_32x32x16_bf16 v[16:31], v[96:99], a[148:151], v[16:31]
    ds_read_b64_tr_b16 v[80:81], v228 offset:40960
    ds_read_b64_tr_b16 v[82:83], v228 offset:43008
    ds_read_b64_tr_b16 v[84:85], v229 offset:40960
    v_mfma_f32_32x32x16_bf16 v[32:47], v[100:103], a[148:151], v[32:47]
    ds_read_b64_tr_b16 v[86:87], v229 offset:43008
    ds_read_b64_tr_b16 v[88:89], v228 offset:41984
    ds_read_b64_tr_b16 v[90:91], v228 offset:44032
    s_waitcnt lgkmcnt(6)
    v_mfma_f32_32x32x16_bf16 v[16:31], v[104:107], a[236:239], v[16:31]
    ds_read_b64_tr_b16 v[92:93], v229 offset:41984
    ds_read_b64_tr_b16 v[94:95], v229 offset:44032
    v_mfma_f32_32x32x16_bf16 v[32:47], v[108:111], a[236:239], v[32:47]
    s_waitcnt vmcnt(2) lgkmcnt(4)
    v_mfma_f32_32x32x16_bf16 v[16:31], v[80:83], a[240:243], v[16:31]
    ds_read_b64_tr_b16 v[96:97], v228 offset:45056
    ds_read_b64_tr_b16 v[98:99], v228 offset:47104
    ds_read_b64_tr_b16 v[100:101], v229 offset:45056
    v_mfma_f32_32x32x16_bf16 v[32:47], v[84:87], a[240:243], v[32:47]
    ds_read_b64_tr_b16 v[102:103], v229 offset:47104
    ds_read_b64_tr_b16 v[104:105], v228 offset:46080
    ds_read_b64_tr_b16 v[106:107], v228 offset:48128
    s_waitcnt lgkmcnt(6)
    v_mfma_f32_32x32x16_bf16 v[16:31], v[88:91], a[152:155], v[16:31]
    ds_read_b64_tr_b16 v[108:109], v229 offset:46080
    ds_read_b64_tr_b16 v[110:111], v229 offset:48128
    v_mfma_f32_32x32x16_bf16 v[32:47], v[92:95], a[152:155], v[32:47]
    s_waitcnt vmcnt(0) lgkmcnt(4)
    v_mfma_f32_32x32x16_bf16 v[16:31], v[96:99], a[156:159], v[16:31]
    v_mfma_f32_32x32x16_bf16 v[32:47], v[100:103], a[156:159], v[32:47]
    s_waitcnt lgkmcnt(0)
    v_mfma_f32_32x32x16_bf16 v[16:31], v[104:107], a[244:247], v[16:31]
    v_mfma_f32_32x32x16_bf16 v[32:47], v[108:111], a[244:247], v[32:47]
    s_nop 10
    v_fmac_f32 v48, v16, v254
    v_fmac_f32 v49, v17, v254
    v_fmac_f32 v50, v18, v254
    v_fmac_f32 v51, v19, v254
    v_cvt_pk_bf16_f32 v80, v48, v49
    v_cvt_pk_bf16_f32 v81, v50, v51
    ds_write_b64 v241, v[80:81] offset:0
    v_fmac_f32 v52, v20, v254
    v_fmac_f32 v53, v21, v254
    v_fmac_f32 v54, v22, v254
    v_fmac_f32 v55, v23, v254
    v_cvt_pk_bf16_f32 v82, v52, v53
    v_cvt_pk_bf16_f32 v83, v54, v55
    ds_write_b64 v241, v[82:83] offset:16
    v_fmac_f32 v56, v24, v254
    v_fmac_f32 v57, v25, v254
    v_fmac_f32 v58, v26, v254
    v_fmac_f32 v59, v27, v254
    v_cvt_pk_bf16_f32 v84, v56, v57
    v_cvt_pk_bf16_f32 v85, v58, v59
    ds_write_b64 v241, v[84:85] offset:32
    v_fmac_f32 v60, v28, v254
    v_fmac_f32 v61, v29, v254
    v_fmac_f32 v62, v30, v254
    v_fmac_f32 v63, v31, v254
    v_cvt_pk_bf16_f32 v86, v60, v61
    v_cvt_pk_bf16_f32 v87, v62, v63
    ds_write_b64 v241, v[86:87] offset:48
    v_fmac_f32 v64, v32, v254
    v_fmac_f32 v65, v33, v254
    v_fmac_f32 v66, v34, v254
    v_fmac_f32 v67, v35, v254
    v_cvt_pk_bf16_f32 v88, v64, v65
    v_cvt_pk_bf16_f32 v89, v66, v67
    ds_write_b64 v241, v[88:89] offset:64
    v_fmac_f32 v68, v36, v254
    v_fmac_f32 v69, v37, v254
    v_fmac_f32 v70, v38, v254
    v_fmac_f32 v71, v39, v254
    v_cvt_pk_bf16_f32 v90, v68, v69
    v_cvt_pk_bf16_f32 v91, v70, v71
    ds_write_b64 v241, v[90:91] offset:80
    v_fmac_f32 v72, v40, v254
    v_fmac_f32 v73, v41, v254
    v_fmac_f32 v74, v42, v254
    v_fmac_f32 v75, v43, v254
    v_cvt_pk_bf16_f32 v92, v72, v73
    v_cvt_pk_bf16_f32 v93, v74, v75
    ds_write_b64 v241, v[92:93] offset:96
    v_fmac_f32 v76, v44, v254
    v_fmac_f32 v77, v45, v254
    v_fmac_f32 v78, v46, v254
    v_fmac_f32 v79, v47, v254
    v_cvt_pk_bf16_f32 v94, v76, v77
    v_cvt_pk_bf16_f32 v95, v78, v79
    ds_write_b64 v241, v[94:95] offset:112
    ds_read_b128 v[112:115], v240 offset:0
    ds_read_b128 v[116:119], v240 offset:1152
    ds_read_b128 v[120:123], v240 offset:2304
    ds_read_b128 v[124:127], v240 offset:3456
    s_add_u32 s5, s78, 0
    s_waitcnt lgkmcnt(3)
    buffer_store_dwordx4 v[112:115], v245, s[84:87], s5 offen nt
    s_add_u32 s5, s78, 7168
    s_waitcnt lgkmcnt(2)
    buffer_store_dwordx4 v[116:119], v245, s[84:87], s5 offen nt
    s_add_u32 s5, s78, 14336
    s_waitcnt lgkmcnt(1)
    buffer_store_dwordx4 v[120:123], v245, s[84:87], s5 offen nt
    s_add_u32 s5, s78, 21504
    s_waitcnt lgkmcnt(0)
    buffer_store_dwordx4 v[124:127], v245, s[84:87], s5 offen nt
    s_endpgm
L_srole:
    s_sub_u32 s5, s5, 30
    s_lshl_b32 s5, s5, 3
    s_add_u32 s64, s5, s4
    s_lshr_b32 s6, s64, 2
    s_mul_i32 s6, s6, 896
    s_bfe_u32 s7, s64, 0x10001
    s_mul_i32 s7, s7, 384
    s_add_u32 s70, s6, s7
    s_add_u32 s70, s70, 128
    s_add_u32 s71, s70, 128
    s_add_u32 s72, s6, 768
    v_lshrrev_b32 v8, 3, v2
    s_mul_i32 s5, s3, 112
    v_add_u32 v8, s5, v8
    v_mul_u32_u24 v8, 3584, v8
    v_and_b32 v9, 7, v2
    v_lshl_add_u32 v8, v9, 4, v8
    v_mov_b32 v5, 0
    s_bitcmp0_b32 s64, 0
    s_waitcnt lgkmcnt(0)
    s_cselect_b32 s48, s30, s32
    s_cselect_b32 s49, s31, s33
    s_mov_b32 s50, 1605632
    s_mov_b32 s51, 0x00020000
    s_mov_b32 s60, s38
    s_mov_b32 s61, s39
    s_mov_b32 s62, 0
    s_mov_b32 s63, 0x00020000
    s_cmp_eq_u32 s64, 0
    s_cselect_b32 s62, 256, 0
    s_bitset1_b32 s93, 31
    v_mov_b32 v6, s92
    v_mov_b32 v7, s93
    buffer_store_dwordx2 v[6:7], v4, s[60:63], 0 offen sc1
    s_mov_b32 s52, s40
    s_mov_b32 s53, s41
    s_mov_b32 s54, 11141120
    s_mov_b32 s55, 0x00020000
    s_add_u32 s5, s70, 0
    buffer_load_dwordx4 v[64:67], v8, s[48:51], s5 offen
    s_add_u32 s5, s70, 28672
    buffer_load_dwordx4 v[68:71], v8, s[48:51], s5 offen
    s_add_u32 s5, s70, 57344
    buffer_load_dwordx4 v[72:75], v8, s[48:51], s5 offen
    s_add_u32 s5, s70, 86016
    buffer_load_dwordx4 v[76:79], v8, s[48:51], s5 offen
    s_add_u32 s5, s70, 114688
    buffer_load_dwordx4 v[80:83], v8, s[48:51], s5 offen
    s_mov_b32 s62, 256
    s_lshl_b32 s5, s3, 11
    v_lshl_add_u32 v9, v2, 5, s5
    v_lshlrev_b32 v13, 2, v2
    s_add_u32 s5, s70, 143360
    buffer_load_dwordx4 v[84:87], v8, s[48:51], s5 offen
    s_waitcnt vmcnt(5)
    v_lshlrev_b32 v20, 16, v64
    v_and_b32 v21, s15, v64
    v_lshlrev_b32 v22, 16, v65
    v_and_b32 v23, s15, v65
    v_lshlrev_b32 v24, 16, v66
    v_and_b32 v25, s15, v66
    v_lshlrev_b32 v26, 16, v67
    v_and_b32 v27, s15, v67
    s_add_u32 s5, s70, 172032
    buffer_load_dwordx4 v[88:91], v8, s[48:51], s5 offen
    s_waitcnt vmcnt(5)
    v_lshlrev_b32 v10, 16, v68
    v_and_b32 v11, s15, v68
    v_add_f32 v20, v20, v10
    v_add_f32 v21, v21, v11
    v_lshlrev_b32 v10, 16, v69
    v_and_b32 v11, s15, v69
    v_add_f32 v22, v22, v10
    v_add_f32 v23, v23, v11
    v_lshlrev_b32 v10, 16, v70
    v_and_b32 v11, s15, v70
    v_add_f32 v24, v24, v10
    v_add_f32 v25, v25, v11
    v_lshlrev_b32 v10, 16, v71
    v_and_b32 v11, s15, v71
    v_add_f32 v26, v26, v10
    v_add_f32 v27, v27, v11
    s_add_u32 s5, s70, 200704
    buffer_load_dwordx4 v[92:95], v8, s[48:51], s5 offen
    s_waitcnt vmcnt(5)
    v_lshlrev_b32 v10, 16, v72
    v_and_b32 v11, s15, v72
    v_add_f32 v20, v20, v10
    v_add_f32 v21, v21, v11
    v_lshlrev_b32 v10, 16, v73
    v_and_b32 v11, s15, v73
    v_add_f32 v22, v22, v10
    v_add_f32 v23, v23, v11
    v_lshlrev_b32 v10, 16, v74
    v_and_b32 v11, s15, v74
    v_add_f32 v24, v24, v10
    v_add_f32 v25, v25, v11
    v_lshlrev_b32 v10, 16, v75
    v_and_b32 v11, s15, v75
    v_add_f32 v26, v26, v10
    v_add_f32 v27, v27, v11
    s_add_u32 s5, s70, 229376
    buffer_load_dwordx4 v[96:99], v8, s[48:51], s5 offen
    s_waitcnt vmcnt(5)
    v_lshlrev_b32 v10, 16, v76
    v_and_b32 v11, s15, v76
    v_add_f32 v20, v20, v10
    v_add_f32 v21, v21, v11
    v_lshlrev_b32 v10, 16, v77
    v_and_b32 v11, s15, v77
    v_add_f32 v22, v22, v10
    v_add_f32 v23, v23, v11
    v_lshlrev_b32 v10, 16, v78
    v_and_b32 v11, s15, v78
    v_add_f32 v24, v24, v10
    v_add_f32 v25, v25, v11
    v_lshlrev_b32 v10, 16, v79
    v_and_b32 v11, s15, v79
    v_add_f32 v26, v26, v10
    v_add_f32 v27, v27, v11
    s_add_u32 s5, s70, 258048
    buffer_load_dwordx4 v[100:103], v8, s[48:51], s5 offen
    s_waitcnt vmcnt(5)
    v_lshlrev_b32 v10, 16, v80
    v_and_b32 v11, s15, v80
    v_add_f32 v20, v20, v10
    v_add_f32 v21, v21, v11
    v_lshlrev_b32 v10, 16, v81
    v_and_b32 v11, s15, v81
    v_add_f32 v22, v22, v10
    v_add_f32 v23, v23, v11
    v_lshlrev_b32 v10, 16, v82
    v_and_b32 v11, s15, v82
    v_add_f32 v24, v24, v10
    v_add_f32 v25, v25, v11
    v_lshlrev_b32 v10, 16, v83
    v_and_b32 v11, s15, v83
    v_add_f32 v26, v26, v10
    v_add_f32 v27, v27, v11
    s_add_u32 s5, s70, 286720
    buffer_load_dwordx4 v[104:107], v8, s[48:51], s5 offen
    s_waitcnt vmcnt(5)
    v_lshlrev_b32 v10, 16, v84
    v_and_b32 v11, s15, v84
    v_add_f32 v20, v20, v10
    v_add_f32 v21, v21, v11
    v_lshlrev_b32 v10, 16, v85
    v_and_b32 v11, s15, v85
    v_add_f32 v22, v22, v10
    v_add_f32 v23, v23, v11
    v_lshlrev_b32 v10, 16, v86
    v_and_b32 v11, s15, v86
    v_add_f32 v24, v24, v10
    v_add_f32 v25, v25, v11
    v_lshlrev_b32 v10, 16, v87
    v_and_b32 v11, s15, v87
    v_add_f32 v26, v26, v10
    v_add_f32 v27, v27, v11
    s_add_u32 s5, s70, 315392
    buffer_load_dwordx4 v[108:111], v8, s[48:51], s5 offen
    buffer_load_dwordx2 v[6:7], v5, s[60:63], 0 offen sc1
    s_waitcnt vmcnt(6)
    v_lshlrev_b32 v10, 16, v88
    v_and_b32 v11, s15, v88
    v_add_f32 v20, v20, v10
    v_add_f32 v21, v21, v11
    v_lshlrev_b32 v10, 16, v89
    v_and_b32 v11, s15, v89
    v_add_f32 v22, v22, v10
    v_add_f32 v23, v23, v11
    v_lshlrev_b32 v10, 16, v90
    v_and_b32 v11, s15, v90
    v_add_f32 v24, v24, v10
    v_add_f32 v25, v25, v11
    v_lshlrev_b32 v10, 16, v91
    v_and_b32 v11, s15, v91
    v_add_f32 v26, v26, v10
    v_add_f32 v27, v27, v11
    s_add_u32 s5, s70, 344064
    buffer_load_dwordx4 v[112:115], v8, s[48:51], s5 offen
    s_waitcnt vmcnt(6)
    v_lshlrev_b32 v10, 16, v92
    v_and_b32 v11, s15, v92
    v_add_f32 v20, v20, v10
    v_add_f32 v21, v21, v11
    v_lshlrev_b32 v10, 16, v93
    v_and_b32 v11, s15, v93
    v_add_f32 v22, v22, v10
    v_add_f32 v23, v23, v11
    v_lshlrev_b32 v10, 16, v94
    v_and_b32 v11, s15, v94
    v_add_f32 v24, v24, v10
    v_add_f32 v25, v25, v11
    v_lshlrev_b32 v10, 16, v95
    v_and_b32 v11, s15, v95
    v_add_f32 v26, v26, v10
    v_add_f32 v27, v27, v11
    s_add_u32 s5, s70, 372736
    buffer_load_dwordx4 v[116:119], v8, s[48:51], s5 offen
    s_waitcnt vmcnt(6)
    v_lshlrev_b32 v10, 16, v96
    v_and_b32 v11, s15, v96
    v_add_f32 v20, v20, v10
    v_add_f32 v21, v21, v11
    v_lshlrev_b32 v10, 16, v97
    v_and_b32 v11, s15, v97
    v_add_f32 v22, v22, v10
    v_add_f32 v23, v23, v11
    v_lshlrev_b32 v10, 16, v98
    v_and_b32 v11, s15, v98
    v_add_f32 v24, v24, v10
    v_add_f32 v25, v25, v11
    v_lshlrev_b32 v10, 16, v99
    v_and_b32 v11, s15, v99
    v_add_f32 v26, v26, v10
    v_add_f32 v27, v27, v11
    s_add_u32 s5, s71, 0
    buffer_load_dwordx4 v[120:123], v8, s[48:51], s5 offen
    s_waitcnt vmcnt(6)
    v_lshlrev_b32 v10, 16, v100
    v_and_b32 v11, s15, v100
    v_add_f32 v20, v20, v10
    v_add_f32 v21, v21, v11
    v_lshlrev_b32 v10, 16, v101
    v_and_b32 v11, s15, v101
    v_add_f32 v22, v22, v10
    v_add_f32 v23, v23, v11
    v_lshlrev_b32 v10, 16, v102
    v_and_b32 v11, s15, v102
    v_add_f32 v24, v24, v10
    v_add_f32 v25, v25, v11
    v_lshlrev_b32 v10, 16, v103
    v_and_b32 v11, s15, v103
    v_add_f32 v26, v26, v10
    v_add_f32 v27, v27, v11
    s_add_u32 s5, s71, 28672
    buffer_load_dwordx4 v[124:127], v8, s[48:51], s5 offen
    s_waitcnt vmcnt(6)
    v_lshlrev_b32 v10, 16, v104
    v_and_b32 v11, s15, v104
    v_add_f32 v20, v20, v10
    v_add_f32 v21, v21, v11
    v_lshlrev_b32 v10, 16, v105
    v_and_b32 v11, s15, v105
    v_add_f32 v22, v22, v10
    v_add_f32 v23, v23, v11
    v_lshlrev_b32 v10, 16, v106
    v_and_b32 v11, s15, v106
    v_add_f32 v24, v24, v10
    v_add_f32 v25, v25, v11
    v_lshlrev_b32 v10, 16, v107
    v_and_b32 v11, s15, v107
    v_add_f32 v26, v26, v10
    v_add_f32 v27, v27, v11
    s_add_u32 s5, s71, 57344
    buffer_load_dwordx4 v[128:131], v8, s[48:51], s5 offen
    s_waitcnt vmcnt(6)
    v_lshlrev_b32 v10, 16, v108
    v_and_b32 v11, s15, v108
    v_add_f32 v20, v20, v10
    v_add_f32 v21, v21, v11
    v_lshlrev_b32 v10, 16, v109
    v_and_b32 v11, s15, v109
    v_add_f32 v22, v22, v10
    v_add_f32 v23, v23, v11
    v_lshlrev_b32 v10, 16, v110
    v_and_b32 v11, s15, v110
    v_add_f32 v24, v24, v10
    v_add_f32 v25, v25, v11
    v_lshlrev_b32 v10, 16, v111
    v_and_b32 v11, s15, v111
    v_add_f32 v26, v26, v10
    v_add_f32 v27, v27, v11
    s_add_u32 s5, s71, 86016
    buffer_load_dwordx4 v[132:135], v8, s[48:51], s5 offen
    s_waitcnt vmcnt(5)
    v_lshlrev_b32 v10, 16, v112
    v_and_b32 v11, s15, v112
    v_add_f32 v20, v20, v10
    v_add_f32 v21, v21, v11
    v_lshlrev_b32 v10, 16, v113
    v_and_b32 v11, s15, v113
    v_add_f32 v22, v22, v10
    v_add_f32 v23, v23, v11
    v_lshlrev_b32 v10, 16, v114
    v_and_b32 v11, s15, v114
    v_add_f32 v24, v24, v10
    v_add_f32 v25, v25, v11
    v_lshlrev_b32 v10, 16, v115
    v_and_b32 v11, s15, v115
    v_add_f32 v26, v26, v10
    v_add_f32 v27, v27, v11
    s_add_u32 s5, s71, 114688
    buffer_load_dwordx4 v[136:139], v8, s[48:51], s5 offen
    s_waitcnt vmcnt(5)
    v_lshlrev_b32 v10, 16, v116
    v_and_b32 v11, s15, v116
    v_add_f32 v20, v20, v10
    v_add_f32 v21, v21, v11
    v_lshlrev_b32 v10, 16, v117
    v_and_b32 v11, s15, v117
    v_add_f32 v22, v22, v10
    v_add_f32 v23, v23, v11
    v_lshlrev_b32 v10, 16, v118
    v_and_b32 v11, s15, v118
    v_add_f32 v24, v24, v10
    v_add_f32 v25, v25, v11
    v_lshlrev_b32 v10, 16, v119
    v_and_b32 v11, s15, v119
    v_add_f32 v26, v26, v10
    v_add_f32 v27, v27, v11
    s_add_u32 s5, s71, 143360
    buffer_load_dwordx4 v[140:143], v8, s[48:51], s5 offen
    ds_write_b128 v9, v[20:23] offset:0
    ds_write_b128 v9, v[24:27] offset:16
    s_min_u32 s5, s3, 0
    s_add_u32 s5, s5, 0
    s_lshl_b32 s6, s5, 13
    v_add_u32 v14, s6, v13
    s_waitcnt lgkmcnt(0)
    s_barrier
    ds_read2st64_b32 v[44:45], v14 offset0:0 offset1:1
    ds_read2st64_b32 v[46:47], v14 offset0:2 offset1:3
    ds_read2st64_b32 v[48:49], v14 offset0:4 offset1:5
    ds_read2st64_b32 v[50:51], v14 offset0:6 offset1:7
    ds_read2st64_b32 v[52:53], v14 offset0:8 offset1:9
    ds_read2st64_b32 v[54:55], v14 offset0:10 offset1:11
    ds_read2st64_b32 v[56:57], v14 offset0:12 offset1:13
    ds_read2st64_b32 v[58:59], v14 offset0:14 offset1:15
    s_waitcnt lgkmcnt(0)
    v_mov_b32 v12, v44
    v_add_f32 v12, v12, v45
    v_add_f32 v12, v12, v46
    v_add_f32 v12, v12, v47
    v_add_f32 v12, v12, v48
    v_add_f32 v12, v12, v49
    v_add_f32 v12, v12, v50
    v_add_f32 v12, v12, v51
    v_add_f32 v12, v12, v52
    v_add_f32 v12, v12, v53
    v_add_f32 v12, v12, v54
    v_add_f32 v12, v12, v55
    v_add_f32 v12, v12, v56
    v_add_f32 v12, v12, v57
    v_add_f32 v12, v12, v58
    v_add_f32 v12, v12, v59
    ds_read2st64_b32 v[44:45], v14 offset0:16 offset1:17
    ds_read2st64_b32 v[46:47], v14 offset0:18 offset1:19
    ds_read2st64_b32 v[48:49], v14 offset0:20 offset1:21
    ds_read2st64_b32 v[50:51], v14 offset0:22 offset1:23
    ds_read2st64_b32 v[52:53], v14 offset0:24 offset1:25
    ds_read2st64_b32 v[54:55], v14 offset0:26 offset1:27
    ds_read2st64_b32 v[56:57], v14 offset0:28 offset1:29
    ds_read2st64_b32 v[58:59], v14 offset0:30 offset1:31
    s_waitcnt lgkmcnt(0)
    v_add_f32 v12, v12, v44
    v_add_f32 v12, v12, v45
    v_add_f32 v12, v12, v46
    v_add_f32 v12, v12, v47
    v_add_f32 v12, v12, v48
    v_add_f32 v12, v12, v49
    v_add_f32 v12, v12, v50
    v_add_f32 v12, v12, v51
    v_add_f32 v12, v12, v52
    v_add_f32 v12, v12, v53
    v_add_f32 v12, v12, v54
    v_add_f32 v12, v12, v55
    v_add_f32 v12, v12, v56
    v_add_f32 v12, v12, v57
    v_add_f32 v12, v12, v58
    v_add_f32 v12, v12, v59
    s_lshl_b32 s6, s64, 10
    s_lshl_b32 s5, s5, 8
    s_add_u32 s6, s6, s5
    s_add_u32 s6, s6, 11026432
    s_cmp_lt_u32 s3, 1
    s_cselect_b32 s5, 0, 0x40000000
    s_add_u32 s6, s6, s5
    buffer_store_dword v12, v13, s[52:55], s6 offen sc1
    s_waitcnt vmcnt(6)
    v_lshlrev_b32 v28, 16, v120
    v_and_b32 v29, s15, v120
    v_lshlrev_b32 v30, 16, v121
    v_and_b32 v31, s15, v121
    v_lshlrev_b32 v32, 16, v122
    v_and_b32 v33, s15, v122
    v_lshlrev_b32 v34, 16, v123
    v_and_b32 v35, s15, v123
    s_add_u32 s5, s71, 172032
    buffer_load_dwordx4 v[144:147], v8, s[48:51], s5 offen
    s_waitcnt vmcnt(6)
    v_lshlrev_b32 v10, 16, v124
    v_and_b32 v11, s15, v124
    v_add_f32 v28, v28, v10
    v_add_f32 v29, v29, v11
    v_lshlrev_b32 v10, 16, v125
    v_and_b32 v11, s15, v125
    v_add_f32 v30, v30, v10
    v_add_f32 v31, v31, v11
    v_lshlrev_b32 v10, 16, v126
    v_and_b32 v11, s15, v126
    v_add_f32 v32, v32, v10
    v_add_f32 v33, v33, v11
    v_lshlrev_b32 v10, 16, v127
    v_and_b32 v11, s15, v127
    v_add_f32 v34, v34, v10
    v_add_f32 v35, v35, v11
    s_add_u32 s5, s71, 200704
    buffer_load_dwordx4 v[148:151], v8, s[48:51], s5 offen
    s_waitcnt vmcnt(6)
    v_lshlrev_b32 v10, 16, v128
    v_and_b32 v11, s15, v128
    v_add_f32 v28, v28, v10
    v_add_f32 v29, v29, v11
    v_lshlrev_b32 v10, 16, v129
    v_and_b32 v11, s15, v129
    v_add_f32 v30, v30, v10
    v_add_f32 v31, v31, v11
    v_lshlrev_b32 v10, 16, v130
    v_and_b32 v11, s15, v130
    v_add_f32 v32, v32, v10
    v_add_f32 v33, v33, v11
    v_lshlrev_b32 v10, 16, v131
    v_and_b32 v11, s15, v131
    v_add_f32 v34, v34, v10
    v_add_f32 v35, v35, v11
    s_add_u32 s5, s71, 229376
    buffer_load_dwordx4 v[152:155], v8, s[48:51], s5 offen
    s_waitcnt vmcnt(6)
    v_lshlrev_b32 v10, 16, v132
    v_and_b32 v11, s15, v132
    v_add_f32 v28, v28, v10
    v_add_f32 v29, v29, v11
    v_lshlrev_b32 v10, 16, v133
    v_and_b32 v11, s15, v133
    v_add_f32 v30, v30, v10
    v_add_f32 v31, v31, v11
    v_lshlrev_b32 v10, 16, v134
    v_and_b32 v11, s15, v134
    v_add_f32 v32, v32, v10
    v_add_f32 v33, v33, v11
    v_lshlrev_b32 v10, 16, v135
    v_and_b32 v11, s15, v135
    v_add_f32 v34, v34, v10
    v_add_f32 v35, v35, v11
    s_add_u32 s5, s71, 258048
    buffer_load_dwordx4 v[156:159], v8, s[48:51], s5 offen
    s_waitcnt vmcnt(6)
    v_lshlrev_b32 v10, 16, v136
    v_and_b32 v11, s15, v136
    v_add_f32 v28, v28, v10
    v_add_f32 v29, v29, v11
    v_lshlrev_b32 v10, 16, v137
    v_and_b32 v11, s15, v137
    v_add_f32 v30, v30, v10
    v_add_f32 v31, v31, v11
    v_lshlrev_b32 v10, 16, v138
    v_and_b32 v11, s15, v138
    v_add_f32 v32, v32, v10
    v_add_f32 v33, v33, v11
    v_lshlrev_b32 v10, 16, v139
    v_and_b32 v11, s15, v139
    v_add_f32 v34, v34, v10
    v_add_f32 v35, v35, v11
    s_add_u32 s5, s71, 286720
    buffer_load_dwordx4 v[160:163], v8, s[48:51], s5 offen
    v_readfirstlane_b32 s43, v7
    v_readfirstlane_b32 s42, v6
    s_cmp_lg_u32 s43, 0
    s_cbranch_scc1 L_stag_ok
L_stag_retry:
    s_add_u32 s100, s100, 1
    s_cmp_gt_u32 s100, 200000
    s_cbranch_scc1 L_stag_ok
    s_sleep 8
    buffer_load_dwordx2 v[6:7], v5, s[60:63], 0 offen sc1
    s_waitcnt vmcnt(0)
    v_readfirstlane_b32 s43, v7
    v_readfirstlane_b32 s42, v6
    s_cmp_lg_u32 s43, 0
    s_cbranch_scc0 L_stag_retry
L_stag_ok:
    s_lshl_b32 s5, s64, 7
    s_add_u32 s5, s5, 11137024
    s_waitcnt vmcnt(5)
    s_barrier
    buffer_store_dwordx2 v[6:7], v4, s[52:55], s5 offen offset:0 sc1
    v_lshlrev_b32 v10, 16, v140
    v_and_b32 v11, s15, v140
    v_add_f32 v28, v28, v10
    v_add_f32 v29, v29, v11
    v_lshlrev_b32 v10, 16, v141
    v_and_b32 v11, s15, v141
    v_add_f32 v30, v30, v10
    v_add_f32 v31, v31, v11
    v_lshlrev_b32 v10, 16, v142
    v_and_b32 v11, s15, v142
    v_add_f32 v32, v32, v10
    v_add_f32 v33, v33, v11
    v_lshlrev_b32 v10, 16, v143
    v_and_b32 v11, s15, v143
    v_add_f32 v34, v34, v10
    v_add_f32 v35, v35, v11
    s_add_u32 s5, s71, 315392
    buffer_load_dwordx4 v[164:167], v8, s[48:51], s5 offen
    s_waitcnt vmcnt(6)
    v_lshlrev_b32 v10, 16, v144
    v_and_b32 v11, s15, v144
    v_add_f32 v28, v28, v10
    v_add_f32 v29, v29, v11
    v_lshlrev_b32 v10, 16, v145
    v_and_b32 v11, s15, v145
    v_add_f32 v30, v30, v10
    v_add_f32 v31, v31, v11
    v_lshlrev_b32 v10, 16, v146
    v_and_b32 v11, s15, v146
    v_add_f32 v32, v32, v10
    v_add_f32 v33, v33, v11
    v_lshlrev_b32 v10, 16, v147
    v_and_b32 v11, s15, v147
    v_add_f32 v34, v34, v10
    v_add_f32 v35, v35, v11
    s_add_u32 s5, s71, 344064
    buffer_load_dwordx4 v[168:171], v8, s[48:51], s5 offen
    s_waitcnt vmcnt(6)
    v_lshlrev_b32 v10, 16, v148
    v_and_b32 v11, s15, v148
    v_add_f32 v28, v28, v10
    v_add_f32 v29, v29, v11
    v_lshlrev_b32 v10, 16, v149
    v_and_b32 v11, s15, v149
    v_add_f32 v30, v30, v10
    v_add_f32 v31, v31, v11
    v_lshlrev_b32 v10, 16, v150
    v_and_b32 v11, s15, v150
    v_add_f32 v32, v32, v10
    v_add_f32 v33, v33, v11
    v_lshlrev_b32 v10, 16, v151
    v_and_b32 v11, s15, v151
    v_add_f32 v34, v34, v10
    v_add_f32 v35, v35, v11
    s_add_u32 s5, s71, 372736
    buffer_load_dwordx4 v[172:175], v8, s[48:51], s5 offen
    s_waitcnt vmcnt(6)
    v_lshlrev_b32 v10, 16, v152
    v_and_b32 v11, s15, v152
    v_add_f32 v28, v28, v10
    v_add_f32 v29, v29, v11
    v_lshlrev_b32 v10, 16, v153
    v_and_b32 v11, s15, v153
    v_add_f32 v30, v30, v10
    v_add_f32 v31, v31, v11
    v_lshlrev_b32 v10, 16, v154
    v_and_b32 v11, s15, v154
    v_add_f32 v32, v32, v10
    v_add_f32 v33, v33, v11
    v_lshlrev_b32 v10, 16, v155
    v_and_b32 v11, s15, v155
    v_add_f32 v34, v34, v10
    v_add_f32 v35, v35, v11
    s_add_u32 s5, s72, 0
    buffer_load_dwordx4 v[176:179], v8, s[48:51], s5 offen
    s_waitcnt vmcnt(6)
    v_lshlrev_b32 v10, 16, v156
    v_and_b32 v11, s15, v156
    v_add_f32 v28, v28, v10
    v_add_f32 v29, v29, v11
    v_lshlrev_b32 v10, 16, v157
    v_and_b32 v11, s15, v157
    v_add_f32 v30, v30, v10
    v_add_f32 v31, v31, v11
    v_lshlrev_b32 v10, 16, v158
    v_and_b32 v11, s15, v158
    v_add_f32 v32, v32, v10
    v_add_f32 v33, v33, v11
    v_lshlrev_b32 v10, 16, v159
    v_and_b32 v11, s15, v159
    v_add_f32 v34, v34, v10
    v_add_f32 v35, v35, v11
    s_add_u32 s5, s72, 28672
    buffer_load_dwordx4 v[180:183], v8, s[48:51], s5 offen
    s_waitcnt vmcnt(6)
    v_lshlrev_b32 v10, 16, v160
    v_and_b32 v11, s15, v160
    v_add_f32 v28, v28, v10
    v_add_f32 v29, v29, v11
    v_lshlrev_b32 v10, 16, v161
    v_and_b32 v11, s15, v161
    v_add_f32 v30, v30, v10
    v_add_f32 v31, v31, v11
    v_lshlrev_b32 v10, 16, v162
    v_and_b32 v11, s15, v162
    v_add_f32 v32, v32, v10
    v_add_f32 v33, v33, v11
    v_lshlrev_b32 v10, 16, v163
    v_and_b32 v11, s15, v163
    v_add_f32 v34, v34, v10
    v_add_f32 v35, v35, v11
    s_add_u32 s5, s72, 57344
    buffer_load_dwordx4 v[184:187], v8, s[48:51], s5 offen
    s_waitcnt vmcnt(5)
    v_lshlrev_b32 v10, 16, v164
    v_and_b32 v11, s15, v164
    v_add_f32 v28, v28, v10
    v_add_f32 v29, v29, v11
    v_lshlrev_b32 v10, 16, v165
    v_and_b32 v11, s15, v165
    v_add_f32 v30, v30, v10
    v_add_f32 v31, v31, v11
    v_lshlrev_b32 v10, 16, v166
    v_and_b32 v11, s15, v166
    v_add_f32 v32, v32, v10
    v_add_f32 v33, v33, v11
    v_lshlrev_b32 v10, 16, v167
    v_and_b32 v11, s15, v167
    v_add_f32 v34, v34, v10
    v_add_f32 v35, v35, v11
    s_add_u32 s5, s72, 86016
    buffer_load_dwordx4 v[188:191], v8, s[48:51], s5 offen
    s_waitcnt vmcnt(5)
    v_lshlrev_b32 v10, 16, v168
    v_and_b32 v11, s15, v168
    v_add_f32 v28, v28, v10
    v_add_f32 v29, v29, v11
    v_lshlrev_b32 v10, 16, v169
    v_and_b32 v11, s15, v169
    v_add_f32 v30, v30, v10
    v_add_f32 v31, v31, v11
    v_lshlrev_b32 v10, 16, v170
    v_and_b32 v11, s15, v170
    v_add_f32 v32, v32, v10
    v_add_f32 v33, v33, v11
    v_lshlrev_b32 v10, 16, v171
    v_and_b32 v11, s15, v171
    v_add_f32 v34, v34, v10
    v_add_f32 v35, v35, v11
    s_add_u32 s5, s72, 114688
    buffer_load_dwordx4 v[192:195], v8, s[48:51], s5 offen
    s_waitcnt vmcnt(5)
    v_lshlrev_b32 v10, 16, v172
    v_and_b32 v11, s15, v172
    v_add_f32 v28, v28, v10
    v_add_f32 v29, v29, v11
    v_lshlrev_b32 v10, 16, v173
    v_and_b32 v11, s15, v173
    v_add_f32 v30, v30, v10
    v_add_f32 v31, v31, v11
    v_lshlrev_b32 v10, 16, v174
    v_and_b32 v11, s15, v174
    v_add_f32 v32, v32, v10
    v_add_f32 v33, v33, v11
    v_lshlrev_b32 v10, 16, v175
    v_and_b32 v11, s15, v175
    v_add_f32 v34, v34, v10
    v_add_f32 v35, v35, v11
    s_add_u32 s5, s72, 143360
    buffer_load_dwordx4 v[196:199], v8, s[48:51], s5 offen
    s_waitcnt vmcnt(5)
    v_lshlrev_b32 v36, 16, v176
    v_and_b32 v37, s15, v176
    v_lshlrev_b32 v38, 16, v177
    v_and_b32 v39, s15, v177
    v_lshlrev_b32 v40, 16, v178
    v_and_b32 v41, s15, v178
    v_lshlrev_b32 v42, 16, v179
    v_and_b32 v43, s15, v179
    s_add_u32 s5, s72, 172032
    buffer_load_dwordx4 v[200:203], v8, s[48:51], s5 offen
    s_waitcnt vmcnt(5)
    v_lshlrev_b32 v10, 16, v180
    v_and_b32 v11, s15, v180
    v_add_f32 v36, v36, v10
    v_add_f32 v37, v37, v11
    v_lshlrev_b32 v10, 16, v181
    v_and_b32 v11, s15, v181
    v_add_f32 v38, v38, v10
    v_add_f32 v39, v39, v11
    v_lshlrev_b32 v10, 16, v182
    v_and_b32 v11, s15, v182
    v_add_f32 v40, v40, v10
    v_add_f32 v41, v41, v11
    v_lshlrev_b32 v10, 16, v183
    v_and_b32 v11, s15, v183
    v_add_f32 v42, v42, v10
    v_add_f32 v43, v43, v11
    s_add_u32 s5, s72, 200704
    buffer_load_dwordx4 v[204:207], v8, s[48:51], s5 offen
    s_waitcnt vmcnt(5)
    v_lshlrev_b32 v10, 16, v184
    v_and_b32 v11, s15, v184
    v_add_f32 v36, v36, v10
    v_add_f32 v37, v37, v11
    v_lshlrev_b32 v10, 16, v185
    v_and_b32 v11, s15, v185
    v_add_f32 v38, v38, v10
    v_add_f32 v39, v39, v11
    v_lshlrev_b32 v10, 16, v186
    v_and_b32 v11, s15, v186
    v_add_f32 v40, v40, v10
    v_add_f32 v41, v41, v11
    v_lshlrev_b32 v10, 16, v187
    v_and_b32 v11, s15, v187
    v_add_f32 v42, v42, v10
    v_add_f32 v43, v43, v11
    s_add_u32 s5, s72, 229376
    buffer_load_dwordx4 v[208:211], v8, s[48:51], s5 offen
    s_waitcnt vmcnt(5)
    v_lshlrev_b32 v10, 16, v188
    v_and_b32 v11, s15, v188
    v_add_f32 v36, v36, v10
    v_add_f32 v37, v37, v11
    v_lshlrev_b32 v10, 16, v189
    v_and_b32 v11, s15, v189
    v_add_f32 v38, v38, v10
    v_add_f32 v39, v39, v11
    v_lshlrev_b32 v10, 16, v190
    v_and_b32 v11, s15, v190
    v_add_f32 v40, v40, v10
    v_add_f32 v41, v41, v11
    v_lshlrev_b32 v10, 16, v191
    v_and_b32 v11, s15, v191
    v_add_f32 v42, v42, v10
    v_add_f32 v43, v43, v11
    s_add_u32 s5, s72, 258048
    buffer_load_dwordx4 v[212:215], v8, s[48:51], s5 offen
    s_waitcnt vmcnt(5)
    v_lshlrev_b32 v10, 16, v192
    v_and_b32 v11, s15, v192
    v_add_f32 v36, v36, v10
    v_add_f32 v37, v37, v11
    v_lshlrev_b32 v10, 16, v193
    v_and_b32 v11, s15, v193
    v_add_f32 v38, v38, v10
    v_add_f32 v39, v39, v11
    v_lshlrev_b32 v10, 16, v194
    v_and_b32 v11, s15, v194
    v_add_f32 v40, v40, v10
    v_add_f32 v41, v41, v11
    v_lshlrev_b32 v10, 16, v195
    v_and_b32 v11, s15, v195
    v_add_f32 v42, v42, v10
    v_add_f32 v43, v43, v11
    s_add_u32 s5, s72, 286720
    buffer_load_dwordx4 v[216:219], v8, s[48:51], s5 offen
    s_waitcnt vmcnt(5)
    v_lshlrev_b32 v10, 16, v196
    v_and_b32 v11, s15, v196
    v_add_f32 v36, v36, v10
    v_add_f32 v37, v37, v11
    v_lshlrev_b32 v10, 16, v197
    v_and_b32 v11, s15, v197
    v_add_f32 v38, v38, v10
    v_add_f32 v39, v39, v11
    v_lshlrev_b32 v10, 16, v198
    v_and_b32 v11, s15, v198
    v_add_f32 v40, v40, v10
    v_add_f32 v41, v41, v11
    v_lshlrev_b32 v10, 16, v199
    v_and_b32 v11, s15, v199
    v_add_f32 v42, v42, v10
    v_add_f32 v43, v43, v11
    s_add_u32 s5, s72, 315392
    buffer_load_dwordx4 v[220:223], v8, s[48:51], s5 offen
    s_waitcnt vmcnt(5)
    v_lshlrev_b32 v10, 16, v200
    v_and_b32 v11, s15, v200
    v_add_f32 v36, v36, v10
    v_add_f32 v37, v37, v11
    v_lshlrev_b32 v10, 16, v201
    v_and_b32 v11, s15, v201
    v_add_f32 v38, v38, v10
    v_add_f32 v39, v39, v11
    v_lshlrev_b32 v10, 16, v202
    v_and_b32 v11, s15, v202
    v_add_f32 v40, v40, v10
    v_add_f32 v41, v41, v11
    v_lshlrev_b32 v10, 16, v203
    v_and_b32 v11, s15, v203
    v_add_f32 v42, v42, v10
    v_add_f32 v43, v43, v11
    s_add_u32 s5, s72, 344064
    buffer_load_dwordx4 v[224:227], v8, s[48:51], s5 offen
    s_waitcnt vmcnt(5)
    v_lshlrev_b32 v10, 16, v204
    v_and_b32 v11, s15, v204
    v_add_f32 v36, v36, v10
    v_add_f32 v37, v37, v11
    v_lshlrev_b32 v10, 16, v205
    v_and_b32 v11, s15, v205
    v_add_f32 v38, v38, v10
    v_add_f32 v39, v39, v11
    v_lshlrev_b32 v10, 16, v206
    v_and_b32 v11, s15, v206
    v_add_f32 v40, v40, v10
    v_add_f32 v41, v41, v11
    v_lshlrev_b32 v10, 16, v207
    v_and_b32 v11, s15, v207
    v_add_f32 v42, v42, v10
    v_add_f32 v43, v43, v11
    s_add_u32 s5, s72, 372736
    buffer_load_dwordx4 v[228:231], v8, s[48:51], s5 offen
    s_waitcnt vmcnt(5)
    v_lshlrev_b32 v10, 16, v208
    v_and_b32 v11, s15, v208
    v_add_f32 v36, v36, v10
    v_add_f32 v37, v37, v11
    v_lshlrev_b32 v10, 16, v209
    v_and_b32 v11, s15, v209
    v_add_f32 v38, v38, v10
    v_add_f32 v39, v39, v11
    v_lshlrev_b32 v10, 16, v210
    v_and_b32 v11, s15, v210
    v_add_f32 v40, v40, v10
    v_add_f32 v41, v41, v11
    v_lshlrev_b32 v10, 16, v211
    v_and_b32 v11, s15, v211
    v_add_f32 v42, v42, v10
    v_add_f32 v43, v43, v11
    s_waitcnt vmcnt(4)
    v_lshlrev_b32 v10, 16, v212
    v_and_b32 v11, s15, v212
    v_add_f32 v36, v36, v10
    v_add_f32 v37, v37, v11
    v_lshlrev_b32 v10, 16, v213
    v_and_b32 v11, s15, v213
    v_add_f32 v38, v38, v10
    v_add_f32 v39, v39, v11
    v_lshlrev_b32 v10, 16, v214
    v_and_b32 v11, s15, v214
    v_add_f32 v40, v40, v10
    v_add_f32 v41, v41, v11
    v_lshlrev_b32 v10, 16, v215
    v_and_b32 v11, s15, v215
    v_add_f32 v42, v42, v10
    v_add_f32 v43, v43, v11
    s_waitcnt vmcnt(3)
    v_lshlrev_b32 v10, 16, v216
    v_and_b32 v11, s15, v216
    v_add_f32 v36, v36, v10
    v_add_f32 v37, v37, v11
    v_lshlrev_b32 v10, 16, v217
    v_and_b32 v11, s15, v217
    v_add_f32 v38, v38, v10
    v_add_f32 v39, v39, v11
    v_lshlrev_b32 v10, 16, v218
    v_and_b32 v11, s15, v218
    v_add_f32 v40, v40, v10
    v_add_f32 v41, v41, v11
    v_lshlrev_b32 v10, 16, v219
    v_and_b32 v11, s15, v219
    v_add_f32 v42, v42, v10
    v_add_f32 v43, v43, v11
    s_waitcnt vmcnt(2)
    v_lshlrev_b32 v10, 16, v220
    v_and_b32 v11, s15, v220
    v_add_f32 v36, v36, v10
    v_add_f32 v37, v37, v11
    v_lshlrev_b32 v10, 16, v221
    v_and_b32 v11, s15, v221
    v_add_f32 v38, v38, v10
    v_add_f32 v39, v39, v11
    v_lshlrev_b32 v10, 16, v222
    v_and_b32 v11, s15, v222
    v_add_f32 v40, v40, v10
    v_add_f32 v41, v41, v11
    v_lshlrev_b32 v10, 16, v223
    v_and_b32 v11, s15, v223
    v_add_f32 v42, v42, v10
    v_add_f32 v43, v43, v11
    s_waitcnt vmcnt(1)
    v_lshlrev_b32 v10, 16, v224
    v_and_b32 v11, s15, v224
    v_add_f32 v36, v36, v10
    v_add_f32 v37, v37, v11
    v_lshlrev_b32 v10, 16, v225
    v_and_b32 v11, s15, v225
    v_add_f32 v38, v38, v10
    v_add_f32 v39, v39, v11
    v_lshlrev_b32 v10, 16, v226
    v_and_b32 v11, s15, v226
    v_add_f32 v40, v40, v10
    v_add_f32 v41, v41, v11
    v_lshlrev_b32 v10, 16, v227
    v_and_b32 v11, s15, v227
    v_add_f32 v42, v42, v10
    v_add_f32 v43, v43, v11
    s_waitcnt vmcnt(0)
    v_lshlrev_b32 v10, 16, v228
    v_and_b32 v11, s15, v228
    v_add_f32 v36, v36, v10
    v_add_f32 v37, v37, v11
    v_lshlrev_b32 v10, 16, v229
    v_and_b32 v11, s15, v229
    v_add_f32 v38, v38, v10
    v_add_f32 v39, v39, v11
    v_lshlrev_b32 v10, 16, v230
    v_and_b32 v11, s15, v230
    v_add_f32 v40, v40, v10
    v_add_f32 v41, v41, v11
    v_lshlrev_b32 v10, 16, v231
    v_and_b32 v11, s15, v231
    v_add_f32 v42, v42, v10
    v_add_f32 v43, v43, v11
    ds_write_b128 v9, v[28:31] offset:8192
    ds_write_b128 v9, v[32:35] offset:8208
    ds_write_b128 v9, v[36:39] offset:16384
    ds_write_b128 v9, v[40:43] offset:16400
    s_min_u32 s5, s3, 1
    s_add_u32 s5, s5, 1
    s_lshl_b32 s6, s5, 13
    v_add_u32 v14, s6, v13
    s_waitcnt lgkmcnt(0)
    s_barrier
    ds_read2st64_b32 v[44:45], v14 offset0:0 offset1:1
    ds_read2st64_b32 v[46:47], v14 offset0:2 offset1:3
    ds_read2st64_b32 v[48:49], v14 offset0:4 offset1:5
    ds_read2st64_b32 v[50:51], v14 offset0:6 offset1:7
    ds_read2st64_b32 v[52:53], v14 offset0:8 offset1:9
    ds_read2st64_b32 v[54:55], v14 offset0:10 offset1:11
    ds_read2st64_b32 v[56:57], v14 offset0:12 offset1:13
    ds_read2st64_b32 v[58:59], v14 offset0:14 offset1:15
    s_waitcnt lgkmcnt(0)
    v_mov_b32 v12, v44
    v_add_f32 v12, v12, v45
    v_add_f32 v12, v12, v46
    v_add_f32 v12, v12, v47
    v_add_f32 v12, v12, v48
    v_add_f32 v12, v12, v49
    v_add_f32 v12, v12, v50
    v_add_f32 v12, v12, v51
    v_add_f32 v12, v12, v52
    v_add_f32 v12, v12, v53
    v_add_f32 v12, v12, v54
    v_add_f32 v12, v12, v55
    v_add_f32 v12, v12, v56
    v_add_f32 v12, v12, v57
    v_add_f32 v12, v12, v58
    v_add_f32 v12, v12, v59
    ds_read2st64_b32 v[44:45], v14 offset0:16 offset1:17
    ds_read2st64_b32 v[46:47], v14 offset0:18 offset1:19
    ds_read2st64_b32 v[48:49], v14 offset0:20 offset1:21
    ds_read2st64_b32 v[50:51], v14 offset0:22 offset1:23
    ds_read2st64_b32 v[52:53], v14 offset0:24 offset1:25
    ds_read2st64_b32 v[54:55], v14 offset0:26 offset1:27
    ds_read2st64_b32 v[56:57], v14 offset0:28 offset1:29
    ds_read2st64_b32 v[58:59], v14 offset0:30 offset1:31
    s_waitcnt lgkmcnt(0)
    v_add_f32 v12, v12, v44
    v_add_f32 v12, v12, v45
    v_add_f32 v12, v12, v46
    v_add_f32 v12, v12, v47
    v_add_f32 v12, v12, v48
    v_add_f32 v12, v12, v49
    v_add_f32 v12, v12, v50
    v_add_f32 v12, v12, v51
    v_add_f32 v12, v12, v52
    v_add_f32 v12, v12, v53
    v_add_f32 v12, v12, v54
    v_add_f32 v12, v12, v55
    v_add_f32 v12, v12, v56
    v_add_f32 v12, v12, v57
    v_add_f32 v12, v12, v58
    v_add_f32 v12, v12, v59
    s_lshl_b32 s6, s64, 10
    s_lshl_b32 s5, s5, 8
    s_add_u32 s6, s6, s5
    s_add_u32 s6, s6, 11026432
    s_cmp_lt_u32 s3, 2
    s_cselect_b32 s5, 0, 0x40000000
    s_add_u32 s6, s6, s5
    buffer_store_dword v12, v13, s[52:55], s6 offen sc1
    s_lshl_b32 s5, s64, 7
    s_add_u32 s5, s5, 11139072
    s_waitcnt vmcnt(0)
    s_barrier
    buffer_store_dwordx2 v[6:7], v4, s[52:55], s5 offen offset:0 sc1
L_end:
    s_endpgm
.section .rodata,"a"
.p2align 6
.amdhsa_kernel parallel_sum__ssm_conv_h3__glu_gated_bilinear__prompt_kernel
  .amdhsa_next_free_vgpr 512
  .amdhsa_next_free_sgpr 102
  .amdhsa_accum_offset 256
  .amdhsa_group_segment_fixed_size 0
  .amdhsa_kernarg_size 104
  .amdhsa_user_sgpr_count 2
  .amdhsa_user_sgpr_kernarg_segment_ptr 1
  .amdhsa_system_sgpr_workgroup_id_x 1
.end_amdhsa_kernel
```
